```python
import torch

def _softmax(x, axis=-1):
    return torch.softmax(x, dim=axis)
def _gelu(x):
    return torch.nn.functional.gelu(x, approximate="tanh")
def _silu(x):
    return torch.nn.functional.silu(x)
def _sigmoid(x):
    return torch.sigmoid(x)
def _layernorm(x, axis=-1, eps=1e-5):
    m = x.mean(dim=axis, keepdim=True)
    v = x.var(dim=axis, keepdim=True, unbiased=False)
    return (x - m) / torch.sqrt(v + eps)
def _scatter_add(tgt, idx, src, axis=0):
    return tgt.clone().index_add_(axis, idx, src)
def _segment_sum(src, seg, n):
    out = torch.zeros((n,) + src.shape[1:], dtype=src.dtype)
    return out.index_add_(0, seg, src)
def _pad(x, pw):
    flat = tuple(v for pair in reversed(pw) for v in pair)
    return torch.nn.functional.pad(x, flat)

kernel_name = 'parallel_sum__ssm_conv_s5__glu_gated_glu__prompt'

def setup_inputs():

    _w = (lambda a: (lambda t: t.to(torch.bfloat16) if t.is_floating_point() else t)(torch.as_tensor(a)))
    def _A_setup():
        B, S, D = 1, 2048, 1024
        P = D
        Lambda_re = -0.5 * (lambda _x: torch.exp(torch.as_tensor(_x)))((lambda *s: torch.randn(*s, dtype=torch.bfloat16) * 0.8)(P))
        Lambda_im = (lambda *s: torch.randn(*s, dtype=torch.bfloat16) * 0.8)(P) * 1.0
        B_re = (lambda *s: torch.randn(*s, dtype=torch.bfloat16) * 0.8)(P, D) * (D ** -0.5)
        B_im = (lambda *s: torch.randn(*s, dtype=torch.bfloat16) * 0.8)(P, D) * (D ** -0.5)
        C_re = (lambda *s: torch.randn(*s, dtype=torch.bfloat16) * 0.8)(D, P) * (P ** -0.5)
        C_im = (lambda *s: torch.randn(*s, dtype=torch.bfloat16) * 0.8)(D, P) * (P ** -0.5)
        log_dt = (lambda *s: torch.randn(*s, dtype=torch.bfloat16) * 0.8)(P) * 0.3 - 2.0
        Dskip = (lambda *s: torch.randn(*s, dtype=torch.bfloat16) * 0.8)(D)
        return {
            "x": _w((lambda *s: torch.randn(*s, dtype=torch.bfloat16) * 0.05)(B, S, D)),
            "Lambda_re": _w(Lambda_re),
            "Lambda_im": _w(Lambda_im),
            "B_re": _w(B_re),
            "B_im": _w(B_im),
            "C_re": _w(C_re),
            "C_im": _w(C_im),
            "log_dt": _w(log_dt),
            "Dskip": _w(Dskip),
        }
    _A_in = _A_setup()

    def _B_setup():
        B, S, D, F = 1, 2048, 1024, 3584
        return {
            "x": _w((lambda *s: torch.randn(*s, dtype=torch.bfloat16) * 0.05)(B, S, D)),
            "w_gate": _w((lambda *s: torch.randn(*s, dtype=torch.bfloat16) * 0.05)(D, F)),
            "w_up": _w((lambda *s: torch.randn(*s, dtype=torch.bfloat16) * 0.05)(D, F)),
            "w_down": _w((lambda *s: torch.randn(*s, dtype=torch.bfloat16) * 0.05)(F, D)),
        }
    _B_in = _B_setup()

    return {
        "A_x": _A_in["x"],
        "A_Lambda_re": _A_in["Lambda_re"],
        "A_Lambda_im": _A_in["Lambda_im"],
        "A_B_re": _A_in["B_re"],
        "A_B_im": _A_in["B_im"],
        "A_C_re": _A_in["C_re"],
        "A_C_im": _A_in["C_im"],
        "A_log_dt": _A_in["log_dt"],
        "A_Dskip": _A_in["Dskip"],
        "B_x": _B_in["x"],
        "B_w_gate": _B_in["w_gate"],
        "B_w_up": _B_in["w_up"],
        "B_w_down": _B_in["w_down"],
    }

def reference(A_x, A_Lambda_re, A_Lambda_im, A_B_re, A_B_im, A_C_re, A_C_im, A_log_dt, A_Dskip, B_x, B_w_gate, B_w_up, B_w_down):
    def _A_ref(x, Lambda_re, Lambda_im, B_re, B_im, C_re, C_im, log_dt, Dskip):
        Bsz, L, H = x.shape
        Lam = Lambda_re + 1j * Lambda_im
        Bmat = B_re + 1j * B_im
        Cmat = C_re + 1j * C_im
        dt = torch.exp(log_dt)
        Lam_bar = torch.exp(dt * Lam)
        B_bar = ((Lam_bar - 1.0) / Lam)[:, None] * Bmat
        Bu = torch.einsum("bld,pd->blp", x + 0j, B_bar)
        h = torch.zeros_like(Bu[:, 0, :])
        hs = []
        for t in range(L):
            h = Lam_bar[None, :] * h + Bu[:, t, :]
            hs.append(h)
        hseq = torch.stack(hs, 1)
        y = 2.0 * torch.einsum("blp,dp->bld", hseq, Cmat).real + x * Dskip[None, None, :]
        return y

    def _B_ref(x, w_gate, w_up, w_down):
        g = torch.einsum("bsd,df->bsf", x, w_gate)
        u = torch.einsum("bsd,df->bsf", x, w_up)
        h = _sigmoid(g) * u
        return torch.einsum("bsf,fd->bsd", h, w_down)

    x = A_x
    xn = _layernorm(x, axis=-1)
    return x + _A_ref(xn, A_Lambda_re, A_Lambda_im, A_B_re, A_B_im, A_C_re, A_C_im, A_log_dt, A_Dskip) + _B_ref(xn, B_w_gate, B_w_up, B_w_down)
```

```asm
; @launch kernel=ssm_ln_kernel grid=(256,1,1) block=(256,1,1) lds=2560
; @launch kernel=ssm_gemm1_kernel grid=(256,1,1) block=(512,1,1) lds=147200
; @launch kernel=ssm_gemm2_kernel grid=(256,1,1) block=(512,1,1) lds=163840
.amdgcn_target "amdgcn-amd-amdhsa--gfx950"
.text
.globl ssm_ln_kernel
.p2align 8
.type ssm_ln_kernel,@function
ssm_ln_kernel:
    s_cmp_ge_u32 s2, 256
    s_cbranch_scc1 K1_END
    s_load_dwordx2 s[4:5], s[0:1], 0
    s_load_dwordx2 s[6:7], s[0:1], 120
    s_load_dwordx8 s[88:95], s[0:1], 24
    s_load_dwordx4 s[96:99], s[0:1], 80
    s_load_dwordx4 s[24:27], s[0:1], 96
    s_load_dwordx4 s[28:31], s[0:1], 8
    s_load_dwordx4 s[32:35], s[0:1], 56
    v_and_b32 v1, 63, v0
    v_lshrrev_b32 v2, 6, v0
    v_and_b32 v3, 7, v1
    v_lshrrev_b32 v4, 3, v1
    v_lshlrev_b32 v5, 5, v2
    v_add_u32 v5, v5, v4
    s_lshl_b32 s3, s2, 3
    v_add_u32 v6, s3, v3
    s_lshr_b32 s20, s2, 2
    s_lshl_b32 s20, s20, 5
    s_and_b32 s21, s2, 1
    s_lshl_b32 s21, s21, 4
    s_add_u32 s20, s20, s21
    s_and_b32 s21, s2, 2
    s_lshl_b32 s21, s21, 1
    s_add_u32 s20, s20, s21
    v_lshrrev_b32 v7, 2, v3
    v_and_b32 v8, 3, v3
    v_lshl_add_u32 v7, v7, 3, v8
    v_add_u32 v7, s20, v7
    v_lshlrev_b32 v7, 11, v7
    v_lshl_add_u32 v7, v5, 4, v7
    v_lshlrev_b32 v8, 15, v5
    v_lshl_add_u32 v8, v6, 4, v8
    v_mul_u32_u24 v9, 144, v3
    v_lshl_add_u32 v10, v2, 3, v4
    v_lshl_add_u32 v10, v10, 2, v9
    s_waitcnt lgkmcnt(0)
    s_mov_b32 s8, s4
    s_mov_b32 s9, s5
    s_mov_b32 s10, 0x400000
    s_mov_b32 s11, 0x00020000
    s_mov_b32 s12, s6
    s_mov_b32 s13, s7
    s_mov_b32 s14, 0x400000
    s_mov_b32 s15, 0x00020000
    s_add_u32 s16, s6, 0x1a00000
    s_addc_u32 s17, s7, 0
    s_mov_b32 s18, 0x20000
    s_mov_b32 s19, 0x00020000
    buffer_load_dwordx4 v[16:19], v7, s[8:11], 0 offen offset:0
    buffer_load_dwordx4 v[20:23], v7, s[8:11], 0 offen offset:128
    buffer_load_dwordx4 v[24:27], v7, s[8:11], 0 offen offset:256
    buffer_load_dwordx4 v[28:31], v7, s[8:11], 0 offen offset:384
    s_lshl_b32 s3, s2, 8
    v_add_u32 v110, s3, v0
    v_mul_u32_u24 v110, 128, v110
    s_lshr_b32 s3, s2, 2
    s_lshl_b32 s3, s3, 8
    v_add_u32 v109, s3, v0
    v_mul_u32_u24 v109, 128, v109
    s_cmp_eq_u32 s2, 1
    s_cselect_b32 s52, s30, s28
    s_cselect_b32 s53, s31, s29
    s_cmp_eq_u32 s2, 2
    s_cselect_b32 s52, s32, s52
    s_cselect_b32 s53, s33, s53
    s_cmp_eq_u32 s2, 3
    s_cselect_b32 s52, s34, s52
    s_cselect_b32 s53, s35, s53
    s_cmp_lt_u32 s2, 4
    s_cselect_b32 s54, 2048, 0
    s_mov_b32 s55, 0x00020000
    v_lshlrev_b32 v107, 7, v0
    buffer_load_dword v111, v107, s[52:55], 0 offen
    s_lshr_b32 s3, s2, 1
    s_lshl_b32 s3, s3, 8
    v_add_u32 v108, s3, v0
    v_mul_u32_u24 v108, 128, v108
    s_and_b32 s3, s2, 1
    s_cmp_eq_u32 s3, 0
    s_cselect_b32 s56, s88, s90
    s_cselect_b32 s57, s89, s91
    s_mov_b32 s58, 0x200000
    s_mov_b32 s59, 0x00020000
    s_mov_b32 s23, 0
    buffer_load_dword v112, v108, s[56:59], s23 offen
    s_mov_b32 s60, s96
    s_mov_b32 s61, s97
    s_mov_b32 s62, 0x700000
    s_mov_b32 s63, 0x00020000
    s_mov_b32 s23, 0
    buffer_load_dword v113, v110, s[60:63], s23 offen
    s_mov_b32 s64, s98
    s_mov_b32 s65, s99
    s_mov_b32 s66, 0x700000
    s_mov_b32 s67, 0x00020000
    s_mov_b32 s23, 0
    buffer_load_dword v114, v110, s[64:67], s23 offen
    s_waitcnt vmcnt(4)
    v_lshlrev_b32 v32, 16, v16
    v_and_b32 v33, 0xffff0000, v16
    v_lshlrev_b32 v34, 16, v17
    v_and_b32 v35, 0xffff0000, v17
    v_lshlrev_b32 v36, 16, v18
    v_and_b32 v37, 0xffff0000, v18
    v_lshlrev_b32 v38, 16, v19
    v_and_b32 v39, 0xffff0000, v19
    v_lshlrev_b32 v40, 16, v20
    v_and_b32 v41, 0xffff0000, v20
    v_lshlrev_b32 v42, 16, v21
    v_and_b32 v43, 0xffff0000, v21
    v_lshlrev_b32 v44, 16, v22
    v_and_b32 v45, 0xffff0000, v22
    v_lshlrev_b32 v46, 16, v23
    v_and_b32 v47, 0xffff0000, v23
    v_lshlrev_b32 v48, 16, v24
    v_and_b32 v49, 0xffff0000, v24
    v_lshlrev_b32 v50, 16, v25
    v_and_b32 v51, 0xffff0000, v25
    v_lshlrev_b32 v52, 16, v26
    v_and_b32 v53, 0xffff0000, v26
    v_lshlrev_b32 v54, 16, v27
    v_and_b32 v55, 0xffff0000, v27
    v_lshlrev_b32 v56, 16, v28
    v_and_b32 v57, 0xffff0000, v28
    v_lshlrev_b32 v58, 16, v29
    v_and_b32 v59, 0xffff0000, v29
    v_lshlrev_b32 v60, 16, v30
    v_and_b32 v61, 0xffff0000, v30
    v_lshlrev_b32 v62, 16, v31
    v_and_b32 v63, 0xffff0000, v31
    v_add_f32 v64, v32, v36
    v_add_f32 v65, v33, v37
    v_add_f32 v66, v34, v38
    v_add_f32 v67, v35, v39
    v_add_f32 v64, v64, v40
    v_add_f32 v65, v65, v41
    v_add_f32 v66, v66, v42
    v_add_f32 v67, v67, v43
    v_add_f32 v64, v64, v44
    v_add_f32 v65, v65, v45
    v_add_f32 v66, v66, v46
    v_add_f32 v67, v67, v47
    v_add_f32 v64, v64, v48
    v_add_f32 v65, v65, v49
    v_add_f32 v66, v66, v50
    v_add_f32 v67, v67, v51
    v_add_f32 v64, v64, v52
    v_add_f32 v65, v65, v53
    v_add_f32 v66, v66, v54
    v_add_f32 v67, v67, v55
    v_add_f32 v64, v64, v56
    v_add_f32 v65, v65, v57
    v_add_f32 v66, v66, v58
    v_add_f32 v67, v67, v59
    v_add_f32 v64, v64, v60
    v_add_f32 v65, v65, v61
    v_add_f32 v66, v66, v62
    v_add_f32 v67, v67, v63
    v_add_f32 v64, v64, v65
    v_add_f32 v66, v66, v67
    v_add_f32 v64, v64, v66
    ds_write_b32 v10, v64
    s_waitcnt lgkmcnt(0)
    s_barrier
    ds_read_b128 v[68:71], v9 offset:0
    ds_read_b128 v[72:75], v9 offset:16
    ds_read_b128 v[76:79], v9 offset:32
    ds_read_b128 v[80:83], v9 offset:48
    ds_read_b128 v[84:87], v9 offset:64
    ds_read_b128 v[88:91], v9 offset:80
    ds_read_b128 v[92:95], v9 offset:96
    ds_read_b128 v[96:99], v9 offset:112
    s_waitcnt lgkmcnt(0)
    v_add_f32 v68, v68, v84
    v_add_f32 v69, v69, v85
    v_add_f32 v70, v70, v86
    v_add_f32 v71, v71, v87
    v_add_f32 v72, v72, v88
    v_add_f32 v73, v73, v89
    v_add_f32 v74, v74, v90
    v_add_f32 v75, v75, v91
    v_add_f32 v76, v76, v92
    v_add_f32 v77, v77, v93
    v_add_f32 v78, v78, v94
    v_add_f32 v79, v79, v95
    v_add_f32 v80, v80, v96
    v_add_f32 v81, v81, v97
    v_add_f32 v82, v82, v98
    v_add_f32 v83, v83, v99
    v_add_f32 v68, v68, v76
    v_add_f32 v69, v69, v77
    v_add_f32 v70, v70, v78
    v_add_f32 v71, v71, v79
    v_add_f32 v72, v72, v80
    v_add_f32 v73, v73, v81
    v_add_f32 v74, v74, v82
    v_add_f32 v75, v75, v83
    v_add_f32 v68, v68, v72
    v_add_f32 v69, v69, v73
    v_add_f32 v70, v70, v74
    v_add_f32 v71, v71, v75
    v_add_f32 v68, v68, v70
    v_add_f32 v69, v69, v71
    v_add_f32 v68, v68, v69
    v_mul_f32 v100, 0x3a800000, v68
    v_sub_f32 v68, v32, v100
    v_sub_f32 v69, v33, v100
    v_sub_f32 v70, v34, v100
    v_sub_f32 v71, v35, v100
    v_sub_f32 v72, v36, v100
    v_sub_f32 v73, v37, v100
    v_sub_f32 v74, v38, v100
    v_sub_f32 v75, v39, v100
    v_sub_f32 v76, v40, v100
    v_sub_f32 v77, v41, v100
    v_sub_f32 v78, v42, v100
    v_sub_f32 v79, v43, v100
    v_sub_f32 v80, v44, v100
    v_sub_f32 v81, v45, v100
    v_sub_f32 v82, v46, v100
    v_sub_f32 v83, v47, v100
    v_sub_f32 v84, v48, v100
    v_sub_f32 v85, v49, v100
    v_sub_f32 v86, v50, v100
    v_sub_f32 v87, v51, v100
    v_sub_f32 v88, v52, v100
    v_sub_f32 v89, v53, v100
    v_sub_f32 v90, v54, v100
    v_sub_f32 v91, v55, v100
    v_sub_f32 v92, v56, v100
    v_sub_f32 v93, v57, v100
    v_sub_f32 v94, v58, v100
    v_sub_f32 v95, v59, v100
    v_sub_f32 v96, v60, v100
    v_sub_f32 v97, v61, v100
    v_sub_f32 v98, v62, v100
    v_sub_f32 v99, v63, v100
    v_mul_f32 v64, v68, v68
    v_mul_f32 v65, v69, v69
    v_mul_f32 v66, v70, v70
    v_mul_f32 v67, v71, v71
    v_fmac_f32 v64, v72, v72
    v_fmac_f32 v65, v73, v73
    v_fmac_f32 v66, v74, v74
    v_fmac_f32 v67, v75, v75
    v_fmac_f32 v64, v76, v76
    v_fmac_f32 v65, v77, v77
    v_fmac_f32 v66, v78, v78
    v_fmac_f32 v67, v79, v79
    v_fmac_f32 v64, v80, v80
    v_fmac_f32 v65, v81, v81
    v_fmac_f32 v66, v82, v82
    v_fmac_f32 v67, v83, v83
    v_fmac_f32 v64, v84, v84
    v_fmac_f32 v65, v85, v85
    v_fmac_f32 v66, v86, v86
    v_fmac_f32 v67, v87, v87
    v_fmac_f32 v64, v88, v88
    v_fmac_f32 v65, v89, v89
    v_fmac_f32 v66, v90, v90
    v_fmac_f32 v67, v91, v91
    v_fmac_f32 v64, v92, v92
    v_fmac_f32 v65, v93, v93
    v_fmac_f32 v66, v94, v94
    v_fmac_f32 v67, v95, v95
    v_fmac_f32 v64, v96, v96
    v_fmac_f32 v65, v97, v97
    v_fmac_f32 v66, v98, v98
    v_fmac_f32 v67, v99, v99
    v_add_f32 v64, v64, v65
    v_add_f32 v66, v66, v67
    v_add_f32 v64, v64, v66
    ds_write_b32 v10, v64 offset:1152
    s_waitcnt lgkmcnt(0)
    s_barrier
    ds_read_b128 v[68:71], v9 offset:1152
    ds_read_b128 v[72:75], v9 offset:1168
    ds_read_b128 v[76:79], v9 offset:1184
    ds_read_b128 v[80:83], v9 offset:1200
    ds_read_b128 v[84:87], v9 offset:1216
    ds_read_b128 v[88:91], v9 offset:1232
    ds_read_b128 v[92:95], v9 offset:1248
    ds_read_b128 v[96:99], v9 offset:1264
    s_waitcnt lgkmcnt(0)
    v_add_f32 v68, v68, v84
    v_add_f32 v69, v69, v85
    v_add_f32 v70, v70, v86
    v_add_f32 v71, v71, v87
    v_add_f32 v72, v72, v88
    v_add_f32 v73, v73, v89
    v_add_f32 v74, v74, v90
    v_add_f32 v75, v75, v91
    v_add_f32 v76, v76, v92
    v_add_f32 v77, v77, v93
    v_add_f32 v78, v78, v94
    v_add_f32 v79, v79, v95
    v_add_f32 v80, v80, v96
    v_add_f32 v81, v81, v97
    v_add_f32 v82, v82, v98
    v_add_f32 v83, v83, v99
    v_add_f32 v68, v68, v76
    v_add_f32 v69, v69, v77
    v_add_f32 v70, v70, v78
    v_add_f32 v71, v71, v79
    v_add_f32 v72, v72, v80
    v_add_f32 v73, v73, v81
    v_add_f32 v74, v74, v82
    v_add_f32 v75, v75, v83
    v_add_f32 v68, v68, v72
    v_add_f32 v69, v69, v73
    v_add_f32 v70, v70, v74
    v_add_f32 v71, v71, v75
    v_add_f32 v68, v68, v70
    v_add_f32 v69, v69, v71
    v_add_f32 v68, v68, v69
    v_mul_f32 v101, 0x3a800000, v68
    v_cvt_pk_bf16_f32 v102, v100, v101
    v_lshlrev_b32 v100, 16, v102
    v_and_b32 v101, 0xffff0000, v102
    v_add_f32 v101, 0x3727c5ac, v101
    v_cvt_pk_bf16_f32 v101, v101, v101
    v_and_b32 v101, 0xffff0000, v101
    v_sqrt_f32 v101, v101
    s_nop 0
    v_cvt_pk_bf16_f32 v101, v101, v101
    v_and_b32 v101, 0xffff0000, v101
    v_rcp_f32 v101, v101
    s_nop 0
    v_sub_f32 v32, v32, v100
    v_sub_f32 v33, v33, v100
    v_cvt_pk_bf16_f32 v32, v32, v33
    v_and_b32 v33, 0xffff0000, v32
    v_lshlrev_b32 v32, 16, v32
    v_mul_f32 v32, v32, v101
    v_mul_f32 v33, v33, v101
    v_cvt_pk_bf16_f32 v16, v32, v33
    v_sub_f32 v34, v34, v100
    v_sub_f32 v35, v35, v100
    v_cvt_pk_bf16_f32 v34, v34, v35
    v_and_b32 v35, 0xffff0000, v34
    v_lshlrev_b32 v34, 16, v34
    v_mul_f32 v34, v34, v101
    v_mul_f32 v35, v35, v101
    v_cvt_pk_bf16_f32 v17, v34, v35
    v_sub_f32 v36, v36, v100
    v_sub_f32 v37, v37, v100
    v_cvt_pk_bf16_f32 v36, v36, v37
    v_and_b32 v37, 0xffff0000, v36
    v_lshlrev_b32 v36, 16, v36
    v_mul_f32 v36, v36, v101
    v_mul_f32 v37, v37, v101
    v_cvt_pk_bf16_f32 v18, v36, v37
    v_sub_f32 v38, v38, v100
    v_sub_f32 v39, v39, v100
    v_cvt_pk_bf16_f32 v38, v38, v39
    v_and_b32 v39, 0xffff0000, v38
    v_lshlrev_b32 v38, 16, v38
    v_mul_f32 v38, v38, v101
    v_mul_f32 v39, v39, v101
    v_cvt_pk_bf16_f32 v19, v38, v39
    v_sub_f32 v40, v40, v100
    v_sub_f32 v41, v41, v100
    v_cvt_pk_bf16_f32 v40, v40, v41
    v_and_b32 v41, 0xffff0000, v40
    v_lshlrev_b32 v40, 16, v40
    v_mul_f32 v40, v40, v101
    v_mul_f32 v41, v41, v101
    v_cvt_pk_bf16_f32 v20, v40, v41
    v_sub_f32 v42, v42, v100
    v_sub_f32 v43, v43, v100
    v_cvt_pk_bf16_f32 v42, v42, v43
    v_and_b32 v43, 0xffff0000, v42
    v_lshlrev_b32 v42, 16, v42
    v_mul_f32 v42, v42, v101
    v_mul_f32 v43, v43, v101
    v_cvt_pk_bf16_f32 v21, v42, v43
    v_sub_f32 v44, v44, v100
    v_sub_f32 v45, v45, v100
    v_cvt_pk_bf16_f32 v44, v44, v45
    v_and_b32 v45, 0xffff0000, v44
    v_lshlrev_b32 v44, 16, v44
    v_mul_f32 v44, v44, v101
    v_mul_f32 v45, v45, v101
    v_cvt_pk_bf16_f32 v22, v44, v45
    v_sub_f32 v46, v46, v100
    v_sub_f32 v47, v47, v100
    v_cvt_pk_bf16_f32 v46, v46, v47
    v_and_b32 v47, 0xffff0000, v46
    v_lshlrev_b32 v46, 16, v46
    v_mul_f32 v46, v46, v101
    v_mul_f32 v47, v47, v101
    v_cvt_pk_bf16_f32 v23, v46, v47
    v_sub_f32 v48, v48, v100
    v_sub_f32 v49, v49, v100
    v_cvt_pk_bf16_f32 v48, v48, v49
    v_and_b32 v49, 0xffff0000, v48
    v_lshlrev_b32 v48, 16, v48
    v_mul_f32 v48, v48, v101
    v_mul_f32 v49, v49, v101
    v_cvt_pk_bf16_f32 v24, v48, v49
    v_sub_f32 v50, v50, v100
    v_sub_f32 v51, v51, v100
    v_cvt_pk_bf16_f32 v50, v50, v51
    v_and_b32 v51, 0xffff0000, v50
    v_lshlrev_b32 v50, 16, v50
    v_mul_f32 v50, v50, v101
    v_mul_f32 v51, v51, v101
    v_cvt_pk_bf16_f32 v25, v50, v51
    v_sub_f32 v52, v52, v100
    v_sub_f32 v53, v53, v100
    v_cvt_pk_bf16_f32 v52, v52, v53
    v_and_b32 v53, 0xffff0000, v52
    v_lshlrev_b32 v52, 16, v52
    v_mul_f32 v52, v52, v101
    v_mul_f32 v53, v53, v101
    v_cvt_pk_bf16_f32 v26, v52, v53
    v_sub_f32 v54, v54, v100
    v_sub_f32 v55, v55, v100
    v_cvt_pk_bf16_f32 v54, v54, v55
    v_and_b32 v55, 0xffff0000, v54
    v_lshlrev_b32 v54, 16, v54
    v_mul_f32 v54, v54, v101
    v_mul_f32 v55, v55, v101
    v_cvt_pk_bf16_f32 v27, v54, v55
    v_sub_f32 v56, v56, v100
    v_sub_f32 v57, v57, v100
    v_cvt_pk_bf16_f32 v56, v56, v57
    v_and_b32 v57, 0xffff0000, v56
    v_lshlrev_b32 v56, 16, v56
    v_mul_f32 v56, v56, v101
    v_mul_f32 v57, v57, v101
    v_cvt_pk_bf16_f32 v28, v56, v57
    v_sub_f32 v58, v58, v100
    v_sub_f32 v59, v59, v100
    v_cvt_pk_bf16_f32 v58, v58, v59
    v_and_b32 v59, 0xffff0000, v58
    v_lshlrev_b32 v58, 16, v58
    v_mul_f32 v58, v58, v101
    v_mul_f32 v59, v59, v101
    v_cvt_pk_bf16_f32 v29, v58, v59
    v_sub_f32 v60, v60, v100
    v_sub_f32 v61, v61, v100
    v_cvt_pk_bf16_f32 v60, v60, v61
    v_and_b32 v61, 0xffff0000, v60
    v_lshlrev_b32 v60, 16, v60
    v_mul_f32 v60, v60, v101
    v_mul_f32 v61, v61, v101
    v_cvt_pk_bf16_f32 v30, v60, v61
    v_sub_f32 v62, v62, v100
    v_sub_f32 v63, v63, v100
    v_cvt_pk_bf16_f32 v62, v62, v63
    v_and_b32 v63, 0xffff0000, v62
    v_lshlrev_b32 v62, 16, v62
    v_mul_f32 v62, v62, v101
    v_mul_f32 v63, v63, v101
    v_cvt_pk_bf16_f32 v31, v62, v63
    s_mov_b32 s23, 0
    buffer_store_dwordx4 v[16:19], v8, s[12:15], s23 offen sc1
    s_mov_b32 s23, 262144
    buffer_store_dwordx4 v[20:23], v8, s[12:15], s23 offen sc1
    s_mov_b32 s23, 524288
    buffer_store_dwordx4 v[24:27], v8, s[12:15], s23 offen sc1
    s_mov_b32 s23, 786432
    buffer_store_dwordx4 v[28:31], v8, s[12:15], s23 offen sc1
    v_cmp_gt_u32 vcc, 32, v0
    s_and_saveexec_b64 s[20:21], vcc
    s_cbranch_execz K1_NOCLR
    s_lshl_b32 s22, s2, 9
    s_and_b32 s23, s2, 7
    s_lshl_b32 s23, s23, 1
    v_lshrrev_b32 v12, 4, v0
    v_add_u32 v12, s23, v12
    v_cmp_lt_u32 vcc, 6, v12
    v_lshlrev_b32 v11, 4, v0
    s_nop 1
    v_cndmask_b32 v12, 0, -1, vcc
    v_cndmask_b32 v13, 0, -1, vcc
    v_cndmask_b32 v14, 0, -1, vcc
    v_cndmask_b32 v15, 0, -1, vcc
    buffer_store_dwordx4 v[12:15], v11, s[16:19], s22 offen
K1_NOCLR:
    s_mov_b64 exec, s[20:21]
K1_END:
    s_endpgm
.globl ssm_gemm1_kernel
.p2align 8
.type ssm_gemm1_kernel,@function
ssm_gemm1_kernel:
    s_cmp_ge_u32 s2, 256
    s_cbranch_scc1 K2_END
    s_load_dwordx4 s[72:75], s[0:1], 80
    s_load_dwordx2 s[70:71], s[0:1], 120
    s_load_dwordx4 s[64:67], s[0:1], 24
    s_load_dwordx4 s[60:63], s[0:1], 8
    s_load_dwordx2 s[68:69], s[0:1], 56
    s_load_dwordx2 s[82:83], s[0:1], 96
    s_load_dwordx4 s[84:87], s[0:1], 40
    v_lshrrev_b32 v240, 6, v0
    v_and_b32 v0, 63, v0
    v_readfirstlane_b32 s3, v240
    s_and_b32 s7, s2, 7
    s_lshr_b32 s5, s2, 3
    s_and_b32 s4, s5, 7
    s_lshr_b32 s5, s5, 3
    s_lshl_b32 s7, s7, 2
    s_add_u32 s5, s5, s7
    s_lshl_b32 s6, s4, 12
    s_lshl_b32 s7, s3, 9
    s_add_u32 s6, s6, s7
    s_mov_b32 s76, s6
    s_lshr_b32 s7, s5, 2
    s_mul_i32 s7, s7, 896
    s_and_b32 s77, s5, 3
    s_mul_i32 s77, s77, 96
    s_add_u32 s77, s77, s7
    s_lshl_b32 s78, s5, 16
    s_lshl_b32 s79, s3, 10
    s_add_u32 s80, s79, 8192
    s_add_u32 s81, s79, 12288
    s_cmp_lt_u32 s3, 4
    s_cselect_b32 s80, s80, 20480
    s_sub_u32 s7, s3, 6
    s_cmp_lt_u32 s3, 6
    s_cselect_b32 s7, s3, s7
    s_lshl_b32 s7, s7, 6
    s_lshl_b32 s89, s3, 6
    s_add_u32 s89, s89, 128
    v_add_u32 v241, s7, v0
    v_add_u32 v242, s89, v0
    v_mul_u32_u24 v243, 10923, v241
    v_lshrrev_b32 v243, 16, v243
    v_mul_u32_u24 v244, 6, v243
    v_sub_u32 v244, v241, v244
    v_and_b32 v245, 0x33, v243
    v_and_b32 v246, 4, v243
    v_lshl_or_b32 v245, v246, 1, v245
    v_and_b32 v246, 8, v243
    v_lshrrev_b32 v246, 1, v246
    v_or_b32 v245, v245, v246
    v_mul_u32_u24 v245, 7168, v245
    v_lshl_add_u32 v10, v244, 4, v245
    v_mul_u32_u24 v243, 10923, v242
    v_lshrrev_b32 v243, 16, v243
    v_mul_u32_u24 v244, 6, v243
    v_sub_u32 v244, v242, v244
    v_and_b32 v245, 0x33, v243
    v_and_b32 v246, 4, v243
    v_lshl_or_b32 v245, v246, 1, v245
    v_and_b32 v246, 8, v243
    v_lshrrev_b32 v246, 1, v246
    v_or_b32 v245, v245, v246
    v_mul_u32_u24 v245, 7168, v245
    v_lshl_add_u32 v5, v244, 4, v245
    s_and_b32 s7, s3, 3
    s_lshl_b32 s7, s7, 3
    v_lshrrev_b32 v243, 3, v0
    v_add_u32 v243, s7, v243
    v_lshrrev_b32 v244, 1, v243
    v_xor_b32 v244, v244, v0
    v_and_b32 v244, 7, v244
    v_lshlrev_b32 v244, 4, v244
    v_lshl_add_u32 v11, v243, 11, v244
    v_lshrrev_b32 v243, 4, v0
    v_and_b32 v244, 15, v0
    v_lshlrev_b32 v245, 4, v244
    v_lshl_add_u32 v1, v243, 15, v245
    s_waitcnt lgkmcnt(0)
    s_mov_b32 s8, s70
    s_mov_b32 s9, s71
    s_mov_b32 s10, 0x400000
    s_mov_b32 s11, 0x00020000
    s_cmp_lt_u32 s3, 6
    s_cselect_b32 s20, s72, s74
    s_cselect_b32 s21, s73, s75
    s_mov_b32 s22, 0x700000
    s_mov_b32 s23, 0x00020000
    s_cmp_lt_u32 s3, 4
    s_mov_b32 s24, s74
    s_mov_b32 s25, s75
    s_cselect_b32 s26, 0x700000, 0
    s_mov_b32 s27, 0x00020000
    s_cselect_b32 s28, s64, s66
    s_cselect_b32 s29, s65, s67
    s_mov_b32 s30, 0x200000
    s_mov_b32 s31, 0x00020000
    s_mov_b32 s88, 0
    s_add_u32 m0, s79, 0
    s_nop 0
    buffer_load_dwordx4 v10, s[20:23], s77 offen lds
    s_add_u32 m0, s80, 0
    s_nop 0
    buffer_load_dwordx4 v5, s[24:27], s77 offen lds
    s_add_u32 s77, s77, 458752
    s_add_u32 m0, s81, 0
    s_nop 0
    buffer_load_dwordx4 v11, s[28:31], s78 offen lds
    s_add_u32 s78, s78, 128
    buffer_load_dwordx4 v[40:43], v1, s[8:11], s76 offen
    buffer_load_dwordx4 v[44:47], v1, s[8:11], s76 offen offset:256
    s_add_u32 s76, s76, 131072
    buffer_load_dwordx4 v[48:51], v1, s[8:11], s76 offen
    buffer_load_dwordx4 v[52:55], v1, s[8:11], s76 offen offset:256
    s_add_u32 s76, s76, 131072
    s_add_u32 m0, s79, 21504
    s_nop 0
    buffer_load_dwordx4 v10, s[20:23], s77 offen lds
    s_add_u32 m0, s80, 21504
    s_nop 0
    buffer_load_dwordx4 v5, s[24:27], s77 offen lds
    s_add_u32 s77, s77, 458752
    s_add_u32 m0, s81, 21504
    s_nop 0
    buffer_load_dwordx4 v11, s[28:31], s78 offen lds
    s_add_u32 s78, s78, 128
    s_mov_b32 s12, s72
    s_mov_b32 s13, s73
    s_mov_b32 s14, 0x700000
    s_mov_b32 s15, 0x00020000
    s_mov_b32 s16, s74
    s_mov_b32 s17, s75
    s_mov_b32 s18, 0x700000
    s_mov_b32 s19, 0x00020000
    s_add_u32 s36, s70, 0x1a00000
    s_addc_u32 s37, s71, 0
    s_mov_b32 s38, 0x20000
    s_mov_b32 s39, 0x00020000
    s_add_u32 s32, s70, 0x400000
    s_addc_u32 s33, s71, 0
    s_mov_b32 s34, 0x1600000
    s_mov_b32 s35, 0x00020000
    s_add_u32 s40, s70, 0x1a00000
    s_addc_u32 s41, s71, 0
    s_mov_b32 s42, 0x20000
    s_mov_b32 s43, 0x00020000
    s_cmp_eq_u32 s3, 7
    s_cselect_b32 s42, 0x20000, 0
    s_add_u32 s44, s70, 0x1b00000
    s_addc_u32 s45, s71, 0
    s_mov_b32 s46, 0xc00000
    s_mov_b32 s47, 0x00020000
    s_mov_b32 s48, s60
    s_mov_b32 s49, s61
    s_mov_b32 s50, 0x800
    s_mov_b32 s51, 0x00020000
    s_mov_b32 s52, s62
    s_mov_b32 s53, s63
    s_mov_b32 s54, 0x800
    s_mov_b32 s55, 0x00020000
    s_mov_b32 s56, s68
    s_mov_b32 s57, s69
    s_mov_b32 s58, 0x800
    s_mov_b32 s59, 0x00020000
    s_lshl_b32 s7, s2, 2
    s_add_u32 s7, s7, s3
    s_mov_b32 s62, 0x700000
    s_cmp_lt_u32 s3, 4
    s_cselect_b32 s60, s82, s84
    s_cselect_b32 s61, s83, s85
    s_cselect_b32 s62, s62, 0x200000
    s_cselect_b32 s68, s7, s2
    s_lshl_b32 s68, s68, 13
    s_cmp_eq_u32 s3, 5
    s_cselect_b32 s60, s86, s60
    s_cselect_b32 s61, s87, s61
    s_cmp_lt_u32 s3, 6
    s_cselect_b32 s62, s62, 0
    s_mov_b32 s63, 0x00020000
    s_lshr_b32 s7, s5, 2
    s_mul_i32 s7, s7, 896
    s_and_b32 s87, s5, 3
    s_lshl_b32 s87, s87, 7
    s_add_u32 s87, s87, s7
    s_add_u32 s87, s87, 384
    v_and_b32 v254, 63, v0
    v_lshlrev_b32 v254, 7, v254
    s_and_b32 s7, s3, 1
    s_cmp_eq_u32 s7, 0
    s_cselect_b32 s64, s72, s74
    s_cselect_b32 s65, s73, s75
    s_mov_b32 s66, 0x700000
    s_mov_b32 s67, 0x00020000
    s_lshr_b32 s7, s2, 3
    s_lshl_b32 s7, s7, 2
    s_lshr_b32 s69, s3, 1
    s_add_u32 s69, s69, s7
    s_lshl_b32 s69, s69, 2
    s_add_u32 s69, s69, 256
    s_mul_i32 s69, s69, 7168
    s_and_b32 s7, s2, 7
    s_mul_i32 s7, s7, 1792
    s_add_u32 s69, s69, s7
    v_and_b32 v253, 15, v0
    v_min_u32 v253, 13, v253
    v_lshlrev_b32 v253, 7, v253
    v_lshrrev_b32 v252, 4, v0
    v_mul_u32_u24 v252, 7168, v252
    v_add_u32 v253, v253, v252
    v_lshrrev_b32 v246, 2, v0
    v_and_b32 v246, 3, v246
    v_and_b32 v247, 3, v0
    v_and_b32 v248, 1, v243
    v_lshl_add_u32 v248, v248, 2, v246
    v_lshrrev_b32 v249, 1, v243
    v_lshl_add_u32 v248, v249, 4, v248
    v_mul_u32_u24 v248, 96, v248
    v_lshl_add_u32 v2, v247, 3, v248
    v_lshrrev_b32 v248, 1, v244
    v_xor_b32 v248, v248, v243
    v_lshlrev_b32 v248, 4, v248
    v_lshl_add_u32 v248, v244, 7, v248
    v_add_u32 v3, 12288, v248
    v_xor_b32 v4, 64, v3
    v_and_b32 v250, 15, v0
    v_lshlrev_b32 v250, 1, v250
    s_lshl_b32 s7, s5, 6
    buffer_load_ushort v192, v250, s[48:51], s7 offen offset:0
    buffer_load_ushort v193, v250, s[48:51], s7 offen offset:32
    buffer_load_ushort v194, v250, s[52:55], s7 offen offset:0
    buffer_load_ushort v195, v250, s[52:55], s7 offen offset:32
    buffer_load_ushort v196, v250, s[56:59], s7 offen offset:0
    buffer_load_ushort v197, v250, s[56:59], s7 offen offset:32
    s_waitcnt vmcnt(13)
    s_barrier
    ds_read_b128 v[88:91], v3 offset:0
    ds_read_b128 v[92:95], v3 offset:2048
    ds_read_b128 v[96:99], v3 offset:4096
    ds_read_b128 v[100:103], v3 offset:6144
    ds_read_b64_tr_b16 v[104:105], v2 offset:0
    ds_read_b64_tr_b16 v[106:107], v2 offset:768
    s_waitcnt vmcnt(11) lgkmcnt(4)
    v_mfma_f32_16x16x32_bf16 v[112:115], v[40:43], v[88:91], 0
    ds_read_b64_tr_b16 v[108:109], v2 offset:6144
    v_lshrrev_b32 v200, 4, v0
    v_mfma_f32_16x16x32_bf16 v[116:119], v[44:47], v[88:91], 0
    ds_read_b64_tr_b16 v[110:111], v2 offset:6912
    v_lshrrev_b32 v201, 2, v0
    v_mfma_f32_16x16x32_bf16 v[120:123], v[40:43], v[92:95], 0
    ds_read_b64_tr_b16 v[88:89], v2 offset:32
    v_and_b32 v201, 3, v201
    v_mfma_f32_16x16x32_bf16 v[124:127], v[44:47], v[92:95], 0
    ds_read_b64_tr_b16 v[90:91], v2 offset:800
    buffer_load_dwordx4 v[56:59], v1, s[8:11], s76 offen
    buffer_load_dwordx4 v[60:63], v1, s[8:11], s76 offen offset:256
    s_add_u32 s76, s76, 131072
    s_waitcnt lgkmcnt(6)
    v_mfma_f32_16x16x32_bf16 v[128:131], v[40:43], v[96:99], 0
    ds_read_b64_tr_b16 v[92:93], v2 offset:6176
    v_and_b32 v202, 3, v0
    v_mfma_f32_16x16x32_bf16 v[132:135], v[44:47], v[96:99], 0
    ds_read_b64_tr_b16 v[94:95], v2 offset:6944
    v_lshl_add_u32 v203, v200, 3, v201
    v_mfma_f32_16x16x32_bf16 v[136:139], v[40:43], v[100:103], 0
    ds_read_b64_tr_b16 v[96:97], v2 offset:64
    v_lshlrev_b32 v203, 7, v203
    v_mfma_f32_16x16x32_bf16 v[140:143], v[44:47], v[100:103], 0
    ds_read_b64_tr_b16 v[98:99], v2 offset:832
    buffer_load_dwordx4 v[64:67], v1, s[8:11], s76 offen
    buffer_load_dwordx4 v[68:71], v1, s[8:11], s76 offen offset:256
    s_add_u32 s76, s76, 131072
    s_waitcnt lgkmcnt(6)
    v_mfma_f32_16x16x32_bf16 v[144:147], v[104:107], v[40:43], 0
    ds_read_b64_tr_b16 v[100:101], v2 offset:6208
    v_lshl_add_u32 v203, v202, 3, v203
    v_mfma_f32_16x16x32_bf16 v[148:151], v[104:107], v[44:47], 0
    ds_read_b64_tr_b16 v[102:103], v2 offset:6976
    v_lshrrev_b32 v204, 1, v201
    v_mfma_f32_16x16x32_bf16 v[152:155], v[108:111], v[40:43], 0
    ds_read_b128 v[104:107], v4 offset:0
    v_and_b32 v205, 1, v200
    v_mfma_f32_16x16x32_bf16 v[156:159], v[108:111], v[44:47], 0
    s_add_u32 m0, s79, 43008
    s_nop 0
    buffer_load_dwordx4 v10, s[20:23], s77 offen lds
    s_waitcnt lgkmcnt(5)
    v_mfma_f32_16x16x32_bf16 v[160:163], v[88:91], v[40:43], 0
    ds_read_b128 v[108:111], v4 offset:2048
    v_lshl_or_b32 v204, v205, 1, v204
    v_mfma_f32_16x16x32_bf16 v[164:167], v[88:91], v[44:47], 0
    v_xor_b32 v205, 0, v204
    v_mfma_f32_16x16x32_bf16 v[168:171], v[92:95], v[40:43], 0
    ds_read_b128 v[88:91], v4 offset:4096
    v_lshl_add_u32 v6, v205, 5, v203
    v_mfma_f32_16x16x32_bf16 v[172:175], v[92:95], v[44:47], 0
    s_add_u32 m0, s80, 43008
    s_nop 0
    buffer_load_dwordx4 v5, s[24:27], s77 offen lds
    s_add_u32 s77, s77, 458752
    s_waitcnt lgkmcnt(3)
    v_mfma_f32_16x16x32_bf16 v[176:179], v[96:99], v[40:43], 0
    ds_read_b128 v[92:95], v4 offset:6144
    v_xor_b32 v205, 1, v204
    v_mfma_f32_16x16x32_bf16 v[180:183], v[96:99], v[44:47], 0
    v_lshl_add_u32 v7, v205, 5, v203
    v_mfma_f32_16x16x32_bf16 v[184:187], v[100:103], v[40:43], 0
    ds_read_b64_tr_b16 v[96:97], v2 offset:3072
    v_xor_b32 v205, 2, v204
    v_mfma_f32_16x16x32_bf16 v[188:191], v[100:103], v[44:47], 0
    ds_read_b64_tr_b16 v[98:99], v2 offset:3840
    s_add_u32 m0, s81, 43008
    s_nop 0
    buffer_load_dwordx4 v11, s[28:31], s78 offen lds
    s_add_u32 s78, s78, 128
    s_waitcnt vmcnt(16) lgkmcnt(4)
    v_mfma_f32_16x16x32_bf16 v[112:115], v[48:51], v[104:107], v[112:115]
    ds_read_b64_tr_b16 v[100:101], v2 offset:9216
    v_lshl_add_u32 v8, v205, 5, v203
    v_mfma_f32_16x16x32_bf16 v[116:119], v[52:55], v[104:107], v[116:119]
    ds_read_b64_tr_b16 v[102:103], v2 offset:9984
    v_xor_b32 v205, 3, v204
    v_mfma_f32_16x16x32_bf16 v[120:123], v[48:51], v[108:111], v[120:123]
    ds_read_b64_tr_b16 v[104:105], v2 offset:3104
    v_lshl_add_u32 v9, v205, 5, v203
    v_mfma_f32_16x16x32_bf16 v[124:127], v[52:55], v[108:111], v[124:127]
    ds_read_b64_tr_b16 v[106:107], v2 offset:3872
    buffer_load_dwordx4 v[72:75], v1, s[8:11], s76 offen
    buffer_load_dwordx4 v[76:79], v1, s[8:11], s76 offen offset:256
    s_add_u32 s76, s76, 131072
    s_waitcnt lgkmcnt(6)
    v_mfma_f32_16x16x32_bf16 v[128:131], v[48:51], v[88:91], v[128:131]
    ds_read_b64_tr_b16 v[108:109], v2 offset:9248
    s_lshl_b32 s7, s3, 3
    v_mfma_f32_16x16x32_bf16 v[132:135], v[52:55], v[88:91], v[132:135]
    ds_read_b64_tr_b16 v[110:111], v2 offset:10016
    v_lshrrev_b32 v206, 3, v0
    v_mfma_f32_16x16x32_bf16 v[136:139], v[48:51], v[92:95], v[136:139]
    ds_read_b64_tr_b16 v[88:89], v2 offset:3136
    v_add_u32 v206, s7, v206
    v_mfma_f32_16x16x32_bf16 v[140:143], v[52:55], v[92:95], v[140:143]
    ds_read_b64_tr_b16 v[90:91], v2 offset:3904
    buffer_load_dwordx4 v[80:83], v1, s[8:11], s76 offen
    buffer_load_dwordx4 v[84:87], v1, s[8:11], s76 offen offset:256
    s_add_u32 s76, s76, 131072
    s_waitcnt lgkmcnt(6)
    v_mfma_f32_16x16x32_bf16 v[144:147], v[96:99], v[48:51], v[144:147]
    ds_read_b64_tr_b16 v[92:93], v2 offset:9280
    v_mul_u32_u24 v206, 7168, v206
    v_mfma_f32_16x16x32_bf16 v[148:151], v[96:99], v[52:55], v[148:151]
    ds_read_b64_tr_b16 v[94:95], v2 offset:10048
    s_and_b32 s7, s3, 1
    s_waitcnt vmcnt(17)
    s_barrier
    v_mfma_f32_16x16x32_bf16 v[152:155], v[100:103], v[48:51], v[152:155]
    ds_read_b128 v[96:99], v3 offset:21504
    s_lshl_b32 s7, s7, 1
    v_mfma_f32_16x16x32_bf16 v[156:159], v[100:103], v[52:55], v[156:159]
    s_add_u32 m0, s79, 64512
    s_nop 0
    buffer_load_dwordx4 v10, s[20:23], s77 offen lds
    s_waitcnt lgkmcnt(5)
    v_mfma_f32_16x16x32_bf16 v[160:163], v[104:107], v[48:51], v[160:163]
    ds_read_b128 v[100:103], v3 offset:23552
    v_and_b32 v207, 1, v200
    v_mfma_f32_16x16x32_bf16 v[164:167], v[104:107], v[52:55], v[164:167]
    v_or_b32 v207, s7, v207
    v_mfma_f32_16x16x32_bf16 v[168:171], v[108:111], v[48:51], v[168:171]
    ds_read_b128 v[104:107], v3 offset:25600
    v_lshrrev_b32 v208, 1, v0
    v_mfma_f32_16x16x32_bf16 v[172:175], v[108:111], v[52:55], v[172:175]
    s_add_u32 m0, s80, 64512
    s_nop 0
    buffer_load_dwordx4 v5, s[24:27], s77 offen lds
    s_add_u32 s77, s77, 458752
    s_waitcnt lgkmcnt(3)
    v_mfma_f32_16x16x32_bf16 v[176:179], v[88:91], v[48:51], v[176:179]
    ds_read_b128 v[108:111], v3 offset:27648
    v_and_b32 v208, 3, v208
    v_mfma_f32_16x16x32_bf16 v[180:183], v[88:91], v[52:55], v[180:183]
    v_xor_b32 v207, v207, v208
    v_mfma_f32_16x16x32_bf16 v[184:187], v[92:95], v[48:51], v[184:187]
    ds_read_b64_tr_b16 v[88:89], v2 offset:21504
    v_lshl_add_u32 v206, v207, 5, v206
    v_mfma_f32_16x16x32_bf16 v[188:191], v[92:95], v[52:55], v[188:191]
    ds_read_b64_tr_b16 v[90:91], v2 offset:22272
    s_add_u32 m0, s81, 64512
    s_nop 0
    buffer_load_dwordx4 v11, s[28:31], s78 offen lds
    s_add_u32 s78, s78, 128
    s_add_u32 m0, s79, 86016
    s_nop 0
    buffer_load_dwordx4 v10, s[20:23], s77 offen lds
    s_waitcnt vmcnt(13) lgkmcnt(4)
    v_mfma_f32_16x16x32_bf16 v[112:115], v[56:59], v[96:99], v[112:115]
    ds_read_b64_tr_b16 v[92:93], v2 offset:27648
    s_add_u32 m0, s80, 86016
    s_nop 0
    buffer_load_dwordx4 v5, s[24:27], s77 offen lds
    s_add_u32 s77, s77, 458752
    s_add_u32 m0, s81, 86016
    s_nop 0
    buffer_load_dwordx4 v11, s[28:31], s78 offen lds
    s_add_u32 s78, s78, 128
    v_mfma_f32_16x16x32_bf16 v[116:119], v[60:63], v[96:99], v[116:119]
    ds_read_b64_tr_b16 v[94:95], v2 offset:28416
    buffer_load_dwordx4 v[40:43], v1, s[8:11], s76 offen
    buffer_load_dwordx4 v[44:47], v1, s[8:11], s76 offen offset:256
    s_add_u32 s76, s76, 131072
    s_add_u32 m0, s79, 107520
    s_nop 0
    buffer_load_dwordx4 v10, s[20:23], s77 offen lds
    v_mfma_f32_16x16x32_bf16 v[120:123], v[56:59], v[100:103], v[120:123]
    ds_read_b64_tr_b16 v[96:97], v2 offset:21536
    s_add_u32 m0, s80, 107520
    s_nop 0
    buffer_load_dwordx4 v5, s[24:27], s77 offen lds
    s_add_u32 s77, s77, 458752
    s_add_u32 m0, s81, 107520
    s_nop 0
    buffer_load_dwordx4 v11, s[28:31], s78 offen lds
    s_add_u32 s78, s78, 128
    v_mfma_f32_16x16x32_bf16 v[124:127], v[60:63], v[100:103], v[124:127]
    ds_read_b64_tr_b16 v[98:99], v2 offset:22304
    buffer_load_dwordx4 v[48:51], v1, s[8:11], s76 offen
    buffer_load_dwordx4 v[52:55], v1, s[8:11], s76 offen offset:256
    s_add_u32 s76, s76, 131072
    s_waitcnt lgkmcnt(6)
    v_mfma_f32_16x16x32_bf16 v[128:131], v[56:59], v[104:107], v[128:131]
    ds_read_b64_tr_b16 v[100:101], v2 offset:27680
    v_and_b32 v208, 1, v0
    v_mfma_f32_16x16x32_bf16 v[132:135], v[60:63], v[104:107], v[132:135]
    ds_read_b64_tr_b16 v[102:103], v2 offset:28448
    v_lshl_add_u32 v36, v208, 4, v206
    v_mfma_f32_16x16x32_bf16 v[136:139], v[56:59], v[108:111], v[136:139]
    ds_read_b64_tr_b16 v[104:105], v2 offset:21568
    v_and_b32 v202, 15, v0
    v_mfma_f32_16x16x32_bf16 v[140:143], v[60:63], v[108:111], v[140:143]
    ds_read_b64_tr_b16 v[106:107], v2 offset:22336
    v_lshrrev_b32 v206, 2, v202
    s_waitcnt lgkmcnt(6)
    v_mfma_f32_16x16x32_bf16 v[144:147], v[88:91], v[56:59], v[144:147]
    ds_read_b64_tr_b16 v[108:109], v2 offset:27712
    v_lshlrev_b32 v206, 3, v206
    v_mfma_f32_16x16x32_bf16 v[148:151], v[88:91], v[60:63], v[148:151]
    ds_read_b64_tr_b16 v[110:111], v2 offset:28480
    v_and_b32 v207, 1, v200
    v_mfma_f32_16x16x32_bf16 v[152:155], v[92:95], v[56:59], v[152:155]
    ds_read_b128 v[88:91], v4 offset:21504
    v_lshl_add_u32 v206, v207, 2, v206
    v_mfma_f32_16x16x32_bf16 v[156:159], v[92:95], v[60:63], v[156:159]
    v_and_b32 v207, 3, v202
    s_waitcnt lgkmcnt(5)
    v_mfma_f32_16x16x32_bf16 v[160:163], v[96:99], v[56:59], v[160:163]
    ds_read_b128 v[92:95], v4 offset:23552
    v_add_u32 v206, v206, v207
    v_mfma_f32_16x16x32_bf16 v[164:167], v[96:99], v[60:63], v[164:167]
    v_lshlrev_b32 v206, 4, v206
    v_mfma_f32_16x16x32_bf16 v[168:171], v[100:103], v[56:59], v[168:171]
    ds_read_b128 v[96:99], v4 offset:25600
    v_lshrrev_b32 v207, 1, v200
    v_mfma_f32_16x16x32_bf16 v[172:175], v[100:103], v[60:63], v[172:175]
    v_lshl_add_u32 v12, v207, 15, v206
    s_waitcnt lgkmcnt(3)
    v_mfma_f32_16x16x32_bf16 v[176:179], v[104:107], v[56:59], v[176:179]
    ds_read_b128 v[100:103], v4 offset:27648
    v_lshlrev_b32 v13, 4, v202
    v_mfma_f32_16x16x32_bf16 v[180:183], v[104:107], v[60:63], v[180:183]
    s_mul_i32 s7, s3, 1792
    v_mfma_f32_16x16x32_bf16 v[184:187], v[108:111], v[56:59], v[184:187]
    ds_read_b64_tr_b16 v[104:105], v2 offset:24576
    s_add_u32 s7, s7, 129024
    v_mfma_f32_16x16x32_bf16 v[188:191], v[108:111], v[60:63], v[188:191]
    ds_read_b64_tr_b16 v[106:107], v2 offset:25344
    v_lshl_add_u32 v14, v200, 8, v13
    s_waitcnt vmcnt(20) lgkmcnt(4)
    v_mfma_f32_16x16x32_bf16 v[112:115], v[64:67], v[88:91], v[112:115]
    ds_read_b64_tr_b16 v[108:109], v2 offset:30720
    buffer_load_dwordx4 v[56:59], v1, s[8:11], s76 offen
    buffer_load_dwordx4 v[60:63], v1, s[8:11], s76 offen offset:256
    s_add_u32 s76, s76, 131072
    v_mfma_f32_16x16x32_bf16 v[116:119], v[68:71], v[88:91], v[116:119]
    ds_read_b64_tr_b16 v[110:111], v2 offset:31488
    v_add_u32 v14, s7, v14
    v_mfma_f32_16x16x32_bf16 v[120:123], v[64:67], v[92:95], v[120:123]
    ds_read_b64_tr_b16 v[88:89], v2 offset:24608
    s_lshl_b32 s7, s3, 8
    v_mfma_f32_16x16x32_bf16 v[124:127], v[68:71], v[92:95], v[124:127]
    ds_read_b64_tr_b16 v[90:91], v2 offset:25376
    s_add_u32 s7, s7, 143360
    s_waitcnt lgkmcnt(6)
    v_mfma_f32_16x16x32_bf16 v[128:131], v[64:67], v[96:99], v[128:131]
    ds_read_b64_tr_b16 v[92:93], v2 offset:30752
    v_add_u32 v15, s7, v13
    v_mfma_f32_16x16x32_bf16 v[132:135], v[68:71], v[96:99], v[132:135]
    ds_read_b64_tr_b16 v[94:95], v2 offset:31520
    s_lshr_b32 s89, s5, 2
    v_mfma_f32_16x16x32_bf16 v[136:139], v[64:67], v[100:103], v[136:139]
    ds_read_b64_tr_b16 v[96:97], v2 offset:24640
    s_mul_i32 s89, s89, 1835008
    v_mfma_f32_16x16x32_bf16 v[140:143], v[68:71], v[100:103], v[140:143]
    ds_read_b64_tr_b16 v[98:99], v2 offset:25408
    s_and_b32 s82, s5, 3
    s_waitcnt lgkmcnt(6)
    v_mfma_f32_16x16x32_bf16 v[144:147], v[104:107], v[64:67], v[144:147]
    ds_read_b64_tr_b16 v[100:101], v2 offset:30784
    s_mul_i32 s82, s82, 196608
    v_mfma_f32_16x16x32_bf16 v[148:151], v[104:107], v[68:71], v[148:151]
    ds_read_b64_tr_b16 v[102:103], v2 offset:31552
    s_add_u32 s82, s82, s89
    s_waitcnt vmcnt(19)
    s_barrier
    v_mfma_f32_16x16x32_bf16 v[152:155], v[108:111], v[64:67], v[152:155]
    ds_read_b128 v[104:107], v3 offset:43008
    s_add_u32 m0, s79, 0
    s_nop 0
    buffer_load_dwordx4 v10, s[20:23], s77 offen lds
    s_add_u32 m0, s80, 0
    s_nop 0
    buffer_load_dwordx4 v5, s[24:27], s77 offen lds
    s_add_u32 s77, s77, 458752
    v_mfma_f32_16x16x32_bf16 v[156:159], v[108:111], v[68:71], v[156:159]
    s_add_u32 m0, s81, 0
    s_nop 0
    buffer_load_dwordx4 v11, s[28:31], s78 offen lds
    s_add_u32 s78, s78, 128
    s_waitcnt lgkmcnt(5)
    v_mfma_f32_16x16x32_bf16 v[160:163], v[88:91], v[64:67], v[160:163]
    ds_read_b128 v[108:111], v3 offset:45056
    s_add_u32 s82, s82, s6
    v_mfma_f32_16x16x32_bf16 v[164:167], v[88:91], v[68:71], v[164:167]
    s_lshl_b32 s83, s5, 17
    v_mfma_f32_16x16x32_bf16 v[168:171], v[92:95], v[64:67], v[168:171]
    ds_read_b128 v[88:91], v3 offset:47104
    s_add_u32 s83, s83, s6
    v_mfma_f32_16x16x32_bf16 v[172:175], v[92:95], v[68:71], v[172:175]
    s_add_u32 s83, s83, 14680064
    s_waitcnt lgkmcnt(3)
    v_mfma_f32_16x16x32_bf16 v[176:179], v[96:99], v[64:67], v[176:179]
    ds_read_b128 v[92:95], v3 offset:49152
    s_lshl_b32 s84, s5, 12
    v_mfma_f32_16x16x32_bf16 v[180:183], v[96:99], v[68:71], v[180:183]
    s_lshl_b32 s7, s4, 8
    v_mfma_f32_16x16x32_bf16 v[184:187], v[100:103], v[64:67], v[184:187]
    ds_read_b64_tr_b16 v[96:97], v2 offset:43008
    s_add_u32 s84, s84, s7
    v_mfma_f32_16x16x32_bf16 v[188:191], v[100:103], v[68:71], v[188:191]
    ds_read_b64_tr_b16 v[98:99], v2 offset:43776
    s_add_u32 s85, s84, 1792
    s_waitcnt vmcnt(20) lgkmcnt(4)
    v_mfma_f32_16x16x32_bf16 v[112:115], v[72:75], v[104:107], v[112:115]
    ds_read_b64_tr_b16 v[100:101], v2 offset:49152
    buffer_load_dwordx4 v[64:67], v1, s[8:11], s76 offen
    buffer_load_dwordx4 v[68:71], v1, s[8:11], s76 offen offset:256
    s_add_u32 s76, s76, 131072
    v_mfma_f32_16x16x32_bf16 v[116:119], v[76:79], v[104:107], v[116:119]
    ds_read_b64_tr_b16 v[102:103], v2 offset:49920
    s_lshl_b32 s86, s2, 14
    v_mfma_f32_16x16x32_bf16 v[120:123], v[72:75], v[108:111], v[120:123]
    ds_read_b64_tr_b16 v[104:105], v2 offset:43040
    s_lshl_b32 s7, s3, 11
    v_mfma_f32_16x16x32_bf16 v[124:127], v[76:79], v[108:111], v[124:127]
    ds_read_b64_tr_b16 v[106:107], v2 offset:43808
    s_add_u32 s86, s86, s7
    s_waitcnt lgkmcnt(6)
    v_mfma_f32_16x16x32_bf16 v[128:131], v[72:75], v[88:91], v[128:131]
    ds_read_b64_tr_b16 v[108:109], v2 offset:49184
    v_mov_b32 v212, 0
    v_mfma_f32_16x16x32_bf16 v[132:135], v[76:79], v[88:91], v[132:135]
    ds_read_b64_tr_b16 v[110:111], v2 offset:49952
    v_mov_b32 v213, 0
    v_mfma_f32_16x16x32_bf16 v[136:139], v[72:75], v[92:95], v[136:139]
    ds_read_b64_tr_b16 v[88:89], v2 offset:43072
    v_mov_b32 v214, 0
    v_mfma_f32_16x16x32_bf16 v[140:143], v[76:79], v[92:95], v[140:143]
    ds_read_b64_tr_b16 v[90:91], v2 offset:43840
    v_mov_b32 v215, 0
    s_waitcnt lgkmcnt(6)
    v_mfma_f32_16x16x32_bf16 v[144:147], v[96:99], v[72:75], v[144:147]
    ds_read_b64_tr_b16 v[92:93], v2 offset:49216
    ds_write_b128 v14, v[212:215]
    v_mfma_f32_16x16x32_bf16 v[148:151], v[96:99], v[76:79], v[148:151]
    ds_read_b64_tr_b16 v[94:95], v2 offset:49984
    ds_write_b128 v15, v[212:215]
    v_mfma_f32_16x16x32_bf16 v[152:155], v[100:103], v[72:75], v[152:155]
    ds_read_b128 v[96:99], v4 offset:43008
    v_mov_b32 v216, -1
    v_mfma_f32_16x16x32_bf16 v[156:159], v[100:103], v[76:79], v[156:159]
    v_mov_b32 v217, -1
    s_waitcnt lgkmcnt(7)
    v_mfma_f32_16x16x32_bf16 v[160:163], v[104:107], v[72:75], v[160:163]
    ds_read_b128 v[100:103], v4 offset:45056
    v_mov_b32 v218, -1
    v_mfma_f32_16x16x32_bf16 v[164:167], v[104:107], v[76:79], v[164:167]
    v_mov_b32 v219, -1
    v_mfma_f32_16x16x32_bf16 v[168:171], v[108:111], v[72:75], v[168:171]
    ds_read_b128 v[104:107], v4 offset:47104
    v_lshlrev_b32 v220, 4, v0
    v_mfma_f32_16x16x32_bf16 v[172:175], v[108:111], v[76:79], v[172:175]
    buffer_store_dwordx4 v[216:219], v220, s[44:47], s86 offen offset:0 sc1
    s_waitcnt lgkmcnt(4)
    v_mfma_f32_16x16x32_bf16 v[176:179], v[88:91], v[72:75], v[176:179]
    ds_read_b128 v[108:111], v4 offset:49152
    buffer_store_dwordx4 v[216:219], v220, s[44:47], s86 offen offset:1024 sc1
    v_mfma_f32_16x16x32_bf16 v[180:183], v[88:91], v[76:79], v[180:183]
    v_lshlrev_b32 v192, 16, v192
    v_mfma_f32_16x16x32_bf16 v[184:187], v[92:95], v[72:75], v[184:187]
    ds_read_b64_tr_b16 v[88:89], v2 offset:46080
    v_lshlrev_b32 v194, 16, v194
    v_mfma_f32_16x16x32_bf16 v[188:191], v[92:95], v[76:79], v[188:191]
    ds_read_b64_tr_b16 v[90:91], v2 offset:46848
    v_lshlrev_b32 v196, 16, v196
    s_waitcnt vmcnt(22) lgkmcnt(4)
    v_mfma_f32_16x16x32_bf16 v[112:115], v[80:83], v[96:99], v[112:115]
    ds_read_b64_tr_b16 v[92:93], v2 offset:52224
    buffer_load_dwordx4 v[72:75], v1, s[8:11], s76 offen
    buffer_load_dwordx4 v[76:79], v1, s[8:11], s76 offen offset:256
    s_add_u32 s76, s76, 131072
    v_mfma_f32_16x16x32_bf16 v[116:119], v[84:87], v[96:99], v[116:119]
    ds_read_b64_tr_b16 v[94:95], v2 offset:52992
    v_mul_f32 v196, 0x3fb8aa3b, v196
    v_mfma_f32_16x16x32_bf16 v[120:123], v[80:83], v[100:103], v[120:123]
    ds_read_b64_tr_b16 v[96:97], v2 offset:46112
    v_exp_f32 v196, v196
    v_mfma_f32_16x16x32_bf16 v[124:127], v[84:87], v[100:103], v[124:127]
    ds_read_b64_tr_b16 v[98:99], v2 offset:46880
    v_cvt_pk_bf16_f32 v196, v196, v196
    s_waitcnt lgkmcnt(6)
    v_mfma_f32_16x16x32_bf16 v[128:131], v[80:83], v[104:107], v[128:131]
    ds_read_b64_tr_b16 v[100:101], v2 offset:52256
    v_and_b32 v196, 0xffff0000, v196
    v_mfma_f32_16x16x32_bf16 v[132:135], v[84:87], v[104:107], v[132:135]
    ds_read_b64_tr_b16 v[102:103], v2 offset:53024
    v_mul_f32 v224, v196, v192
    v_mfma_f32_16x16x32_bf16 v[136:139], v[80:83], v[108:111], v[136:139]
    ds_read_b64_tr_b16 v[104:105], v2 offset:46144
    v_mul_f32 v225, v196, v194
    v_mfma_f32_16x16x32_bf16 v[140:143], v[84:87], v[108:111], v[140:143]
    ds_read_b64_tr_b16 v[106:107], v2 offset:46912
    v_mul_f32 v16, 0x3fb8aa3b, v224
    s_waitcnt lgkmcnt(6)
    v_mfma_f32_16x16x32_bf16 v[144:147], v[88:91], v[80:83], v[144:147]
    ds_read_b64_tr_b16 v[108:109], v2 offset:52288
    v_mul_f32 v18, 0x3e22f983, v225
    v_mfma_f32_16x16x32_bf16 v[148:151], v[88:91], v[84:87], v[148:151]
    ds_read_b64_tr_b16 v[110:111], v2 offset:53056
    v_lshlrev_b32 v193, 16, v193
    s_waitcnt vmcnt(21)
    s_barrier
    v_mfma_f32_16x16x32_bf16 v[152:155], v[92:95], v[80:83], v[152:155]
    v_add_u32 v3, 64512, v3
    ds_read_b128 v[88:91], v3 offset:0
    s_add_u32 m0, s79, 21504
    s_nop 0
    buffer_load_dwordx4 v10, s[20:23], s77 offen lds
    s_add_u32 m0, s80, 21504
    s_nop 0
    buffer_load_dwordx4 v5, s[24:27], s77 offen lds
    s_add_u32 s77, s77, 458752
    v_mfma_f32_16x16x32_bf16 v[156:159], v[92:95], v[84:87], v[156:159]
    s_add_u32 m0, s81, 21504
    s_nop 0
    buffer_load_dwordx4 v11, s[28:31], s78 offen lds
    s_add_u32 s78, s78, 128
    s_waitcnt lgkmcnt(5)
    v_mfma_f32_16x16x32_bf16 v[160:163], v[96:99], v[80:83], v[160:163]
    ds_read_b128 v[92:95], v3 offset:2048
    v_lshlrev_b32 v195, 16, v195
    v_mfma_f32_16x16x32_bf16 v[164:167], v[96:99], v[84:87], v[164:167]
    v_lshlrev_b32 v197, 16, v197
    v_mfma_f32_16x16x32_bf16 v[168:171], v[100:103], v[80:83], v[168:171]
    ds_read_b128 v[96:99], v3 offset:4096
    v_mul_f32 v197, 0x3fb8aa3b, v197
    v_mfma_f32_16x16x32_bf16 v[172:175], v[100:103], v[84:87], v[172:175]
    v_exp_f32 v197, v197
    s_waitcnt lgkmcnt(3)
    v_mfma_f32_16x16x32_bf16 v[176:179], v[104:107], v[80:83], v[176:179]
    ds_read_b128 v[100:103], v3 offset:6144
    v_cvt_pk_bf16_f32 v197, v197, v197
    v_mfma_f32_16x16x32_bf16 v[180:183], v[104:107], v[84:87], v[180:183]
    v_and_b32 v197, 0xffff0000, v197
    v_mfma_f32_16x16x32_bf16 v[184:187], v[108:111], v[80:83], v[184:187]
    v_add_u32 v2, 64512, v2
    ds_read_b64_tr_b16 v[104:105], v2 offset:0
    v_mul_f32 v232, v197, v193
    v_mfma_f32_16x16x32_bf16 v[188:191], v[108:111], v[84:87], v[188:191]
    ds_read_b64_tr_b16 v[106:107], v2 offset:768
    v_mul_f32 v233, v197, v195
    s_waitcnt vmcnt(19) lgkmcnt(4)
    v_mfma_f32_16x16x32_bf16 v[112:115], v[40:43], v[88:91], v[112:115]
    ds_read_b64_tr_b16 v[108:109], v2 offset:6144
    buffer_load_dwordx4 v[80:83], v1, s[8:11], s76 offen
    buffer_load_dwordx4 v[84:87], v1, s[8:11], s76 offen offset:256
    s_add_u32 s76, s76, 131072
    v_mfma_f32_16x16x32_bf16 v[116:119], v[44:47], v[88:91], v[116:119]
    ds_read_b64_tr_b16 v[110:111], v2 offset:6912
    v_mul_f32 v17, 0x3fb8aa3b, v232
    v_mfma_f32_16x16x32_bf16 v[120:123], v[40:43], v[92:95], v[120:123]
    ds_read_b64_tr_b16 v[88:89], v2 offset:32
    v_mul_f32 v19, 0x3e22f983, v233
    v_mfma_f32_16x16x32_bf16 v[124:127], v[44:47], v[92:95], v[124:127]
    ds_read_b64_tr_b16 v[90:91], v2 offset:800
    v_mul_f32 v240, 1.0, v16
    s_waitcnt lgkmcnt(6)
    v_mfma_f32_16x16x32_bf16 v[128:131], v[40:43], v[96:99], v[128:131]
    ds_read_b64_tr_b16 v[92:93], v2 offset:6176
    v_mul_f32 v241, 1.0, v18
    v_mfma_f32_16x16x32_bf16 v[132:135], v[44:47], v[96:99], v[132:135]
    ds_read_b64_tr_b16 v[94:95], v2 offset:6944
    v_mul_f32 v243, 1.0, v17
    v_mfma_f32_16x16x32_bf16 v[136:139], v[40:43], v[100:103], v[136:139]
    ds_read_b64_tr_b16 v[96:97], v2 offset:64
    v_mul_f32 v244, 1.0, v19
    v_mfma_f32_16x16x32_bf16 v[140:143], v[44:47], v[100:103], v[140:143]
    ds_read_b64_tr_b16 v[98:99], v2 offset:832
    v_exp_f32 v240, v240
    s_waitcnt lgkmcnt(6)
    v_mfma_f32_16x16x32_bf16 v[144:147], v[104:107], v[40:43], v[144:147]
    ds_read_b64_tr_b16 v[100:101], v2 offset:6208
    v_fract_f32 v241, v241
    v_mfma_f32_16x16x32_bf16 v[148:151], v[104:107], v[44:47], v[148:151]
    ds_read_b64_tr_b16 v[102:103], v2 offset:6976
    v_exp_f32 v243, v243
    v_mfma_f32_16x16x32_bf16 v[152:155], v[108:111], v[40:43], v[152:155]
    v_add_u32 v4, 64512, v4
    ds_read_b128 v[104:107], v4 offset:0
    v_fract_f32 v244, v244
    v_mfma_f32_16x16x32_bf16 v[156:159], v[108:111], v[44:47], v[156:159]
    v_cos_f32 v242, v241
    s_waitcnt lgkmcnt(5)
    v_mfma_f32_16x16x32_bf16 v[160:163], v[88:91], v[40:43], v[160:163]
    ds_read_b128 v[108:111], v4 offset:2048
    v_sin_f32 v241, v241
    v_mfma_f32_16x16x32_bf16 v[164:167], v[88:91], v[44:47], v[164:167]
    v_cos_f32 v245, v244
    v_mfma_f32_16x16x32_bf16 v[168:171], v[92:95], v[40:43], v[168:171]
    ds_read_b128 v[88:91], v4 offset:4096
    v_sin_f32 v244, v244
    v_mfma_f32_16x16x32_bf16 v[172:175], v[92:95], v[44:47], v[172:175]
    v_mul_f32 v20, v240, v242
    s_waitcnt lgkmcnt(3)
    v_mfma_f32_16x16x32_bf16 v[176:179], v[96:99], v[40:43], v[176:179]
    ds_read_b128 v[92:95], v4 offset:6144
    v_mul_f32 v21, v240, v241
    v_mfma_f32_16x16x32_bf16 v[180:183], v[96:99], v[44:47], v[180:183]
    v_mul_f32 v22, v243, v245
    v_mfma_f32_16x16x32_bf16 v[184:187], v[100:103], v[40:43], v[184:187]
    ds_read_b64_tr_b16 v[96:97], v2 offset:3072
    v_mul_f32 v23, v243, v244
    v_mfma_f32_16x16x32_bf16 v[188:191], v[100:103], v[44:47], v[188:191]
    ds_read_b64_tr_b16 v[98:99], v2 offset:3840
    v_add_f32 v224, -1.0, v20
    s_waitcnt vmcnt(16) lgkmcnt(4)
    v_mfma_f32_16x16x32_bf16 v[112:115], v[48:51], v[104:107], v[112:115]
    ds_read_b64_tr_b16 v[100:101], v2 offset:9216
    buffer_load_dwordx4 v[40:43], v1, s[8:11], s76 offen
    buffer_load_dwordx4 v[44:47], v1, s[8:11], s76 offen offset:256
    s_add_u32 s76, s76, 131072
    v_mfma_f32_16x16x32_bf16 v[116:119], v[52:55], v[104:107], v[116:119]
    ds_read_b64_tr_b16 v[102:103], v2 offset:9984
    v_mul_f32 v225, v192, v192
    v_mfma_f32_16x16x32_bf16 v[120:123], v[48:51], v[108:111], v[120:123]
    ds_read_b64_tr_b16 v[104:105], v2 offset:3104
    v_fmac_f32 v225, v194, v194
    v_mfma_f32_16x16x32_bf16 v[124:127], v[52:55], v[108:111], v[124:127]
    ds_read_b64_tr_b16 v[106:107], v2 offset:3872
    v_rcp_f32 v225, v225
    s_waitcnt lgkmcnt(6)
    v_mfma_f32_16x16x32_bf16 v[128:131], v[48:51], v[88:91], v[128:131]
    ds_read_b64_tr_b16 v[108:109], v2 offset:9248
    v_mul_f32 v226, v224, v192
    v_mfma_f32_16x16x32_bf16 v[132:135], v[52:55], v[88:91], v[132:135]
    ds_read_b64_tr_b16 v[110:111], v2 offset:10016
    v_fmac_f32 v226, v21, v194
    v_mfma_f32_16x16x32_bf16 v[136:139], v[48:51], v[92:95], v[136:139]
    ds_read_b64_tr_b16 v[88:89], v2 offset:3136
    v_mul_f32 v227, v21, v192
    v_mfma_f32_16x16x32_bf16 v[140:143], v[52:55], v[92:95], v[140:143]
    ds_read_b64_tr_b16 v[90:91], v2 offset:3904
    v_fma_f32 v227, -v224, v194, v227
    s_waitcnt lgkmcnt(6)
    v_mfma_f32_16x16x32_bf16 v[144:147], v[96:99], v[48:51], v[144:147]
    ds_read_b64_tr_b16 v[92:93], v2 offset:9280
    v_add_f32 v225, v225, v225
    v_mfma_f32_16x16x32_bf16 v[148:151], v[96:99], v[52:55], v[148:151]
    ds_read_b64_tr_b16 v[94:95], v2 offset:10048
    v_mul_f32 v24, v226, v225
    s_barrier
    v_mfma_f32_16x16x32_bf16 v[152:155], v[100:103], v[48:51], v[152:155]
    ds_read_b128 v[96:99], v3 offset:21504
    s_add_u32 m0, s79, 43008
    s_nop 0
    buffer_load_dwordx4 v10, s[20:23], s77 offen lds
    s_add_u32 m0, s80, 43008
    s_nop 0
    buffer_load_dwordx4 v5, s[24:27], s77 offen lds
    s_add_u32 s77, s77, 458752
    v_mfma_f32_16x16x32_bf16 v[156:159], v[100:103], v[52:55], v[156:159]
    s_add_u32 m0, s81, 43008
    s_nop 0
    buffer_load_dwordx4 v11, s[28:31], s78 offen lds
    s_add_u32 s78, s78, 128
    s_waitcnt lgkmcnt(5)
    v_mfma_f32_16x16x32_bf16 v[160:163], v[104:107], v[48:51], v[160:163]
    ds_read_b128 v[100:103], v3 offset:23552
    v_mul_f32 v25, v227, v225
    v_mfma_f32_16x16x32_bf16 v[164:167], v[104:107], v[52:55], v[164:167]
    v_add_f32 v232, -1.0, v22
    v_mfma_f32_16x16x32_bf16 v[168:171], v[108:111], v[48:51], v[168:171]
    ds_read_b128 v[104:107], v3 offset:25600
    v_mul_f32 v233, v193, v193
    v_mfma_f32_16x16x32_bf16 v[172:175], v[108:111], v[52:55], v[172:175]
    v_fmac_f32 v233, v195, v195
    s_waitcnt lgkmcnt(3)
    v_mfma_f32_16x16x32_bf16 v[176:179], v[88:91], v[48:51], v[176:179]
    ds_read_b128 v[108:111], v3 offset:27648
    v_rcp_f32 v233, v233
    v_mfma_f32_16x16x32_bf16 v[180:183], v[88:91], v[52:55], v[180:183]
    v_mul_f32 v234, v232, v193
    v_mfma_f32_16x16x32_bf16 v[184:187], v[92:95], v[48:51], v[184:187]
    ds_read_b64_tr_b16 v[88:89], v2 offset:21504
    v_fmac_f32 v234, v23, v195
    v_mfma_f32_16x16x32_bf16 v[188:191], v[92:95], v[52:55], v[188:191]
    ds_read_b64_tr_b16 v[90:91], v2 offset:22272
    v_mul_f32 v235, v23, v193
    s_waitcnt vmcnt(19) lgkmcnt(4)
    v_mfma_f32_16x16x32_bf16 v[112:115], v[56:59], v[96:99], v[112:115]
    ds_read_b64_tr_b16 v[92:93], v2 offset:27648
    buffer_load_dwordx4 v[48:51], v1, s[8:11], s76 offen
    buffer_load_dwordx4 v[52:55], v1, s[8:11], s76 offen offset:256
    s_add_u32 s76, s76, 131072
    v_mfma_f32_16x16x32_bf16 v[116:119], v[60:63], v[96:99], v[116:119]
    ds_read_b64_tr_b16 v[94:95], v2 offset:28416
    v_fma_f32 v235, -v232, v195, v235
    v_mfma_f32_16x16x32_bf16 v[120:123], v[56:59], v[100:103], v[120:123]
    ds_read_b64_tr_b16 v[96:97], v2 offset:21536
    v_add_f32 v233, v233, v233
    v_mfma_f32_16x16x32_bf16 v[124:127], v[60:63], v[100:103], v[124:127]
    ds_read_b64_tr_b16 v[98:99], v2 offset:22304
    v_mul_f32 v26, v234, v233
    s_waitcnt lgkmcnt(6)
    v_mfma_f32_16x16x32_bf16 v[128:131], v[56:59], v[104:107], v[128:131]
    ds_read_b64_tr_b16 v[100:101], v2 offset:27680
    v_mul_f32 v27, v235, v233
    v_mfma_f32_16x16x32_bf16 v[132:135], v[60:63], v[104:107], v[132:135]
    ds_read_b64_tr_b16 v[102:103], v2 offset:28448
    v_mul_f32 v240, 0x41000000, v16
    v_mfma_f32_16x16x32_bf16 v[136:139], v[56:59], v[108:111], v[136:139]
    ds_read_b64_tr_b16 v[104:105], v2 offset:21568
    v_mul_f32 v241, 0x41000000, v18
    v_mfma_f32_16x16x32_bf16 v[140:143], v[60:63], v[108:111], v[140:143]
    ds_read_b64_tr_b16 v[106:107], v2 offset:22336
    v_mul_f32 v243, 0x41000000, v17
    s_waitcnt lgkmcnt(6)
    v_mfma_f32_16x16x32_bf16 v[144:147], v[88:91], v[56:59], v[144:147]
    ds_read_b64_tr_b16 v[108:109], v2 offset:27712
    v_mul_f32 v244, 0x41000000, v19
    v_mfma_f32_16x16x32_bf16 v[148:151], v[88:91], v[60:63], v[148:151]
    ds_read_b64_tr_b16 v[110:111], v2 offset:28480
    v_exp_f32 v240, v240
    v_mfma_f32_16x16x32_bf16 v[152:155], v[92:95], v[56:59], v[152:155]
    ds_read_b128 v[88:91], v4 offset:21504
    v_fract_f32 v241, v241
    v_mfma_f32_16x16x32_bf16 v[156:159], v[92:95], v[60:63], v[156:159]
    v_exp_f32 v243, v243
    s_waitcnt lgkmcnt(5)
    v_mfma_f32_16x16x32_bf16 v[160:163], v[96:99], v[56:59], v[160:163]
    ds_read_b128 v[92:95], v4 offset:23552
    v_fract_f32 v244, v244
    v_mfma_f32_16x16x32_bf16 v[164:167], v[96:99], v[60:63], v[164:167]
    v_cos_f32 v242, v241
    v_mfma_f32_16x16x32_bf16 v[168:171], v[100:103], v[56:59], v[168:171]
    ds_read_b128 v[96:99], v4 offset:25600
    v_sin_f32 v241, v241
    v_mfma_f32_16x16x32_bf16 v[172:175], v[100:103], v[60:63], v[172:175]
    v_cos_f32 v245, v244
    s_waitcnt lgkmcnt(3)
    v_mfma_f32_16x16x32_bf16 v[176:179], v[104:107], v[56:59], v[176:179]
    ds_read_b128 v[100:103], v4 offset:27648
    v_sin_f32 v244, v244
    v_mfma_f32_16x16x32_bf16 v[180:183], v[104:107], v[60:63], v[180:183]
    v_mul_f32 v28, v240, v242
    v_mfma_f32_16x16x32_bf16 v[184:187], v[108:111], v[56:59], v[184:187]
    ds_read_b64_tr_b16 v[104:105], v2 offset:24576
    v_mul_f32 v29, v240, v241
    v_mfma_f32_16x16x32_bf16 v[188:191], v[108:111], v[60:63], v[188:191]
    ds_read_b64_tr_b16 v[106:107], v2 offset:25344
    v_mul_f32 v30, v243, v245
    s_waitcnt vmcnt(16) lgkmcnt(4)
    v_mfma_f32_16x16x32_bf16 v[112:115], v[64:67], v[88:91], v[112:115]
    ds_read_b64_tr_b16 v[108:109], v2 offset:30720
    buffer_load_dwordx4 v[56:59], v1, s[8:11], s76 offen
    buffer_load_dwordx4 v[60:63], v1, s[8:11], s76 offen offset:256
    s_add_u32 s76, s76, 131072
    v_mfma_f32_16x16x32_bf16 v[116:119], v[68:71], v[88:91], v[116:119]
    ds_read_b64_tr_b16 v[110:111], v2 offset:31488
    v_mul_f32 v31, v243, v244
    v_mfma_f32_16x16x32_bf16 v[120:123], v[64:67], v[92:95], v[120:123]
    ds_read_b64_tr_b16 v[88:89], v2 offset:24608
    v_mul_f32 v240, 0x42000000, v16
    v_mfma_f32_16x16x32_bf16 v[124:127], v[68:71], v[92:95], v[124:127]
    ds_read_b64_tr_b16 v[90:91], v2 offset:25376
    v_mul_f32 v241, 0x42000000, v18
    s_waitcnt lgkmcnt(6)
    v_mfma_f32_16x16x32_bf16 v[128:131], v[64:67], v[96:99], v[128:131]
    ds_read_b64_tr_b16 v[92:93], v2 offset:30752
    v_mul_f32 v243, 0x42000000, v17
    v_mfma_f32_16x16x32_bf16 v[132:135], v[68:71], v[96:99], v[132:135]
    ds_read_b64_tr_b16 v[94:95], v2 offset:31520
    v_mul_f32 v244, 0x42000000, v19
    v_mfma_f32_16x16x32_bf16 v[136:139], v[64:67], v[100:103], v[136:139]
    ds_read_b64_tr_b16 v[96:97], v2 offset:24640
    v_exp_f32 v240, v240
    v_mfma_f32_16x16x32_bf16 v[140:143], v[68:71], v[100:103], v[140:143]
    ds_read_b64_tr_b16 v[98:99], v2 offset:25408
    v_fract_f32 v241, v241
    s_waitcnt lgkmcnt(6)
    v_mfma_f32_16x16x32_bf16 v[144:147], v[104:107], v[64:67], v[144:147]
    ds_read_b64_tr_b16 v[100:101], v2 offset:30784
    v_exp_f32 v243, v243
    v_mfma_f32_16x16x32_bf16 v[148:151], v[104:107], v[68:71], v[148:151]
    ds_read_b64_tr_b16 v[102:103], v2 offset:31552
    v_fract_f32 v244, v244
    s_barrier
    v_mfma_f32_16x16x32_bf16 v[152:155], v[108:111], v[64:67], v[152:155]
    ds_read_b128 v[104:107], v3 offset:43008
    s_add_u32 m0, s79, 64512
    s_nop 0
    buffer_load_dwordx4 v10, s[20:23], s77 offen lds
    s_add_u32 m0, s80, 64512
    s_nop 0
    buffer_load_dwordx4 v5, s[24:27], s77 offen lds
    s_add_u32 s77, s77, 458752
    v_mfma_f32_16x16x32_bf16 v[156:159], v[108:111], v[68:71], v[156:159]
    s_add_u32 m0, s81, 64512
    s_nop 0
    buffer_load_dwordx4 v11, s[28:31], s78 offen lds
    s_add_u32 s78, s78, 128
    s_waitcnt lgkmcnt(5)
    v_mfma_f32_16x16x32_bf16 v[160:163], v[88:91], v[64:67], v[160:163]
    ds_read_b128 v[108:111], v3 offset:45056
    v_cos_f32 v242, v241
    v_mfma_f32_16x16x32_bf16 v[164:167], v[88:91], v[68:71], v[164:167]
    v_sin_f32 v241, v241
    v_mfma_f32_16x16x32_bf16 v[168:171], v[92:95], v[64:67], v[168:171]
    ds_read_b128 v[88:91], v3 offset:47104
    v_cos_f32 v245, v244
    v_mfma_f32_16x16x32_bf16 v[172:175], v[92:95], v[68:71], v[172:175]
    v_sin_f32 v244, v244
    s_waitcnt lgkmcnt(3)
    v_mfma_f32_16x16x32_bf16 v[176:179], v[96:99], v[64:67], v[176:179]
    ds_read_b128 v[92:95], v3 offset:49152
    v_mul_f32 v32, v240, v242
    v_mfma_f32_16x16x32_bf16 v[180:183], v[96:99], v[68:71], v[180:183]
    v_mul_f32 v33, v240, v241
    v_mfma_f32_16x16x32_bf16 v[184:187], v[100:103], v[64:67], v[184:187]
    ds_read_b64_tr_b16 v[96:97], v2 offset:43008
    v_mul_f32 v34, v243, v245
    v_mfma_f32_16x16x32_bf16 v[188:191], v[100:103], v[68:71], v[188:191]
    ds_read_b64_tr_b16 v[98:99], v2 offset:43776
    v_mul_f32 v35, v243, v244
    s_waitcnt vmcnt(17) lgkmcnt(4)
    v_mfma_f32_16x16x32_bf16 v[112:115], v[72:75], v[104:107], v[112:115]
    ds_read_b64_tr_b16 v[100:101], v2 offset:49152
    buffer_load_dwordx4 v[64:67], v1, s[8:11], s76 offen
    buffer_load_dwordx4 v[68:71], v1, s[8:11], s76 offen offset:256
    s_add_u32 s76, s76, 131072
    v_mfma_f32_16x16x32_bf16 v[116:119], v[76:79], v[104:107], v[116:119]
    ds_read_b64_tr_b16 v[102:103], v2 offset:49920
    v_mfma_f32_16x16x32_bf16 v[120:123], v[72:75], v[108:111], v[120:123]
    ds_read_b64_tr_b16 v[104:105], v2 offset:43040
    v_mfma_f32_16x16x32_bf16 v[124:127], v[76:79], v[108:111], v[124:127]
    ds_read_b64_tr_b16 v[106:107], v2 offset:43808
    s_waitcnt lgkmcnt(6)
    v_mfma_f32_16x16x32_bf16 v[128:131], v[72:75], v[88:91], v[128:131]
    ds_read_b64_tr_b16 v[108:109], v2 offset:49184
    v_mfma_f32_16x16x32_bf16 v[132:135], v[76:79], v[88:91], v[132:135]
    ds_read_b64_tr_b16 v[110:111], v2 offset:49952
    v_mfma_f32_16x16x32_bf16 v[136:139], v[72:75], v[92:95], v[136:139]
    ds_read_b64_tr_b16 v[88:89], v2 offset:43072
    v_mfma_f32_16x16x32_bf16 v[140:143], v[76:79], v[92:95], v[140:143]
    ds_read_b64_tr_b16 v[90:91], v2 offset:43840
    s_waitcnt lgkmcnt(6)
    v_mfma_f32_16x16x32_bf16 v[144:147], v[96:99], v[72:75], v[144:147]
    ds_read_b64_tr_b16 v[92:93], v2 offset:49216
    v_mfma_f32_16x16x32_bf16 v[148:151], v[96:99], v[76:79], v[148:151]
    ds_read_b64_tr_b16 v[94:95], v2 offset:49984
    v_mfma_f32_16x16x32_bf16 v[152:155], v[100:103], v[72:75], v[152:155]
    ds_read_b128 v[96:99], v4 offset:43008
    v_mfma_f32_16x16x32_bf16 v[156:159], v[100:103], v[76:79], v[156:159]
    s_waitcnt lgkmcnt(5)
    v_mfma_f32_16x16x32_bf16 v[160:163], v[104:107], v[72:75], v[160:163]
    ds_read_b128 v[100:103], v4 offset:45056
    v_mfma_f32_16x16x32_bf16 v[164:167], v[104:107], v[76:79], v[164:167]
    v_mfma_f32_16x16x32_bf16 v[168:171], v[108:111], v[72:75], v[168:171]
    ds_read_b128 v[104:107], v4 offset:47104
    v_mfma_f32_16x16x32_bf16 v[172:175], v[108:111], v[76:79], v[172:175]
    s_waitcnt lgkmcnt(3)
    v_mfma_f32_16x16x32_bf16 v[176:179], v[88:91], v[72:75], v[176:179]
    ds_read_b128 v[108:111], v4 offset:49152
    v_mfma_f32_16x16x32_bf16 v[180:183], v[88:91], v[76:79], v[180:183]
    v_mfma_f32_16x16x32_bf16 v[184:187], v[92:95], v[72:75], v[184:187]
    ds_read_b64_tr_b16 v[88:89], v2 offset:46080
    v_mfma_f32_16x16x32_bf16 v[188:191], v[92:95], v[76:79], v[188:191]
    ds_read_b64_tr_b16 v[90:91], v2 offset:46848
    s_waitcnt vmcnt(14) lgkmcnt(4)
    v_mfma_f32_16x16x32_bf16 v[112:115], v[80:83], v[96:99], v[112:115]
    ds_read_b64_tr_b16 v[92:93], v2 offset:52224
    buffer_load_dwordx4 v[72:75], v1, s[8:11], s76 offen
    buffer_load_dwordx4 v[76:79], v1, s[8:11], s76 offen offset:256
    s_add_u32 s76, s76, 131072
    v_mfma_f32_16x16x32_bf16 v[116:119], v[84:87], v[96:99], v[116:119]
    ds_read_b64_tr_b16 v[94:95], v2 offset:52992
    v_mfma_f32_16x16x32_bf16 v[120:123], v[80:83], v[100:103], v[120:123]
    ds_read_b64_tr_b16 v[96:97], v2 offset:46112
    v_mfma_f32_16x16x32_bf16 v[124:127], v[84:87], v[100:103], v[124:127]
    ds_read_b64_tr_b16 v[98:99], v2 offset:46880
    s_waitcnt lgkmcnt(6)
    v_mfma_f32_16x16x32_bf16 v[128:131], v[80:83], v[104:107], v[128:131]
    ds_read_b64_tr_b16 v[100:101], v2 offset:52256
    v_mfma_f32_16x16x32_bf16 v[132:135], v[84:87], v[104:107], v[132:135]
    ds_read_b64_tr_b16 v[102:103], v2 offset:53024
    v_mfma_f32_16x16x32_bf16 v[136:139], v[80:83], v[108:111], v[136:139]
    ds_read_b64_tr_b16 v[104:105], v2 offset:46144
    v_mfma_f32_16x16x32_bf16 v[140:143], v[84:87], v[108:111], v[140:143]
    ds_read_b64_tr_b16 v[106:107], v2 offset:46912
    s_waitcnt lgkmcnt(6)
    v_mfma_f32_16x16x32_bf16 v[144:147], v[88:91], v[80:83], v[144:147]
    ds_read_b64_tr_b16 v[108:109], v2 offset:52288
    v_mfma_f32_16x16x32_bf16 v[148:151], v[88:91], v[84:87], v[148:151]
    ds_read_b64_tr_b16 v[110:111], v2 offset:53056
    s_barrier
    v_mfma_f32_16x16x32_bf16 v[152:155], v[92:95], v[80:83], v[152:155]
    v_subrev_u32 v3, 64512, v3
    ds_read_b128 v[88:91], v3 offset:0
    s_add_u32 m0, s79, 86016
    s_nop 0
    buffer_load_dwordx4 v10, s[20:23], s77 offen lds
    s_add_u32 m0, s80, 86016
    s_nop 0
    buffer_load_dwordx4 v5, s[24:27], s77 offen lds
    s_add_u32 s77, s77, 458752
    v_mfma_f32_16x16x32_bf16 v[156:159], v[92:95], v[84:87], v[156:159]
    s_add_u32 m0, s81, 86016
    s_nop 0
    buffer_load_dwordx4 v11, s[28:31], s78 offen lds
    s_add_u32 s78, s78, 128
    s_waitcnt lgkmcnt(5)
    v_mfma_f32_16x16x32_bf16 v[160:163], v[96:99], v[80:83], v[160:163]
    ds_read_b128 v[92:95], v3 offset:2048
    v_mfma_f32_16x16x32_bf16 v[164:167], v[96:99], v[84:87], v[164:167]
    v_mfma_f32_16x16x32_bf16 v[168:171], v[100:103], v[80:83], v[168:171]
    ds_read_b128 v[96:99], v3 offset:4096
    v_mfma_f32_16x16x32_bf16 v[172:175], v[100:103], v[84:87], v[172:175]
    s_waitcnt lgkmcnt(3)
    v_mfma_f32_16x16x32_bf16 v[176:179], v[104:107], v[80:83], v[176:179]
    ds_read_b128 v[100:103], v3 offset:6144
    v_mfma_f32_16x16x32_bf16 v[180:183], v[104:107], v[84:87], v[180:183]
    v_mfma_f32_16x16x32_bf16 v[184:187], v[108:111], v[80:83], v[184:187]
    v_subrev_u32 v2, 64512, v2
    ds_read_b64_tr_b16 v[104:105], v2 offset:0
    v_mfma_f32_16x16x32_bf16 v[188:191], v[108:111], v[84:87], v[188:191]
    ds_read_b64_tr_b16 v[106:107], v2 offset:768
    s_waitcnt vmcnt(17) lgkmcnt(4)
    v_mfma_f32_16x16x32_bf16 v[112:115], v[40:43], v[88:91], v[112:115]
    ds_read_b64_tr_b16 v[108:109], v2 offset:6144
    buffer_load_dwordx4 v[80:83], v1, s[8:11], s76 offen
    buffer_load_dwordx4 v[84:87], v1, s[8:11], s76 offen offset:256
    s_add_u32 s76, s76, 131072
    v_mfma_f32_16x16x32_bf16 v[116:119], v[44:47], v[88:91], v[116:119]
    ds_read_b64_tr_b16 v[110:111], v2 offset:6912
    v_mfma_f32_16x16x32_bf16 v[120:123], v[40:43], v[92:95], v[120:123]
    ds_read_b64_tr_b16 v[88:89], v2 offset:32
    v_mfma_f32_16x16x32_bf16 v[124:127], v[44:47], v[92:95], v[124:127]
    ds_read_b64_tr_b16 v[90:91], v2 offset:800
    s_waitcnt lgkmcnt(6)
    v_mfma_f32_16x16x32_bf16 v[128:131], v[40:43], v[96:99], v[128:131]
    ds_read_b64_tr_b16 v[92:93], v2 offset:6176
    v_mfma_f32_16x16x32_bf16 v[132:135], v[44:47], v[96:99], v[132:135]
    ds_read_b64_tr_b16 v[94:95], v2 offset:6944
    v_mfma_f32_16x16x32_bf16 v[136:139], v[40:43], v[100:103], v[136:139]
    ds_read_b64_tr_b16 v[96:97], v2 offset:64
    v_mfma_f32_16x16x32_bf16 v[140:143], v[44:47], v[100:103], v[140:143]
    ds_read_b64_tr_b16 v[98:99], v2 offset:832
    s_waitcnt lgkmcnt(6)
    v_mfma_f32_16x16x32_bf16 v[144:147], v[104:107], v[40:43], v[144:147]
    ds_read_b64_tr_b16 v[100:101], v2 offset:6208
    v_mfma_f32_16x16x32_bf16 v[148:151], v[104:107], v[44:47], v[148:151]
    ds_read_b64_tr_b16 v[102:103], v2 offset:6976
    v_mfma_f32_16x16x32_bf16 v[152:155], v[108:111], v[40:43], v[152:155]
    v_subrev_u32 v4, 64512, v4
    ds_read_b128 v[104:107], v4 offset:0
    v_mfma_f32_16x16x32_bf16 v[156:159], v[108:111], v[44:47], v[156:159]
    s_waitcnt lgkmcnt(5)
    v_mfma_f32_16x16x32_bf16 v[160:163], v[88:91], v[40:43], v[160:163]
    ds_read_b128 v[108:111], v4 offset:2048
    v_mfma_f32_16x16x32_bf16 v[164:167], v[88:91], v[44:47], v[164:167]
    v_mfma_f32_16x16x32_bf16 v[168:171], v[92:95], v[40:43], v[168:171]
    ds_read_b128 v[88:91], v4 offset:4096
    v_mfma_f32_16x16x32_bf16 v[172:175], v[92:95], v[44:47], v[172:175]
    s_waitcnt lgkmcnt(3)
    v_mfma_f32_16x16x32_bf16 v[176:179], v[96:99], v[40:43], v[176:179]
    ds_read_b128 v[92:95], v4 offset:6144
    v_mfma_f32_16x16x32_bf16 v[180:183], v[96:99], v[44:47], v[180:183]
    v_mfma_f32_16x16x32_bf16 v[184:187], v[100:103], v[40:43], v[184:187]
    ds_read_b64_tr_b16 v[96:97], v2 offset:3072
    v_mfma_f32_16x16x32_bf16 v[188:191], v[100:103], v[44:47], v[188:191]
    ds_read_b64_tr_b16 v[98:99], v2 offset:3840
    s_waitcnt vmcnt(14) lgkmcnt(4)
    v_mfma_f32_16x16x32_bf16 v[112:115], v[48:51], v[104:107], v[112:115]
    ds_read_b64_tr_b16 v[100:101], v2 offset:9216
    buffer_load_dwordx4 v[40:43], v1, s[8:11], s76 offen
    buffer_load_dwordx4 v[44:47], v1, s[8:11], s76 offen offset:256
    s_add_u32 s76, s76, 131072
    v_mfma_f32_16x16x32_bf16 v[116:119], v[52:55], v[104:107], v[116:119]
    ds_read_b64_tr_b16 v[102:103], v2 offset:9984
    v_mfma_f32_16x16x32_bf16 v[120:123], v[48:51], v[108:111], v[120:123]
    ds_read_b64_tr_b16 v[104:105], v2 offset:3104
    v_mfma_f32_16x16x32_bf16 v[124:127], v[52:55], v[108:111], v[124:127]
    ds_read_b64_tr_b16 v[106:107], v2 offset:3872
    s_waitcnt lgkmcnt(6)
    v_mfma_f32_16x16x32_bf16 v[128:131], v[48:51], v[88:91], v[128:131]
    ds_read_b64_tr_b16 v[108:109], v2 offset:9248
    v_mfma_f32_16x16x32_bf16 v[132:135], v[52:55], v[88:91], v[132:135]
    ds_read_b64_tr_b16 v[110:111], v2 offset:10016
    v_mfma_f32_16x16x32_bf16 v[136:139], v[48:51], v[92:95], v[136:139]
    ds_read_b64_tr_b16 v[88:89], v2 offset:3136
    v_mfma_f32_16x16x32_bf16 v[140:143], v[52:55], v[92:95], v[140:143]
    ds_read_b64_tr_b16 v[90:91], v2 offset:3904
    s_waitcnt lgkmcnt(6)
    v_mfma_f32_16x16x32_bf16 v[144:147], v[96:99], v[48:51], v[144:147]
    ds_read_b64_tr_b16 v[92:93], v2 offset:9280
    v_mfma_f32_16x16x32_bf16 v[148:151], v[96:99], v[52:55], v[148:151]
    ds_read_b64_tr_b16 v[94:95], v2 offset:10048
    s_barrier
    v_mfma_f32_16x16x32_bf16 v[152:155], v[100:103], v[48:51], v[152:155]
    ds_read_b128 v[96:99], v3 offset:21504
    s_add_u32 m0, s79, 107520
    s_nop 0
    buffer_load_dwordx4 v10, s[20:23], s77 offen lds
    s_add_u32 m0, s80, 107520
    s_nop 0
    buffer_load_dwordx4 v5, s[24:27], s77 offen lds
    s_add_u32 s77, s77, 458752
    v_mfma_f32_16x16x32_bf16 v[156:159], v[100:103], v[52:55], v[156:159]
    s_add_u32 m0, s81, 107520
    s_nop 0
    buffer_load_dwordx4 v11, s[28:31], s78 offen lds
    s_add_u32 s78, s78, 128
    s_waitcnt lgkmcnt(5)
    v_mfma_f32_16x16x32_bf16 v[160:163], v[104:107], v[48:51], v[160:163]
    ds_read_b128 v[100:103], v3 offset:23552
    v_mfma_f32_16x16x32_bf16 v[164:167], v[104:107], v[52:55], v[164:167]
    v_mfma_f32_16x16x32_bf16 v[168:171], v[108:111], v[48:51], v[168:171]
    ds_read_b128 v[104:107], v3 offset:25600
    v_mfma_f32_16x16x32_bf16 v[172:175], v[108:111], v[52:55], v[172:175]
    s_waitcnt lgkmcnt(3)
    v_mfma_f32_16x16x32_bf16 v[176:179], v[88:91], v[48:51], v[176:179]
    ds_read_b128 v[108:111], v3 offset:27648
    v_mfma_f32_16x16x32_bf16 v[180:183], v[88:91], v[52:55], v[180:183]
    v_mfma_f32_16x16x32_bf16 v[184:187], v[92:95], v[48:51], v[184:187]
    ds_read_b64_tr_b16 v[88:89], v2 offset:21504
    v_mfma_f32_16x16x32_bf16 v[188:191], v[92:95], v[52:55], v[188:191]
    ds_read_b64_tr_b16 v[90:91], v2 offset:22272
    s_waitcnt vmcnt(17) lgkmcnt(4)
    v_mfma_f32_16x16x32_bf16 v[112:115], v[56:59], v[96:99], v[112:115]
    ds_read_b64_tr_b16 v[92:93], v2 offset:27648
    buffer_load_dwordx4 v[48:51], v1, s[8:11], s76 offen
    buffer_load_dwordx4 v[52:55], v1, s[8:11], s76 offen offset:256
    s_add_u32 s76, s76, 131072
    v_mfma_f32_16x16x32_bf16 v[116:119], v[60:63], v[96:99], v[116:119]
    ds_read_b64_tr_b16 v[94:95], v2 offset:28416
    v_mfma_f32_16x16x32_bf16 v[120:123], v[56:59], v[100:103], v[120:123]
    ds_read_b64_tr_b16 v[96:97], v2 offset:21536
    v_mfma_f32_16x16x32_bf16 v[124:127], v[60:63], v[100:103], v[124:127]
    ds_read_b64_tr_b16 v[98:99], v2 offset:22304
    s_waitcnt lgkmcnt(6)
    v_mfma_f32_16x16x32_bf16 v[128:131], v[56:59], v[104:107], v[128:131]
    ds_read_b64_tr_b16 v[100:101], v2 offset:27680
    v_mfma_f32_16x16x32_bf16 v[132:135], v[60:63], v[104:107], v[132:135]
    ds_read_b64_tr_b16 v[102:103], v2 offset:28448
    v_mfma_f32_16x16x32_bf16 v[136:139], v[56:59], v[108:111], v[136:139]
    ds_read_b64_tr_b16 v[104:105], v2 offset:21568
    v_mfma_f32_16x16x32_bf16 v[140:143], v[60:63], v[108:111], v[140:143]
    ds_read_b64_tr_b16 v[106:107], v2 offset:22336
    s_waitcnt lgkmcnt(6)
    v_mfma_f32_16x16x32_bf16 v[144:147], v[88:91], v[56:59], v[144:147]
    ds_read_b64_tr_b16 v[108:109], v2 offset:27712
    v_mfma_f32_16x16x32_bf16 v[148:151], v[88:91], v[60:63], v[148:151]
    ds_read_b64_tr_b16 v[110:111], v2 offset:28480
    v_mfma_f32_16x16x32_bf16 v[152:155], v[92:95], v[56:59], v[152:155]
    ds_read_b128 v[88:91], v4 offset:21504
    v_mfma_f32_16x16x32_bf16 v[156:159], v[92:95], v[60:63], v[156:159]
    s_waitcnt lgkmcnt(5)
    v_mfma_f32_16x16x32_bf16 v[160:163], v[96:99], v[56:59], v[160:163]
    ds_read_b128 v[92:95], v4 offset:23552
    v_mfma_f32_16x16x32_bf16 v[164:167], v[96:99], v[60:63], v[164:167]
    v_mfma_f32_16x16x32_bf16 v[168:171], v[100:103], v[56:59], v[168:171]
    ds_read_b128 v[96:99], v4 offset:25600
    v_mfma_f32_16x16x32_bf16 v[172:175], v[100:103], v[60:63], v[172:175]
    s_waitcnt lgkmcnt(3)
    v_mfma_f32_16x16x32_bf16 v[176:179], v[104:107], v[56:59], v[176:179]
    ds_read_b128 v[100:103], v4 offset:27648
    v_mfma_f32_16x16x32_bf16 v[180:183], v[104:107], v[60:63], v[180:183]
    v_mfma_f32_16x16x32_bf16 v[184:187], v[108:111], v[56:59], v[184:187]
    ds_read_b64_tr_b16 v[104:105], v2 offset:24576
    v_mfma_f32_16x16x32_bf16 v[188:191], v[108:111], v[60:63], v[188:191]
    ds_read_b64_tr_b16 v[106:107], v2 offset:25344
    s_waitcnt vmcnt(14) lgkmcnt(4)
    v_mfma_f32_16x16x32_bf16 v[112:115], v[64:67], v[88:91], v[112:115]
    ds_read_b64_tr_b16 v[108:109], v2 offset:30720
    buffer_load_dwordx4 v[56:59], v1, s[8:11], s76 offen
    buffer_load_dwordx4 v[60:63], v1, s[8:11], s76 offen offset:256
    s_add_u32 s76, s76, 131072
    v_mfma_f32_16x16x32_bf16 v[116:119], v[68:71], v[88:91], v[116:119]
    ds_read_b64_tr_b16 v[110:111], v2 offset:31488
    v_mfma_f32_16x16x32_bf16 v[120:123], v[64:67], v[92:95], v[120:123]
    ds_read_b64_tr_b16 v[88:89], v2 offset:24608
    v_mfma_f32_16x16x32_bf16 v[124:127], v[68:71], v[92:95], v[124:127]
    ds_read_b64_tr_b16 v[90:91], v2 offset:25376
    s_waitcnt lgkmcnt(6)
    v_mfma_f32_16x16x32_bf16 v[128:131], v[64:67], v[96:99], v[128:131]
    ds_read_b64_tr_b16 v[92:93], v2 offset:30752
    v_mfma_f32_16x16x32_bf16 v[132:135], v[68:71], v[96:99], v[132:135]
    ds_read_b64_tr_b16 v[94:95], v2 offset:31520
    v_mfma_f32_16x16x32_bf16 v[136:139], v[64:67], v[100:103], v[136:139]
    ds_read_b64_tr_b16 v[96:97], v2 offset:24640
    v_mfma_f32_16x16x32_bf16 v[140:143], v[68:71], v[100:103], v[140:143]
    ds_read_b64_tr_b16 v[98:99], v2 offset:25408
    s_waitcnt lgkmcnt(6)
    v_mfma_f32_16x16x32_bf16 v[144:147], v[104:107], v[64:67], v[144:147]
    ds_read_b64_tr_b16 v[100:101], v2 offset:30784
    v_mfma_f32_16x16x32_bf16 v[148:151], v[104:107], v[68:71], v[148:151]
    ds_read_b64_tr_b16 v[102:103], v2 offset:31552
    s_barrier
    v_mfma_f32_16x16x32_bf16 v[152:155], v[108:111], v[64:67], v[152:155]
    ds_read_b128 v[104:107], v3 offset:43008
    s_add_u32 m0, s79, 0
    s_nop 0
    buffer_load_dwordx4 v10, s[20:23], s77 offen lds
    s_add_u32 m0, s80, 0
    s_nop 0
    buffer_load_dwordx4 v5, s[24:27], s77 offen lds
    s_add_u32 s77, s77, 458752
    v_mfma_f32_16x16x32_bf16 v[156:159], v[108:111], v[68:71], v[156:159]
    s_add_u32 m0, s81, 0
    s_nop 0
    buffer_load_dwordx4 v11, s[28:31], s78 offen lds
    s_add_u32 s78, s78, 128
    s_waitcnt lgkmcnt(5)
    v_mfma_f32_16x16x32_bf16 v[160:163], v[88:91], v[64:67], v[160:163]
    ds_read_b128 v[108:111], v3 offset:45056
    v_mfma_f32_16x16x32_bf16 v[164:167], v[88:91], v[68:71], v[164:167]
    v_mfma_f32_16x16x32_bf16 v[168:171], v[92:95], v[64:67], v[168:171]
    ds_read_b128 v[88:91], v3 offset:47104
    v_mfma_f32_16x16x32_bf16 v[172:175], v[92:95], v[68:71], v[172:175]
    s_waitcnt lgkmcnt(3)
    v_mfma_f32_16x16x32_bf16 v[176:179], v[96:99], v[64:67], v[176:179]
    ds_read_b128 v[92:95], v3 offset:49152
    v_mfma_f32_16x16x32_bf16 v[180:183], v[96:99], v[68:71], v[180:183]
    v_mfma_f32_16x16x32_bf16 v[184:187], v[100:103], v[64:67], v[184:187]
    ds_read_b64_tr_b16 v[96:97], v2 offset:43008
    v_mfma_f32_16x16x32_bf16 v[188:191], v[100:103], v[68:71], v[188:191]
    ds_read_b64_tr_b16 v[98:99], v2 offset:43776
    s_waitcnt vmcnt(17) lgkmcnt(4)
    v_mfma_f32_16x16x32_bf16 v[112:115], v[72:75], v[104:107], v[112:115]
    ds_read_b64_tr_b16 v[100:101], v2 offset:49152
    buffer_load_dwordx4 v[64:67], v1, s[8:11], s76 offen
    buffer_load_dwordx4 v[68:71], v1, s[8:11], s76 offen offset:256
    s_add_u32 s76, s76, 131072
    v_mfma_f32_16x16x32_bf16 v[116:119], v[76:79], v[104:107], v[116:119]
    ds_read_b64_tr_b16 v[102:103], v2 offset:49920
    v_mfma_f32_16x16x32_bf16 v[120:123], v[72:75], v[108:111], v[120:123]
    ds_read_b64_tr_b16 v[104:105], v2 offset:43040
    v_mfma_f32_16x16x32_bf16 v[124:127], v[76:79], v[108:111], v[124:127]
    ds_read_b64_tr_b16 v[106:107], v2 offset:43808
    s_waitcnt lgkmcnt(6)
    v_mfma_f32_16x16x32_bf16 v[128:131], v[72:75], v[88:91], v[128:131]
    ds_read_b64_tr_b16 v[108:109], v2 offset:49184
    v_mfma_f32_16x16x32_bf16 v[132:135], v[76:79], v[88:91], v[132:135]
    ds_read_b64_tr_b16 v[110:111], v2 offset:49952
    v_mfma_f32_16x16x32_bf16 v[136:139], v[72:75], v[92:95], v[136:139]
    ds_read_b64_tr_b16 v[88:89], v2 offset:43072
    v_mfma_f32_16x16x32_bf16 v[140:143], v[76:79], v[92:95], v[140:143]
    ds_read_b64_tr_b16 v[90:91], v2 offset:43840
    s_waitcnt lgkmcnt(6)
    v_mfma_f32_16x16x32_bf16 v[144:147], v[96:99], v[72:75], v[144:147]
    ds_read_b64_tr_b16 v[92:93], v2 offset:49216
    v_mfma_f32_16x16x32_bf16 v[148:151], v[96:99], v[76:79], v[148:151]
    ds_read_b64_tr_b16 v[94:95], v2 offset:49984
    v_mfma_f32_16x16x32_bf16 v[152:155], v[100:103], v[72:75], v[152:155]
    ds_read_b128 v[96:99], v4 offset:43008
    v_mfma_f32_16x16x32_bf16 v[156:159], v[100:103], v[76:79], v[156:159]
    s_waitcnt lgkmcnt(5)
    v_mfma_f32_16x16x32_bf16 v[160:163], v[104:107], v[72:75], v[160:163]
    ds_read_b128 v[100:103], v4 offset:45056
    v_mfma_f32_16x16x32_bf16 v[164:167], v[104:107], v[76:79], v[164:167]
    v_mfma_f32_16x16x32_bf16 v[168:171], v[108:111], v[72:75], v[168:171]
    ds_read_b128 v[104:107], v4 offset:47104
    v_mfma_f32_16x16x32_bf16 v[172:175], v[108:111], v[76:79], v[172:175]
    s_waitcnt lgkmcnt(3)
    v_mfma_f32_16x16x32_bf16 v[176:179], v[88:91], v[72:75], v[176:179]
    ds_read_b128 v[108:111], v4 offset:49152
    v_mfma_f32_16x16x32_bf16 v[180:183], v[88:91], v[76:79], v[180:183]
    v_mfma_f32_16x16x32_bf16 v[184:187], v[92:95], v[72:75], v[184:187]
    ds_read_b64_tr_b16 v[88:89], v2 offset:46080
    v_mfma_f32_16x16x32_bf16 v[188:191], v[92:95], v[76:79], v[188:191]
    ds_read_b64_tr_b16 v[90:91], v2 offset:46848
    s_waitcnt vmcnt(14) lgkmcnt(4)
    v_mfma_f32_16x16x32_bf16 v[112:115], v[80:83], v[96:99], v[112:115]
    ds_read_b64_tr_b16 v[92:93], v2 offset:52224
    buffer_load_dwordx4 v[72:75], v1, s[8:11], s76 offen
    buffer_load_dwordx4 v[76:79], v1, s[8:11], s76 offen offset:256
    s_add_u32 s76, s76, 131072
    v_mfma_f32_16x16x32_bf16 v[116:119], v[84:87], v[96:99], v[116:119]
    ds_read_b64_tr_b16 v[94:95], v2 offset:52992
    v_mfma_f32_16x16x32_bf16 v[120:123], v[80:83], v[100:103], v[120:123]
    ds_read_b64_tr_b16 v[96:97], v2 offset:46112
    v_mfma_f32_16x16x32_bf16 v[124:127], v[84:87], v[100:103], v[124:127]
    ds_read_b64_tr_b16 v[98:99], v2 offset:46880
    s_waitcnt lgkmcnt(6)
    v_mfma_f32_16x16x32_bf16 v[128:131], v[80:83], v[104:107], v[128:131]
    ds_read_b64_tr_b16 v[100:101], v2 offset:52256
    v_mfma_f32_16x16x32_bf16 v[132:135], v[84:87], v[104:107], v[132:135]
    ds_read_b64_tr_b16 v[102:103], v2 offset:53024
    v_mfma_f32_16x16x32_bf16 v[136:139], v[80:83], v[108:111], v[136:139]
    ds_read_b64_tr_b16 v[104:105], v2 offset:46144
    v_mfma_f32_16x16x32_bf16 v[140:143], v[84:87], v[108:111], v[140:143]
    ds_read_b64_tr_b16 v[106:107], v2 offset:46912
    s_waitcnt lgkmcnt(6)
    v_mfma_f32_16x16x32_bf16 v[144:147], v[88:91], v[80:83], v[144:147]
    ds_read_b64_tr_b16 v[108:109], v2 offset:52288
    v_mfma_f32_16x16x32_bf16 v[148:151], v[88:91], v[84:87], v[148:151]
    ds_read_b64_tr_b16 v[110:111], v2 offset:53056
    s_barrier
    v_mfma_f32_16x16x32_bf16 v[152:155], v[92:95], v[80:83], v[152:155]
    v_add_u32 v3, 64512, v3
    ds_read_b128 v[88:91], v3 offset:0
    s_add_u32 m0, s79, 21504
    s_nop 0
    buffer_load_dwordx4 v10, s[20:23], s77 offen lds
    s_add_u32 m0, s80, 21504
    s_nop 0
    buffer_load_dwordx4 v5, s[24:27], s77 offen lds
    s_add_u32 s77, s77, 458752
    v_mfma_f32_16x16x32_bf16 v[156:159], v[92:95], v[84:87], v[156:159]
    s_add_u32 m0, s81, 21504
    s_nop 0
    buffer_load_dwordx4 v11, s[28:31], s78 offen lds
    s_add_u32 s78, s78, 128
    s_waitcnt lgkmcnt(5)
    v_mfma_f32_16x16x32_bf16 v[160:163], v[96:99], v[80:83], v[160:163]
    ds_read_b128 v[92:95], v3 offset:2048
    v_mfma_f32_16x16x32_bf16 v[164:167], v[96:99], v[84:87], v[164:167]
    v_mfma_f32_16x16x32_bf16 v[168:171], v[100:103], v[80:83], v[168:171]
    ds_read_b128 v[96:99], v3 offset:4096
    v_mfma_f32_16x16x32_bf16 v[172:175], v[100:103], v[84:87], v[172:175]
    s_waitcnt lgkmcnt(3)
    v_mfma_f32_16x16x32_bf16 v[176:179], v[104:107], v[80:83], v[176:179]
    ds_read_b128 v[100:103], v3 offset:6144
    v_mfma_f32_16x16x32_bf16 v[180:183], v[104:107], v[84:87], v[180:183]
    v_mfma_f32_16x16x32_bf16 v[184:187], v[108:111], v[80:83], v[184:187]
    v_add_u32 v2, 64512, v2
    ds_read_b64_tr_b16 v[104:105], v2 offset:0
    v_mfma_f32_16x16x32_bf16 v[188:191], v[108:111], v[84:87], v[188:191]
    ds_read_b64_tr_b16 v[106:107], v2 offset:768
    s_waitcnt vmcnt(17) lgkmcnt(4)
    v_mfma_f32_16x16x32_bf16 v[112:115], v[40:43], v[88:91], v[112:115]
    ds_read_b64_tr_b16 v[108:109], v2 offset:6144
    buffer_load_dwordx4 v[80:83], v1, s[8:11], s76 offen
    buffer_load_dwordx4 v[84:87], v1, s[8:11], s76 offen offset:256
    s_add_u32 s76, s76, 131072
    v_mfma_f32_16x16x32_bf16 v[116:119], v[44:47], v[88:91], v[116:119]
    ds_read_b64_tr_b16 v[110:111], v2 offset:6912
    v_mfma_f32_16x16x32_bf16 v[120:123], v[40:43], v[92:95], v[120:123]
    ds_read_b64_tr_b16 v[88:89], v2 offset:32
    v_mfma_f32_16x16x32_bf16 v[124:127], v[44:47], v[92:95], v[124:127]
    ds_read_b64_tr_b16 v[90:91], v2 offset:800
    s_waitcnt lgkmcnt(6)
    v_mfma_f32_16x16x32_bf16 v[128:131], v[40:43], v[96:99], v[128:131]
    ds_read_b64_tr_b16 v[92:93], v2 offset:6176
    v_mfma_f32_16x16x32_bf16 v[132:135], v[44:47], v[96:99], v[132:135]
    ds_read_b64_tr_b16 v[94:95], v2 offset:6944
    v_mfma_f32_16x16x32_bf16 v[136:139], v[40:43], v[100:103], v[136:139]
    ds_read_b64_tr_b16 v[96:97], v2 offset:64
    v_mfma_f32_16x16x32_bf16 v[140:143], v[44:47], v[100:103], v[140:143]
    ds_read_b64_tr_b16 v[98:99], v2 offset:832
    s_waitcnt lgkmcnt(6)
    v_mfma_f32_16x16x32_bf16 v[144:147], v[104:107], v[40:43], v[144:147]
    ds_read_b64_tr_b16 v[100:101], v2 offset:6208
    v_mfma_f32_16x16x32_bf16 v[148:151], v[104:107], v[44:47], v[148:151]
    ds_read_b64_tr_b16 v[102:103], v2 offset:6976
    v_mfma_f32_16x16x32_bf16 v[152:155], v[108:111], v[40:43], v[152:155]
    v_add_u32 v4, 64512, v4
    ds_read_b128 v[104:107], v4 offset:0
    v_mfma_f32_16x16x32_bf16 v[156:159], v[108:111], v[44:47], v[156:159]
    s_waitcnt lgkmcnt(5)
    v_mfma_f32_16x16x32_bf16 v[160:163], v[88:91], v[40:43], v[160:163]
    ds_read_b128 v[108:111], v4 offset:2048
    v_mfma_f32_16x16x32_bf16 v[164:167], v[88:91], v[44:47], v[164:167]
    v_mfma_f32_16x16x32_bf16 v[168:171], v[92:95], v[40:43], v[168:171]
    ds_read_b128 v[88:91], v4 offset:4096
    v_mfma_f32_16x16x32_bf16 v[172:175], v[92:95], v[44:47], v[172:175]
    s_waitcnt lgkmcnt(3)
    v_mfma_f32_16x16x32_bf16 v[176:179], v[96:99], v[40:43], v[176:179]
    ds_read_b128 v[92:95], v4 offset:6144
    v_mfma_f32_16x16x32_bf16 v[180:183], v[96:99], v[44:47], v[180:183]
    v_mfma_f32_16x16x32_bf16 v[184:187], v[100:103], v[40:43], v[184:187]
    ds_read_b64_tr_b16 v[96:97], v2 offset:3072
    v_mfma_f32_16x16x32_bf16 v[188:191], v[100:103], v[44:47], v[188:191]
    ds_read_b64_tr_b16 v[98:99], v2 offset:3840
    s_waitcnt vmcnt(14) lgkmcnt(4)
    v_mfma_f32_16x16x32_bf16 v[112:115], v[48:51], v[104:107], v[112:115]
    ds_read_b64_tr_b16 v[100:101], v2 offset:9216
    buffer_load_dwordx4 v[40:43], v1, s[8:11], s76 offen
    buffer_load_dwordx4 v[44:47], v1, s[8:11], s76 offen offset:256
    s_add_u32 s76, s76, 131072
    v_mfma_f32_16x16x32_bf16 v[116:119], v[52:55], v[104:107], v[116:119]
    ds_read_b64_tr_b16 v[102:103], v2 offset:9984
    v_mfma_f32_16x16x32_bf16 v[120:123], v[48:51], v[108:111], v[120:123]
    ds_read_b64_tr_b16 v[104:105], v2 offset:3104
    v_mfma_f32_16x16x32_bf16 v[124:127], v[52:55], v[108:111], v[124:127]
    ds_read_b64_tr_b16 v[106:107], v2 offset:3872
    s_waitcnt lgkmcnt(6)
    v_mfma_f32_16x16x32_bf16 v[128:131], v[48:51], v[88:91], v[128:131]
    ds_read_b64_tr_b16 v[108:109], v2 offset:9248
    v_mfma_f32_16x16x32_bf16 v[132:135], v[52:55], v[88:91], v[132:135]
    ds_read_b64_tr_b16 v[110:111], v2 offset:10016
    v_mfma_f32_16x16x32_bf16 v[136:139], v[48:51], v[92:95], v[136:139]
    ds_read_b64_tr_b16 v[88:89], v2 offset:3136
    v_mfma_f32_16x16x32_bf16 v[140:143], v[52:55], v[92:95], v[140:143]
    ds_read_b64_tr_b16 v[90:91], v2 offset:3904
    s_waitcnt lgkmcnt(6)
    v_mfma_f32_16x16x32_bf16 v[144:147], v[96:99], v[48:51], v[144:147]
    ds_read_b64_tr_b16 v[92:93], v2 offset:9280
    v_mfma_f32_16x16x32_bf16 v[148:151], v[96:99], v[52:55], v[148:151]
    ds_read_b64_tr_b16 v[94:95], v2 offset:10048
    s_barrier
    v_mfma_f32_16x16x32_bf16 v[152:155], v[100:103], v[48:51], v[152:155]
    ds_read_b128 v[96:99], v3 offset:21504
    s_add_u32 m0, s79, 43008
    s_nop 0
    buffer_load_dwordx4 v10, s[20:23], s77 offen lds
    s_add_u32 m0, s80, 43008
    s_nop 0
    buffer_load_dwordx4 v5, s[24:27], s77 offen lds
    s_add_u32 s77, s77, 458752
    v_mfma_f32_16x16x32_bf16 v[156:159], v[100:103], v[52:55], v[156:159]
    s_add_u32 m0, s81, 43008
    s_nop 0
    buffer_load_dwordx4 v11, s[28:31], s78 offen lds
    s_add_u32 s78, s78, 128
    s_waitcnt lgkmcnt(5)
    v_mfma_f32_16x16x32_bf16 v[160:163], v[104:107], v[48:51], v[160:163]
    ds_read_b128 v[100:103], v3 offset:23552
    v_mfma_f32_16x16x32_bf16 v[164:167], v[104:107], v[52:55], v[164:167]
    v_mfma_f32_16x16x32_bf16 v[168:171], v[108:111], v[48:51], v[168:171]
    ds_read_b128 v[104:107], v3 offset:25600
    v_mfma_f32_16x16x32_bf16 v[172:175], v[108:111], v[52:55], v[172:175]
    s_waitcnt lgkmcnt(3)
    v_mfma_f32_16x16x32_bf16 v[176:179], v[88:91], v[48:51], v[176:179]
    ds_read_b128 v[108:111], v3 offset:27648
    v_mfma_f32_16x16x32_bf16 v[180:183], v[88:91], v[52:55], v[180:183]
    v_mfma_f32_16x16x32_bf16 v[184:187], v[92:95], v[48:51], v[184:187]
    ds_read_b64_tr_b16 v[88:89], v2 offset:21504
    v_mfma_f32_16x16x32_bf16 v[188:191], v[92:95], v[52:55], v[188:191]
    ds_read_b64_tr_b16 v[90:91], v2 offset:22272
    s_waitcnt vmcnt(17) lgkmcnt(4)
    v_mfma_f32_16x16x32_bf16 v[112:115], v[56:59], v[96:99], v[112:115]
    ds_read_b64_tr_b16 v[92:93], v2 offset:27648
    buffer_load_dwordx4 v[48:51], v1, s[8:11], s76 offen
    buffer_load_dwordx4 v[52:55], v1, s[8:11], s76 offen offset:256
    s_add_u32 s76, s76, 131072
    v_mfma_f32_16x16x32_bf16 v[116:119], v[60:63], v[96:99], v[116:119]
    ds_read_b64_tr_b16 v[94:95], v2 offset:28416
    v_mfma_f32_16x16x32_bf16 v[120:123], v[56:59], v[100:103], v[120:123]
    ds_read_b64_tr_b16 v[96:97], v2 offset:21536
    v_mfma_f32_16x16x32_bf16 v[124:127], v[60:63], v[100:103], v[124:127]
    ds_read_b64_tr_b16 v[98:99], v2 offset:22304
    s_waitcnt lgkmcnt(6)
    v_mfma_f32_16x16x32_bf16 v[128:131], v[56:59], v[104:107], v[128:131]
    ds_read_b64_tr_b16 v[100:101], v2 offset:27680
    v_mfma_f32_16x16x32_bf16 v[132:135], v[60:63], v[104:107], v[132:135]
    ds_read_b64_tr_b16 v[102:103], v2 offset:28448
    v_mfma_f32_16x16x32_bf16 v[136:139], v[56:59], v[108:111], v[136:139]
    ds_read_b64_tr_b16 v[104:105], v2 offset:21568
    v_mfma_f32_16x16x32_bf16 v[140:143], v[60:63], v[108:111], v[140:143]
    ds_read_b64_tr_b16 v[106:107], v2 offset:22336
    s_waitcnt lgkmcnt(6)
    v_mfma_f32_16x16x32_bf16 v[144:147], v[88:91], v[56:59], v[144:147]
    ds_read_b64_tr_b16 v[108:109], v2 offset:27712
    v_mfma_f32_16x16x32_bf16 v[148:151], v[88:91], v[60:63], v[148:151]
    ds_read_b64_tr_b16 v[110:111], v2 offset:28480
    v_mfma_f32_16x16x32_bf16 v[152:155], v[92:95], v[56:59], v[152:155]
    ds_read_b128 v[88:91], v4 offset:21504
    v_mfma_f32_16x16x32_bf16 v[156:159], v[92:95], v[60:63], v[156:159]
    s_waitcnt lgkmcnt(5)
    v_mfma_f32_16x16x32_bf16 v[160:163], v[96:99], v[56:59], v[160:163]
    ds_read_b128 v[92:95], v4 offset:23552
    v_mfma_f32_16x16x32_bf16 v[164:167], v[96:99], v[60:63], v[164:167]
    v_mfma_f32_16x16x32_bf16 v[168:171], v[100:103], v[56:59], v[168:171]
    ds_read_b128 v[96:99], v4 offset:25600
    v_mfma_f32_16x16x32_bf16 v[172:175], v[100:103], v[60:63], v[172:175]
    s_waitcnt lgkmcnt(3)
    v_mfma_f32_16x16x32_bf16 v[176:179], v[104:107], v[56:59], v[176:179]
    ds_read_b128 v[100:103], v4 offset:27648
    v_mfma_f32_16x16x32_bf16 v[180:183], v[104:107], v[60:63], v[180:183]
    v_mfma_f32_16x16x32_bf16 v[184:187], v[108:111], v[56:59], v[184:187]
    ds_read_b64_tr_b16 v[104:105], v2 offset:24576
    v_mfma_f32_16x16x32_bf16 v[188:191], v[108:111], v[60:63], v[188:191]
    ds_read_b64_tr_b16 v[106:107], v2 offset:25344
    s_waitcnt vmcnt(14) lgkmcnt(4)
    v_mfma_f32_16x16x32_bf16 v[112:115], v[64:67], v[88:91], v[112:115]
    ds_read_b64_tr_b16 v[108:109], v2 offset:30720
    buffer_load_dwordx4 v[56:59], v1, s[8:11], s76 offen
    buffer_load_dwordx4 v[60:63], v1, s[8:11], s76 offen offset:256
    s_add_u32 s76, s76, 131072
    v_mfma_f32_16x16x32_bf16 v[116:119], v[68:71], v[88:91], v[116:119]
    ds_read_b64_tr_b16 v[110:111], v2 offset:31488
    v_mfma_f32_16x16x32_bf16 v[120:123], v[64:67], v[92:95], v[120:123]
    ds_read_b64_tr_b16 v[88:89], v2 offset:24608
    v_mfma_f32_16x16x32_bf16 v[124:127], v[68:71], v[92:95], v[124:127]
    ds_read_b64_tr_b16 v[90:91], v2 offset:25376
    s_waitcnt lgkmcnt(6)
    v_mfma_f32_16x16x32_bf16 v[128:131], v[64:67], v[96:99], v[128:131]
    ds_read_b64_tr_b16 v[92:93], v2 offset:30752
    v_mfma_f32_16x16x32_bf16 v[132:135], v[68:71], v[96:99], v[132:135]
    ds_read_b64_tr_b16 v[94:95], v2 offset:31520
    v_mfma_f32_16x16x32_bf16 v[136:139], v[64:67], v[100:103], v[136:139]
    ds_read_b64_tr_b16 v[96:97], v2 offset:24640
    v_mfma_f32_16x16x32_bf16 v[140:143], v[68:71], v[100:103], v[140:143]
    ds_read_b64_tr_b16 v[98:99], v2 offset:25408
    s_waitcnt lgkmcnt(6)
    v_mfma_f32_16x16x32_bf16 v[144:147], v[104:107], v[64:67], v[144:147]
    ds_read_b64_tr_b16 v[100:101], v2 offset:30784
    v_mfma_f32_16x16x32_bf16 v[148:151], v[104:107], v[68:71], v[148:151]
    ds_read_b64_tr_b16 v[102:103], v2 offset:31552
    s_barrier
    v_mfma_f32_16x16x32_bf16 v[152:155], v[108:111], v[64:67], v[152:155]
    ds_read_b128 v[104:107], v3 offset:43008
    s_add_u32 m0, s79, 64512
    s_nop 0
    buffer_load_dwordx4 v10, s[20:23], s77 offen lds
    s_add_u32 m0, s80, 64512
    s_nop 0
    buffer_load_dwordx4 v5, s[24:27], s77 offen lds
    s_add_u32 s77, s77, 458752
    v_mfma_f32_16x16x32_bf16 v[156:159], v[108:111], v[68:71], v[156:159]
    s_add_u32 m0, s81, 64512
    s_nop 0
    buffer_load_dwordx4 v11, s[28:31], s78 offen lds
    s_add_u32 s78, s78, 128
    s_waitcnt lgkmcnt(5)
    v_mfma_f32_16x16x32_bf16 v[160:163], v[88:91], v[64:67], v[160:163]
    ds_read_b128 v[108:111], v3 offset:45056
    v_mfma_f32_16x16x32_bf16 v[164:167], v[88:91], v[68:71], v[164:167]
    v_mfma_f32_16x16x32_bf16 v[168:171], v[92:95], v[64:67], v[168:171]
    ds_read_b128 v[88:91], v3 offset:47104
    v_mfma_f32_16x16x32_bf16 v[172:175], v[92:95], v[68:71], v[172:175]
    s_waitcnt lgkmcnt(3)
    v_mfma_f32_16x16x32_bf16 v[176:179], v[96:99], v[64:67], v[176:179]
    ds_read_b128 v[92:95], v3 offset:49152
    v_mfma_f32_16x16x32_bf16 v[180:183], v[96:99], v[68:71], v[180:183]
    v_mfma_f32_16x16x32_bf16 v[184:187], v[100:103], v[64:67], v[184:187]
    ds_read_b64_tr_b16 v[96:97], v2 offset:43008
    v_mfma_f32_16x16x32_bf16 v[188:191], v[100:103], v[68:71], v[188:191]
    ds_read_b64_tr_b16 v[98:99], v2 offset:43776
    s_waitcnt vmcnt(17) lgkmcnt(4)
    v_mfma_f32_16x16x32_bf16 v[112:115], v[72:75], v[104:107], v[112:115]
    ds_read_b64_tr_b16 v[100:101], v2 offset:49152
    buffer_load_dwordx4 v[64:67], v1, s[8:11], s76 offen
    buffer_load_dwordx4 v[68:71], v1, s[8:11], s76 offen offset:256
    s_add_u32 s76, s76, 131072
    v_mfma_f32_16x16x32_bf16 v[116:119], v[76:79], v[104:107], v[116:119]
    ds_read_b64_tr_b16 v[102:103], v2 offset:49920
    v_mfma_f32_16x16x32_bf16 v[120:123], v[72:75], v[108:111], v[120:123]
    ds_read_b64_tr_b16 v[104:105], v2 offset:43040
    v_mfma_f32_16x16x32_bf16 v[124:127], v[76:79], v[108:111], v[124:127]
    ds_read_b64_tr_b16 v[106:107], v2 offset:43808
    s_waitcnt lgkmcnt(6)
    v_mfma_f32_16x16x32_bf16 v[128:131], v[72:75], v[88:91], v[128:131]
    ds_read_b64_tr_b16 v[108:109], v2 offset:49184
    v_mfma_f32_16x16x32_bf16 v[132:135], v[76:79], v[88:91], v[132:135]
    ds_read_b64_tr_b16 v[110:111], v2 offset:49952
    v_mfma_f32_16x16x32_bf16 v[136:139], v[72:75], v[92:95], v[136:139]
    ds_read_b64_tr_b16 v[88:89], v2 offset:43072
    v_mfma_f32_16x16x32_bf16 v[140:143], v[76:79], v[92:95], v[140:143]
    ds_read_b64_tr_b16 v[90:91], v2 offset:43840
    s_waitcnt lgkmcnt(6)
    v_mfma_f32_16x16x32_bf16 v[144:147], v[96:99], v[72:75], v[144:147]
    ds_read_b64_tr_b16 v[92:93], v2 offset:49216
    v_mfma_f32_16x16x32_bf16 v[148:151], v[96:99], v[76:79], v[148:151]
    ds_read_b64_tr_b16 v[94:95], v2 offset:49984
    v_mfma_f32_16x16x32_bf16 v[152:155], v[100:103], v[72:75], v[152:155]
    ds_read_b128 v[96:99], v4 offset:43008
    v_mfma_f32_16x16x32_bf16 v[156:159], v[100:103], v[76:79], v[156:159]
    s_waitcnt lgkmcnt(5)
    v_mfma_f32_16x16x32_bf16 v[160:163], v[104:107], v[72:75], v[160:163]
    ds_read_b128 v[100:103], v4 offset:45056
    v_mfma_f32_16x16x32_bf16 v[164:167], v[104:107], v[76:79], v[164:167]
    v_mfma_f32_16x16x32_bf16 v[168:171], v[108:111], v[72:75], v[168:171]
    ds_read_b128 v[104:107], v4 offset:47104
    v_mfma_f32_16x16x32_bf16 v[172:175], v[108:111], v[76:79], v[172:175]
    s_waitcnt lgkmcnt(3)
    v_mfma_f32_16x16x32_bf16 v[176:179], v[88:91], v[72:75], v[176:179]
    ds_read_b128 v[108:111], v4 offset:49152
    v_mfma_f32_16x16x32_bf16 v[180:183], v[88:91], v[76:79], v[180:183]
    v_mfma_f32_16x16x32_bf16 v[184:187], v[92:95], v[72:75], v[184:187]
    ds_read_b64_tr_b16 v[88:89], v2 offset:46080
    v_mfma_f32_16x16x32_bf16 v[188:191], v[92:95], v[76:79], v[188:191]
    ds_read_b64_tr_b16 v[90:91], v2 offset:46848
    s_waitcnt vmcnt(14) lgkmcnt(4)
    v_mfma_f32_16x16x32_bf16 v[112:115], v[80:83], v[96:99], v[112:115]
    ds_read_b64_tr_b16 v[92:93], v2 offset:52224
    buffer_load_dwordx4 v[72:75], v1, s[8:11], s76 offen
    buffer_load_dwordx4 v[76:79], v1, s[8:11], s76 offen offset:256
    s_add_u32 s76, s76, 131072
    v_mfma_f32_16x16x32_bf16 v[116:119], v[84:87], v[96:99], v[116:119]
    ds_read_b64_tr_b16 v[94:95], v2 offset:52992
    v_mfma_f32_16x16x32_bf16 v[120:123], v[80:83], v[100:103], v[120:123]
    ds_read_b64_tr_b16 v[96:97], v2 offset:46112
    v_mfma_f32_16x16x32_bf16 v[124:127], v[84:87], v[100:103], v[124:127]
    ds_read_b64_tr_b16 v[98:99], v2 offset:46880
    s_waitcnt lgkmcnt(6)
    v_mfma_f32_16x16x32_bf16 v[128:131], v[80:83], v[104:107], v[128:131]
    ds_read_b64_tr_b16 v[100:101], v2 offset:52256
    v_mfma_f32_16x16x32_bf16 v[132:135], v[84:87], v[104:107], v[132:135]
    ds_read_b64_tr_b16 v[102:103], v2 offset:53024
    v_mfma_f32_16x16x32_bf16 v[136:139], v[80:83], v[108:111], v[136:139]
    ds_read_b64_tr_b16 v[104:105], v2 offset:46144
    v_mfma_f32_16x16x32_bf16 v[140:143], v[84:87], v[108:111], v[140:143]
    ds_read_b64_tr_b16 v[106:107], v2 offset:46912
    s_waitcnt lgkmcnt(6)
    v_mfma_f32_16x16x32_bf16 v[144:147], v[88:91], v[80:83], v[144:147]
    ds_read_b64_tr_b16 v[108:109], v2 offset:52288
    v_mfma_f32_16x16x32_bf16 v[148:151], v[88:91], v[84:87], v[148:151]
    ds_read_b64_tr_b16 v[110:111], v2 offset:53056
    s_barrier
    v_mfma_f32_16x16x32_bf16 v[152:155], v[92:95], v[80:83], v[152:155]
    v_subrev_u32 v3, 64512, v3
    ds_read_b128 v[88:91], v3 offset:0
    s_add_u32 s77, s87, 6881280
    s_add_u32 m0, s79, 86016
    s_nop 0
    buffer_load_dwordx4 v36, s[12:15], s77 offen lds
    s_add_u32 m0, s79, 94208
    s_nop 0
    buffer_load_dwordx4 v36, s[16:19], s77 offen lds
    s_sub_u32 s77, s77, 458752
    v_mfma_f32_16x16x32_bf16 v[156:159], v[92:95], v[84:87], v[156:159]
    s_waitcnt lgkmcnt(5)
    v_mfma_f32_16x16x32_bf16 v[160:163], v[96:99], v[80:83], v[160:163]
    ds_read_b128 v[92:95], v3 offset:2048
    v_mfma_f32_16x16x32_bf16 v[164:167], v[96:99], v[84:87], v[164:167]
    v_mfma_f32_16x16x32_bf16 v[168:171], v[100:103], v[80:83], v[168:171]
    ds_read_b128 v[96:99], v3 offset:4096
    v_mfma_f32_16x16x32_bf16 v[172:175], v[100:103], v[84:87], v[172:175]
    s_waitcnt lgkmcnt(3)
    v_mfma_f32_16x16x32_bf16 v[176:179], v[104:107], v[80:83], v[176:179]
    ds_read_b128 v[100:103], v3 offset:6144
    v_mfma_f32_16x16x32_bf16 v[180:183], v[104:107], v[84:87], v[180:183]
    v_mfma_f32_16x16x32_bf16 v[184:187], v[108:111], v[80:83], v[184:187]
    v_subrev_u32 v2, 64512, v2
    ds_read_b64_tr_b16 v[104:105], v2 offset:0
    v_mfma_f32_16x16x32_bf16 v[188:191], v[108:111], v[84:87], v[188:191]
    ds_read_b64_tr_b16 v[106:107], v2 offset:768
    s_waitcnt vmcnt(16) lgkmcnt(4)
    v_mfma_f32_16x16x32_bf16 v[112:115], v[40:43], v[88:91], v[112:115]
    ds_read_b64_tr_b16 v[108:109], v2 offset:6144
    buffer_load_dwordx4 v[80:83], v1, s[8:11], s76 offen
    buffer_load_dwordx4 v[84:87], v1, s[8:11], s76 offen offset:256
    s_add_u32 s76, s76, 131072
    v_mfma_f32_16x16x32_bf16 v[116:119], v[44:47], v[88:91], v[116:119]
    ds_read_b64_tr_b16 v[110:111], v2 offset:6912
    v_mfma_f32_16x16x32_bf16 v[120:123], v[40:43], v[92:95], v[120:123]
    ds_read_b64_tr_b16 v[88:89], v2 offset:32
    v_mfma_f32_16x16x32_bf16 v[124:127], v[44:47], v[92:95], v[124:127]
    ds_read_b64_tr_b16 v[90:91], v2 offset:800
    s_waitcnt lgkmcnt(6)
    v_mfma_f32_16x16x32_bf16 v[128:131], v[40:43], v[96:99], v[128:131]
    ds_read_b64_tr_b16 v[92:93], v2 offset:6176
    v_mfma_f32_16x16x32_bf16 v[132:135], v[44:47], v[96:99], v[132:135]
    ds_read_b64_tr_b16 v[94:95], v2 offset:6944
    v_mfma_f32_16x16x32_bf16 v[136:139], v[40:43], v[100:103], v[136:139]
    ds_read_b64_tr_b16 v[96:97], v2 offset:64
    v_mfma_f32_16x16x32_bf16 v[140:143], v[44:47], v[100:103], v[140:143]
    ds_read_b64_tr_b16 v[98:99], v2 offset:832
    s_waitcnt lgkmcnt(6)
    v_mfma_f32_16x16x32_bf16 v[144:147], v[104:107], v[40:43], v[144:147]
    ds_read_b64_tr_b16 v[100:101], v2 offset:6208
    v_mfma_f32_16x16x32_bf16 v[148:151], v[104:107], v[44:47], v[148:151]
    ds_read_b64_tr_b16 v[102:103], v2 offset:6976
    v_mfma_f32_16x16x32_bf16 v[152:155], v[108:111], v[40:43], v[152:155]
    v_subrev_u32 v4, 64512, v4
    ds_read_b128 v[104:107], v4 offset:0
    v_mfma_f32_16x16x32_bf16 v[156:159], v[108:111], v[44:47], v[156:159]
    s_waitcnt lgkmcnt(5)
    v_mfma_f32_16x16x32_bf16 v[160:163], v[88:91], v[40:43], v[160:163]
    ds_read_b128 v[108:111], v4 offset:2048
    v_mfma_f32_16x16x32_bf16 v[164:167], v[88:91], v[44:47], v[164:167]
    v_mfma_f32_16x16x32_bf16 v[168:171], v[92:95], v[40:43], v[168:171]
    ds_read_b128 v[88:91], v4 offset:4096
    v_mfma_f32_16x16x32_bf16 v[172:175], v[92:95], v[44:47], v[172:175]
    s_waitcnt lgkmcnt(3)
    v_mfma_f32_16x16x32_bf16 v[176:179], v[96:99], v[40:43], v[176:179]
    ds_read_b128 v[92:95], v4 offset:6144
    v_mfma_f32_16x16x32_bf16 v[180:183], v[96:99], v[44:47], v[180:183]
    v_mfma_f32_16x16x32_bf16 v[184:187], v[100:103], v[40:43], v[184:187]
    ds_read_b64_tr_b16 v[96:97], v2 offset:3072
    v_mfma_f32_16x16x32_bf16 v[188:191], v[100:103], v[44:47], v[188:191]
    ds_read_b64_tr_b16 v[98:99], v2 offset:3840
    s_waitcnt vmcnt(13) lgkmcnt(4)
    v_mfma_f32_16x16x32_bf16 v[112:115], v[48:51], v[104:107], v[112:115]
    ds_read_b64_tr_b16 v[100:101], v2 offset:9216
    buffer_load_dwordx4 v[40:43], v1, s[8:11], s76 offen
    buffer_load_dwordx4 v[44:47], v1, s[8:11], s76 offen offset:256
    s_add_u32 s76, s76, 131072
    v_mfma_f32_16x16x32_bf16 v[116:119], v[52:55], v[104:107], v[116:119]
    ds_read_b64_tr_b16 v[102:103], v2 offset:9984
    v_mfma_f32_16x16x32_bf16 v[120:123], v[48:51], v[108:111], v[120:123]
    ds_read_b64_tr_b16 v[104:105], v2 offset:3104
    v_mfma_f32_16x16x32_bf16 v[124:127], v[52:55], v[108:111], v[124:127]
    ds_read_b64_tr_b16 v[106:107], v2 offset:3872
    s_waitcnt lgkmcnt(6)
    v_mfma_f32_16x16x32_bf16 v[128:131], v[48:51], v[88:91], v[128:131]
    ds_read_b64_tr_b16 v[108:109], v2 offset:9248
    v_mfma_f32_16x16x32_bf16 v[132:135], v[52:55], v[88:91], v[132:135]
    ds_read_b64_tr_b16 v[110:111], v2 offset:10016
    v_mfma_f32_16x16x32_bf16 v[136:139], v[48:51], v[92:95], v[136:139]
    ds_read_b64_tr_b16 v[88:89], v2 offset:3136
    v_mfma_f32_16x16x32_bf16 v[140:143], v[52:55], v[92:95], v[140:143]
    ds_read_b64_tr_b16 v[90:91], v2 offset:3904
    s_waitcnt lgkmcnt(6)
    v_mfma_f32_16x16x32_bf16 v[144:147], v[96:99], v[48:51], v[144:147]
    ds_read_b64_tr_b16 v[92:93], v2 offset:9280
    v_mfma_f32_16x16x32_bf16 v[148:151], v[96:99], v[52:55], v[148:151]
    ds_read_b64_tr_b16 v[94:95], v2 offset:10048
    s_barrier
    v_mfma_f32_16x16x32_bf16 v[152:155], v[100:103], v[48:51], v[152:155]
    ds_read_b128 v[96:99], v3 offset:21504
    s_add_u32 m0, s79, 107520
    s_nop 0
    buffer_load_dwordx4 v36, s[12:15], s77 offen lds
    s_add_u32 m0, s79, 115712
    s_nop 0
    buffer_load_dwordx4 v36, s[16:19], s77 offen lds
    s_sub_u32 s77, s77, 458752
    v_mfma_f32_16x16x32_bf16 v[156:159], v[100:103], v[52:55], v[156:159]
    s_waitcnt lgkmcnt(5)
    v_mfma_f32_16x16x32_bf16 v[160:163], v[104:107], v[48:51], v[160:163]
    ds_read_b128 v[100:103], v3 offset:23552
    v_mfma_f32_16x16x32_bf16 v[164:167], v[104:107], v[52:55], v[164:167]
    v_mfma_f32_16x16x32_bf16 v[168:171], v[108:111], v[48:51], v[168:171]
    ds_read_b128 v[104:107], v3 offset:25600
    v_mfma_f32_16x16x32_bf16 v[172:175], v[108:111], v[52:55], v[172:175]
    s_waitcnt lgkmcnt(3)
    v_mfma_f32_16x16x32_bf16 v[176:179], v[88:91], v[48:51], v[176:179]
    ds_read_b128 v[108:111], v3 offset:27648
    v_mfma_f32_16x16x32_bf16 v[180:183], v[88:91], v[52:55], v[180:183]
    v_mfma_f32_16x16x32_bf16 v[184:187], v[92:95], v[48:51], v[184:187]
    ds_read_b64_tr_b16 v[88:89], v2 offset:21504
    v_mfma_f32_16x16x32_bf16 v[188:191], v[92:95], v[52:55], v[188:191]
    ds_read_b64_tr_b16 v[90:91], v2 offset:22272
    s_waitcnt vmcnt(15) lgkmcnt(4)
    v_mfma_f32_16x16x32_bf16 v[112:115], v[56:59], v[96:99], v[112:115]
    ds_read_b64_tr_b16 v[92:93], v2 offset:27648
    buffer_load_dwordx4 v[48:51], v1, s[8:11], s76 offen
    buffer_load_dwordx4 v[52:55], v1, s[8:11], s76 offen offset:256
    s_add_u32 s76, s6, 3276800
    v_mfma_f32_16x16x32_bf16 v[116:119], v[60:63], v[96:99], v[116:119]
    ds_read_b64_tr_b16 v[94:95], v2 offset:28416
    v_mfma_f32_16x16x32_bf16 v[120:123], v[56:59], v[100:103], v[120:123]
    ds_read_b64_tr_b16 v[96:97], v2 offset:21536
    v_mfma_f32_16x16x32_bf16 v[124:127], v[60:63], v[100:103], v[124:127]
    ds_read_b64_tr_b16 v[98:99], v2 offset:22304
    s_waitcnt lgkmcnt(6)
    v_mfma_f32_16x16x32_bf16 v[128:131], v[56:59], v[104:107], v[128:131]
    ds_read_b64_tr_b16 v[100:101], v2 offset:27680
    v_mfma_f32_16x16x32_bf16 v[132:135], v[60:63], v[104:107], v[132:135]
    ds_read_b64_tr_b16 v[102:103], v2 offset:28448
    v_mfma_f32_16x16x32_bf16 v[136:139], v[56:59], v[108:111], v[136:139]
    ds_read_b64_tr_b16 v[104:105], v2 offset:21568
    v_mfma_f32_16x16x32_bf16 v[140:143], v[60:63], v[108:111], v[140:143]
    ds_read_b64_tr_b16 v[106:107], v2 offset:22336
    s_waitcnt lgkmcnt(6)
    v_mfma_f32_16x16x32_bf16 v[144:147], v[88:91], v[56:59], v[144:147]
    ds_read_b64_tr_b16 v[108:109], v2 offset:27712
    v_mfma_f32_16x16x32_bf16 v[148:151], v[88:91], v[60:63], v[148:151]
    ds_read_b64_tr_b16 v[110:111], v2 offset:28480
    v_mfma_f32_16x16x32_bf16 v[152:155], v[92:95], v[56:59], v[152:155]
    ds_read_b128 v[88:91], v4 offset:21504
    v_mfma_f32_16x16x32_bf16 v[156:159], v[92:95], v[60:63], v[156:159]
    s_waitcnt lgkmcnt(5)
    v_mfma_f32_16x16x32_bf16 v[160:163], v[96:99], v[56:59], v[160:163]
    ds_read_b128 v[92:95], v4 offset:23552
    v_mfma_f32_16x16x32_bf16 v[164:167], v[96:99], v[60:63], v[164:167]
    v_mfma_f32_16x16x32_bf16 v[168:171], v[100:103], v[56:59], v[168:171]
    ds_read_b128 v[96:99], v4 offset:25600
    v_mfma_f32_16x16x32_bf16 v[172:175], v[100:103], v[60:63], v[172:175]
    s_waitcnt lgkmcnt(3)
    v_mfma_f32_16x16x32_bf16 v[176:179], v[104:107], v[56:59], v[176:179]
    ds_read_b128 v[100:103], v4 offset:27648
    v_mfma_f32_16x16x32_bf16 v[180:183], v[104:107], v[60:63], v[180:183]
    v_mfma_f32_16x16x32_bf16 v[184:187], v[108:111], v[56:59], v[184:187]
    ds_read_b64_tr_b16 v[104:105], v2 offset:24576
    v_mfma_f32_16x16x32_bf16 v[188:191], v[108:111], v[60:63], v[188:191]
    ds_read_b64_tr_b16 v[106:107], v2 offset:25344
    s_waitcnt vmcnt(12) lgkmcnt(4)
    v_mfma_f32_16x16x32_bf16 v[112:115], v[64:67], v[88:91], v[112:115]
    ds_read_b64_tr_b16 v[108:109], v2 offset:30720
    v_mfma_f32_16x16x32_bf16 v[116:119], v[68:71], v[88:91], v[116:119]
    ds_read_b64_tr_b16 v[110:111], v2 offset:31488
    v_mfma_f32_16x16x32_bf16 v[120:123], v[64:67], v[92:95], v[120:123]
    ds_read_b64_tr_b16 v[88:89], v2 offset:24608
    v_mfma_f32_16x16x32_bf16 v[124:127], v[68:71], v[92:95], v[124:127]
    ds_read_b64_tr_b16 v[90:91], v2 offset:25376
    s_waitcnt lgkmcnt(6)
    v_mfma_f32_16x16x32_bf16 v[128:131], v[64:67], v[96:99], v[128:131]
    ds_read_b64_tr_b16 v[92:93], v2 offset:30752
    v_mfma_f32_16x16x32_bf16 v[132:135], v[68:71], v[96:99], v[132:135]
    ds_read_b64_tr_b16 v[94:95], v2 offset:31520
    v_mfma_f32_16x16x32_bf16 v[136:139], v[64:67], v[100:103], v[136:139]
    ds_read_b64_tr_b16 v[96:97], v2 offset:24640
    v_mfma_f32_16x16x32_bf16 v[140:143], v[68:71], v[100:103], v[140:143]
    ds_read_b64_tr_b16 v[98:99], v2 offset:25408
    s_waitcnt lgkmcnt(6)
    v_mfma_f32_16x16x32_bf16 v[144:147], v[104:107], v[64:67], v[144:147]
    ds_read_b64_tr_b16 v[100:101], v2 offset:30784
    v_mfma_f32_16x16x32_bf16 v[148:151], v[104:107], v[68:71], v[148:151]
    ds_read_b64_tr_b16 v[102:103], v2 offset:31552
    s_barrier
    v_mfma_f32_16x16x32_bf16 v[152:155], v[108:111], v[64:67], v[152:155]
    ds_read_b128 v[104:107], v3 offset:43008
    s_add_u32 m0, s79, 0
    s_nop 0
    buffer_load_dwordx4 v36, s[12:15], s77 offen lds
    s_add_u32 m0, s79, 8192
    s_nop 0
    buffer_load_dwordx4 v36, s[16:19], s77 offen lds
    s_sub_u32 s77, s77, 458752
    v_mfma_f32_16x16x32_bf16 v[156:159], v[108:111], v[68:71], v[156:159]
    s_waitcnt lgkmcnt(5)
    v_mfma_f32_16x16x32_bf16 v[160:163], v[88:91], v[64:67], v[160:163]
    ds_read_b128 v[108:111], v3 offset:45056
    v_mfma_f32_16x16x32_bf16 v[164:167], v[88:91], v[68:71], v[164:167]
    v_mfma_f32_16x16x32_bf16 v[168:171], v[92:95], v[64:67], v[168:171]
    ds_read_b128 v[88:91], v3 offset:47104
    v_mfma_f32_16x16x32_bf16 v[172:175], v[92:95], v[68:71], v[172:175]
    s_waitcnt lgkmcnt(3)
    v_mfma_f32_16x16x32_bf16 v[176:179], v[96:99], v[64:67], v[176:179]
    ds_read_b128 v[92:95], v3 offset:49152
    v_mfma_f32_16x16x32_bf16 v[180:183], v[96:99], v[68:71], v[180:183]
    v_mfma_f32_16x16x32_bf16 v[184:187], v[100:103], v[64:67], v[184:187]
    ds_read_b64_tr_b16 v[96:97], v2 offset:43008
    v_mfma_f32_16x16x32_bf16 v[188:191], v[100:103], v[68:71], v[188:191]
    ds_read_b64_tr_b16 v[98:99], v2 offset:43776
    s_waitcnt vmcnt(12) lgkmcnt(4)
    v_mfma_f32_16x16x32_bf16 v[112:115], v[72:75], v[104:107], v[112:115]
    ds_read_b64_tr_b16 v[100:101], v2 offset:49152
    buffer_load_dword v255, v254, s[60:63], s68 offen offset:0
    v_mfma_f32_16x16x32_bf16 v[116:119], v[76:79], v[104:107], v[116:119]
    ds_read_b64_tr_b16 v[102:103], v2 offset:49920
    v_mfma_f32_16x16x32_bf16 v[120:123], v[72:75], v[108:111], v[120:123]
    ds_read_b64_tr_b16 v[104:105], v2 offset:43040
    v_mfma_f32_16x16x32_bf16 v[124:127], v[76:79], v[108:111], v[124:127]
    ds_read_b64_tr_b16 v[106:107], v2 offset:43808
    s_waitcnt lgkmcnt(6)
    v_mfma_f32_16x16x32_bf16 v[128:131], v[72:75], v[88:91], v[128:131]
    ds_read_b64_tr_b16 v[108:109], v2 offset:49184
    v_mfma_f32_16x16x32_bf16 v[132:135], v[76:79], v[88:91], v[132:135]
    ds_read_b64_tr_b16 v[110:111], v2 offset:49952
    v_mfma_f32_16x16x32_bf16 v[136:139], v[72:75], v[92:95], v[136:139]
    ds_read_b64_tr_b16 v[88:89], v2 offset:43072
    v_mfma_f32_16x16x32_bf16 v[140:143], v[76:79], v[92:95], v[140:143]
    ds_read_b64_tr_b16 v[90:91], v2 offset:43840
    s_waitcnt lgkmcnt(6)
    v_mfma_f32_16x16x32_bf16 v[144:147], v[96:99], v[72:75], v[144:147]
    ds_read_b64_tr_b16 v[92:93], v2 offset:49216
    v_mfma_f32_16x16x32_bf16 v[148:151], v[96:99], v[76:79], v[148:151]
    ds_read_b64_tr_b16 v[94:95], v2 offset:49984
    v_mfma_f32_16x16x32_bf16 v[152:155], v[100:103], v[72:75], v[152:155]
    ds_read_b128 v[96:99], v4 offset:43008
    v_mfma_f32_16x16x32_bf16 v[156:159], v[100:103], v[76:79], v[156:159]
    s_waitcnt lgkmcnt(5)
    v_mfma_f32_16x16x32_bf16 v[160:163], v[104:107], v[72:75], v[160:163]
    ds_read_b128 v[100:103], v4 offset:45056
    v_mfma_f32_16x16x32_bf16 v[164:167], v[104:107], v[76:79], v[164:167]
    v_mfma_f32_16x16x32_bf16 v[168:171], v[108:111], v[72:75], v[168:171]
    ds_read_b128 v[104:107], v4 offset:47104
    v_mfma_f32_16x16x32_bf16 v[172:175], v[108:111], v[76:79], v[172:175]
    s_waitcnt lgkmcnt(3)
    v_mfma_f32_16x16x32_bf16 v[176:179], v[88:91], v[72:75], v[176:179]
    ds_read_b128 v[108:111], v4 offset:49152
    v_mfma_f32_16x16x32_bf16 v[180:183], v[88:91], v[76:79], v[180:183]
    v_mfma_f32_16x16x32_bf16 v[184:187], v[92:95], v[72:75], v[184:187]
    ds_read_b64_tr_b16 v[88:89], v2 offset:46080
    v_mfma_f32_16x16x32_bf16 v[188:191], v[92:95], v[76:79], v[188:191]
    ds_read_b64_tr_b16 v[90:91], v2 offset:46848
    s_waitcnt vmcnt(9) lgkmcnt(4)
    v_mfma_f32_16x16x32_bf16 v[112:115], v[80:83], v[96:99], v[112:115]
    ds_read_b64_tr_b16 v[92:93], v2 offset:52224
    v_mfma_f32_16x16x32_bf16 v[116:119], v[84:87], v[96:99], v[116:119]
    ds_read_b64_tr_b16 v[94:95], v2 offset:52992
    v_mfma_f32_16x16x32_bf16 v[120:123], v[80:83], v[100:103], v[120:123]
    ds_read_b64_tr_b16 v[96:97], v2 offset:46112
    v_mfma_f32_16x16x32_bf16 v[124:127], v[84:87], v[100:103], v[124:127]
    ds_read_b64_tr_b16 v[98:99], v2 offset:46880
    s_waitcnt lgkmcnt(6)
    v_mfma_f32_16x16x32_bf16 v[128:131], v[80:83], v[104:107], v[128:131]
    ds_read_b64_tr_b16 v[100:101], v2 offset:52256
    v_mfma_f32_16x16x32_bf16 v[132:135], v[84:87], v[104:107], v[132:135]
    ds_read_b64_tr_b16 v[102:103], v2 offset:53024
    v_mfma_f32_16x16x32_bf16 v[136:139], v[80:83], v[108:111], v[136:139]
    ds_read_b64_tr_b16 v[104:105], v2 offset:46144
    v_mfma_f32_16x16x32_bf16 v[140:143], v[84:87], v[108:111], v[140:143]
    ds_read_b64_tr_b16 v[106:107], v2 offset:46912
    s_waitcnt lgkmcnt(6)
    v_mfma_f32_16x16x32_bf16 v[144:147], v[88:91], v[80:83], v[144:147]
    ds_read_b64_tr_b16 v[108:109], v2 offset:52288
    v_mfma_f32_16x16x32_bf16 v[148:151], v[88:91], v[84:87], v[148:151]
    ds_read_b64_tr_b16 v[110:111], v2 offset:53056
    s_barrier
    v_mfma_f32_16x16x32_bf16 v[152:155], v[92:95], v[80:83], v[152:155]
    v_add_u32 v2, 64512, v2
    ds_read_b64_tr_b16 v[88:89], v2 offset:0
    s_add_u32 m0, s79, 21504
    s_nop 0
    buffer_load_dwordx4 v36, s[12:15], s77 offen lds
    s_add_u32 m0, s79, 29696
    s_nop 0
    buffer_load_dwordx4 v36, s[16:19], s77 offen lds
    s_sub_u32 s77, s77, 458752
    v_mfma_f32_16x16x32_bf16 v[156:159], v[92:95], v[84:87], v[156:159]
    ds_read_b64_tr_b16 v[90:91], v2 offset:768
    s_waitcnt lgkmcnt(6)
    v_mfma_f32_16x16x32_bf16 v[160:163], v[96:99], v[80:83], v[160:163]
    ds_read_b64_tr_b16 v[92:93], v2 offset:6144
    v_mfma_f32_16x16x32_bf16 v[164:167], v[96:99], v[84:87], v[164:167]
    ds_read_b64_tr_b16 v[94:95], v2 offset:6912
    v_mfma_f32_16x16x32_bf16 v[168:171], v[100:103], v[80:83], v[168:171]
    ds_read_b64_tr_b16 v[96:97], v2 offset:3072
    v_mfma_f32_16x16x32_bf16 v[172:175], v[100:103], v[84:87], v[172:175]
    ds_read_b64_tr_b16 v[98:99], v2 offset:3840
    s_waitcnt lgkmcnt(6)
    v_mfma_f32_16x16x32_bf16 v[176:179], v[104:107], v[80:83], v[176:179]
    ds_read_b64_tr_b16 v[100:101], v2 offset:9216
    v_mfma_f32_16x16x32_bf16 v[180:183], v[104:107], v[84:87], v[180:183]
    ds_read_b64_tr_b16 v[102:103], v2 offset:9984
    v_mfma_f32_16x16x32_bf16 v[184:187], v[108:111], v[80:83], v[184:187]
    v_add_u32 v3, 64512, v3
    ds_read_b128 v[104:107], v3 offset:0
    v_mfma_f32_16x16x32_bf16 v[188:191], v[108:111], v[84:87], v[188:191]
    s_waitcnt vmcnt(9) lgkmcnt(5)
    v_mfma_f32_16x16x32_bf16 v[144:147], v[88:91], v[40:43], v[144:147]
    ds_read_b128 v[108:111], v3 offset:2048
    v_mfma_f32_16x16x32_bf16 v[148:151], v[88:91], v[44:47], v[148:151]
    v_mfma_f32_16x16x32_bf16 v[152:155], v[92:95], v[40:43], v[152:155]
    ds_read_b128 v[88:91], v3 offset:4096
    v_mfma_f32_16x16x32_bf16 v[156:159], v[92:95], v[44:47], v[156:159]
    s_waitcnt vmcnt(5) lgkmcnt(3)
    v_mfma_f32_16x16x32_bf16 v[144:147], v[96:99], v[48:51], v[144:147]
    ds_read_b128 v[92:95], v3 offset:6144
    v_mfma_f32_16x16x32_bf16 v[148:151], v[96:99], v[52:55], v[148:151]
    v_mfma_f32_16x16x32_bf16 v[152:155], v[100:103], v[48:51], v[152:155]
    v_add_u32 v4, 64512, v4
    ds_read_b128 v[96:99], v4 offset:0
    v_mfma_f32_16x16x32_bf16 v[156:159], v[100:103], v[52:55], v[156:159]
    s_waitcnt lgkmcnt(3)
    v_mfma_f32_16x16x32_bf16 v[112:115], v[40:43], v[104:107], v[112:115]
    ds_read_b128 v[100:103], v4 offset:2048
    v_mfma_f32_16x16x32_bf16 v[116:119], v[44:47], v[104:107], v[116:119]
    v_mfma_f32_16x16x32_bf16 v[120:123], v[40:43], v[108:111], v[120:123]
    ds_read_b128 v[104:107], v4 offset:4096
    v_mul_f32 v144, 0xbfb8aa3b, v144
    v_mfma_f32_16x16x32_bf16 v[124:127], v[44:47], v[108:111], v[124:127]
    v_mul_f32 v145, 0xbfb8aa3b, v145
    v_mul_f32 v146, 0xbfb8aa3b, v146
    s_waitcnt lgkmcnt(3)
    v_mfma_f32_16x16x32_bf16 v[128:131], v[40:43], v[88:91], v[128:131]
    ds_read_b128 v[108:111], v4 offset:6144
    v_mul_f32 v147, 0xbfb8aa3b, v147
    v_mfma_f32_16x16x32_bf16 v[132:135], v[44:47], v[88:91], v[132:135]
    v_mul_f32 v148, 0xbfb8aa3b, v148
    v_mul_f32 v149, 0xbfb8aa3b, v149
    v_mfma_f32_16x16x32_bf16 v[136:139], v[40:43], v[92:95], v[136:139]
    ds_read_b64_tr_b16 v[88:89], v2 offset:32
    v_mul_f32 v150, 0xbfb8aa3b, v150
    v_mfma_f32_16x16x32_bf16 v[140:143], v[44:47], v[92:95], v[140:143]
    ds_read_b64_tr_b16 v[90:91], v2 offset:800
    v_mul_f32 v151, 0xbfb8aa3b, v151
    v_exp_f32 v144, v144
    s_waitcnt lgkmcnt(4)
    v_mfma_f32_16x16x32_bf16 v[112:115], v[48:51], v[96:99], v[112:115]
    ds_read_b64_tr_b16 v[92:93], v2 offset:6176
    v_exp_f32 v145, v145
    v_mfma_f32_16x16x32_bf16 v[116:119], v[52:55], v[96:99], v[116:119]
    ds_read_b64_tr_b16 v[94:95], v2 offset:6944
    v_exp_f32 v146, v146
    v_exp_f32 v147, v147
    v_mfma_f32_16x16x32_bf16 v[120:123], v[48:51], v[100:103], v[120:123]
    ds_read_b64_tr_b16 v[96:97], v2 offset:3104
    v_exp_f32 v148, v148
    v_mfma_f32_16x16x32_bf16 v[124:127], v[52:55], v[100:103], v[124:127]
    ds_read_b64_tr_b16 v[98:99], v2 offset:3872
    v_exp_f32 v149, v149
    v_exp_f32 v150, v150
    s_waitcnt lgkmcnt(6)
    v_mfma_f32_16x16x32_bf16 v[128:131], v[48:51], v[104:107], v[128:131]
    ds_read_b64_tr_b16 v[100:101], v2 offset:9248
    v_exp_f32 v151, v151
    v_mfma_f32_16x16x32_bf16 v[132:135], v[52:55], v[104:107], v[132:135]
    ds_read_b64_tr_b16 v[102:103], v2 offset:10016
    v_add_f32 v144, 1.0, v144
    v_add_f32 v145, 1.0, v145
    v_mfma_f32_16x16x32_bf16 v[136:139], v[48:51], v[108:111], v[136:139]
    ds_read_b64_tr_b16 v[104:105], v2 offset:64
    v_add_f32 v146, 1.0, v146
    v_mfma_f32_16x16x32_bf16 v[140:143], v[52:55], v[108:111], v[140:143]
    ds_read_b64_tr_b16 v[106:107], v2 offset:832
    v_add_f32 v147, 1.0, v147
    v_add_f32 v148, 1.0, v148
    s_waitcnt lgkmcnt(6)
    v_mfma_f32_16x16x32_bf16 v[160:163], v[88:91], v[40:43], v[160:163]
    ds_read_b64_tr_b16 v[108:109], v2 offset:6208
    v_add_f32 v149, 1.0, v149
    v_mfma_f32_16x16x32_bf16 v[164:167], v[88:91], v[44:47], v[164:167]
    ds_read_b64_tr_b16 v[110:111], v2 offset:6976
    v_add_f32 v150, 1.0, v150
    v_add_f32 v151, 1.0, v151
    v_mfma_f32_16x16x32_bf16 v[168:171], v[92:95], v[40:43], v[168:171]
    ds_read_b64_tr_b16 v[88:89], v2 offset:3136
    v_rcp_f32 v144, v144
    v_mfma_f32_16x16x32_bf16 v[172:175], v[92:95], v[44:47], v[172:175]
    ds_read_b64_tr_b16 v[90:91], v2 offset:3904
    v_rcp_f32 v145, v145
    v_rcp_f32 v146, v146
    s_waitcnt lgkmcnt(6)
    v_mfma_f32_16x16x32_bf16 v[160:163], v[96:99], v[48:51], v[160:163]
    ds_read_b64_tr_b16 v[92:93], v2 offset:9280
    v_rcp_f32 v147, v147
    v_mfma_f32_16x16x32_bf16 v[164:167], v[96:99], v[52:55], v[164:167]
    ds_read_b64_tr_b16 v[94:95], v2 offset:10048
    v_rcp_f32 v148, v148
    v_rcp_f32 v149, v149
    s_barrier
    v_mfma_f32_16x16x32_bf16 v[168:171], v[100:103], v[48:51], v[168:171]
    v_add_u32 v6, 86016, v6
    ds_read_b64_tr_b16 v[96:97], v6 offset:4096
    s_add_u32 m0, s79, 43008
    s_nop 0
    buffer_load_dwordx4 v36, s[12:15], s77 offen lds
    s_add_u32 m0, s79, 51200
    s_nop 0
    buffer_load_dwordx4 v36, s[16:19], s77 offen lds
    s_sub_u32 s77, s77, 458752
    v_mfma_f32_16x16x32_bf16 v[172:175], v[100:103], v[52:55], v[172:175]
    ds_read_b64_tr_b16 v[98:99], v6 offset:4608
    v_rcp_f32 v150, v150
    v_rcp_f32 v151, v151
    s_waitcnt lgkmcnt(6)
    v_mfma_f32_16x16x32_bf16 v[176:179], v[104:107], v[40:43], v[176:179]
    ds_read_b64_tr_b16 v[100:101], v6 offset:12288
    v_mul_f32 v144, v144, v152
    v_mfma_f32_16x16x32_bf16 v[180:183], v[104:107], v[44:47], v[180:183]
    ds_read_b64_tr_b16 v[102:103], v6 offset:12800
    v_mul_f32 v145, v145, v153
    v_mul_f32 v146, v146, v154
    v_mfma_f32_16x16x32_bf16 v[184:187], v[108:111], v[40:43], v[184:187]
    v_add_u32 v7, 86016, v7
    ds_read_b64_tr_b16 v[104:105], v7 offset:4096
    v_mul_f32 v147, v147, v155
    v_mfma_f32_16x16x32_bf16 v[188:191], v[108:111], v[44:47], v[188:191]
    ds_read_b64_tr_b16 v[106:107], v7 offset:4608
    v_mul_f32 v148, v148, v156
    v_mul_f32 v149, v149, v157
    s_waitcnt lgkmcnt(6)
    v_mfma_f32_16x16x32_bf16 v[176:179], v[88:91], v[48:51], v[176:179]
    ds_read_b64_tr_b16 v[108:109], v7 offset:12288
    v_mul_f32 v150, v150, v158
    v_mfma_f32_16x16x32_bf16 v[180:183], v[88:91], v[52:55], v[180:183]
    ds_read_b64_tr_b16 v[110:111], v7 offset:12800
    v_mul_f32 v151, v151, v159
    v_cvt_pk_bf16_f32 v152, v144, v145
    s_waitcnt vmcnt(4)
    v_mfma_f32_16x16x32_bf16 v[184:187], v[92:95], v[48:51], v[184:187]
    v_add_u32 v8, 86016, v8
    ds_read_b64_tr_b16 v[88:89], v8 offset:4096
    v_cvt_pk_bf16_f32 v153, v146, v147
    v_mfma_f32_16x16x32_bf16 v[188:191], v[92:95], v[52:55], v[188:191]
    ds_read_b64_tr_b16 v[90:91], v8 offset:4608
    v_cvt_pk_bf16_f32 v154, v148, v149
    v_cvt_pk_bf16_f32 v155, v150, v151
    s_waitcnt lgkmcnt(6)
    v_mfma_f32_16x16x32_bf16 v[192:195], v[96:99], v[48:51], 0
    ds_read_b64_tr_b16 v[92:93], v8 offset:12288
    s_add_u32 s89, s82, 0
    v_mfma_f32_16x16x32_bf16 v[196:199], v[96:99], v[52:55], 0
    ds_read_b64_tr_b16 v[94:95], v8 offset:12800
    v_permlane16_swap_b32 v152, v154
    v_permlane16_swap_b32 v153, v155
    v_mfma_f32_16x16x32_bf16 v[200:203], v[100:103], v[48:51], 0
    v_add_u32 v9, 86016, v9
    ds_read_b64_tr_b16 v[96:97], v9 offset:4096
    buffer_store_dwordx4 v[152:155], v12, s[32:35], s89 offen sc1
    v_mfma_f32_16x16x32_bf16 v[204:207], v[100:103], v[52:55], 0
    ds_read_b64_tr_b16 v[98:99], v9 offset:4608
    v_fma_f32 v144, v20, v112, v113
    v_fma_f32 v145, v20, v128, v129
    s_waitcnt lgkmcnt(6)
    v_mfma_f32_16x16x32_bf16 v[208:211], v[104:107], v[48:51], 0
    ds_read_b64_tr_b16 v[100:101], v9 offset:12288
    v_fma_f32 v146, v22, v120, v121
    v_mfma_f32_16x16x32_bf16 v[212:215], v[104:107], v[52:55], 0
    ds_read_b64_tr_b16 v[102:103], v9 offset:12800
    v_fma_f32 v147, v22, v136, v137
    v_fma_f32 v144, -v21, v128, v144
    v_mfma_f32_16x16x32_bf16 v[216:219], v[108:111], v[48:51], 0
    ds_read_b64_tr_b16 v[104:105], v6 offset:0
    v_fma_f32 v145, v21, v112, v145
    v_mfma_f32_16x16x32_bf16 v[220:223], v[108:111], v[52:55], 0
    ds_read_b64_tr_b16 v[106:107], v6 offset:512
    v_fma_f32 v146, -v23, v136, v146
    v_fma_f32 v147, v23, v120, v147
    s_waitcnt lgkmcnt(6)
    v_mfma_f32_16x16x32_bf16 v[224:227], v[88:91], v[48:51], 0
    ds_read_b64_tr_b16 v[108:109], v6 offset:8192
    v_fma_f32 v148, v20, v144, v114
    v_mfma_f32_16x16x32_bf16 v[228:231], v[88:91], v[52:55], 0
    ds_read_b64_tr_b16 v[110:111], v6 offset:8704
    v_fma_f32 v149, v20, v145, v130
    v_fma_f32 v150, v22, v146, v122
    v_mfma_f32_16x16x32_bf16 v[232:235], v[92:95], v[48:51], 0
    ds_read_b64_tr_b16 v[88:89], v7 offset:0
    v_fma_f32 v151, v22, v147, v138
    v_mfma_f32_16x16x32_bf16 v[236:239], v[92:95], v[52:55], 0
    ds_read_b64_tr_b16 v[90:91], v7 offset:512
    v_fma_f32 v148, -v21, v145, v148
    v_fma_f32 v149, v21, v144, v149
    s_waitcnt lgkmcnt(6)
    v_mfma_f32_16x16x32_bf16 v[240:243], v[96:99], v[48:51], 0
    ds_read_b64_tr_b16 v[92:93], v7 offset:8192
    v_fma_f32 v150, -v23, v147, v150
    v_mfma_f32_16x16x32_bf16 v[244:247], v[96:99], v[52:55], 0
    ds_read_b64_tr_b16 v[94:95], v7 offset:8704
    v_fma_f32 v151, v23, v146, v151
    v_fma_f32 v144, v20, v148, v115
    v_mfma_f32_16x16x32_bf16 v[248:251], v[100:103], v[48:51], 0
    ds_read_b64_tr_b16 v[96:97], v8 offset:0
    v_fma_f32 v145, v20, v149, v131
    v_mfma_f32_16x16x32_bf16 v[252:255], v[100:103], v[52:55], 0
    ds_read_b64_tr_b16 v[98:99], v8 offset:512
    v_fma_f32 v146, v22, v150, v123
    v_fma_f32 v147, v22, v151, v139
    s_waitcnt lgkmcnt(6)
    v_mfma_f32_16x16x32_bf16 v[192:195], v[104:107], v[40:43], v[192:195]
    ds_read_b64_tr_b16 v[100:101], v8 offset:8192
    buffer_load_dwordx4 v[48:51], v1, s[8:11], s76 offen
    buffer_load_dwordx4 v[52:55], v1, s[8:11], s76 offen offset:256
    s_sub_u32 s76, s76, 131072
    v_mfma_f32_16x16x32_bf16 v[196:199], v[104:107], v[44:47], v[196:199]
    ds_read_b64_tr_b16 v[102:103], v8 offset:8704
    v_fma_f32 v144, -v21, v149, v144
    v_fma_f32 v145, v21, v148, v145
    v_mfma_f32_16x16x32_bf16 v[200:203], v[108:111], v[40:43], v[200:203]
    ds_read_b64_tr_b16 v[104:105], v9 offset:0
    v_fma_f32 v146, -v23, v151, v146
    v_mfma_f32_16x16x32_bf16 v[204:207], v[108:111], v[44:47], v[204:207]
    ds_read_b64_tr_b16 v[106:107], v9 offset:512
    v_fma_f32 v147, v23, v150, v147
    v_fma_f32 v148, v20, v144, v116
    s_waitcnt lgkmcnt(6)
    v_mfma_f32_16x16x32_bf16 v[208:211], v[88:91], v[40:43], v[208:211]
    ds_read_b64_tr_b16 v[108:109], v9 offset:8192
    v_fma_f32 v149, v20, v145, v132
    v_mfma_f32_16x16x32_bf16 v[212:215], v[88:91], v[44:47], v[212:215]
    ds_read_b64_tr_b16 v[110:111], v9 offset:8704
    v_fma_f32 v150, v22, v146, v124
    v_fma_f32 v151, v22, v147, v140
    s_barrier
    v_mfma_f32_16x16x32_bf16 v[216:219], v[92:95], v[40:43], v[216:219]
    ds_read_b64_tr_b16 v[88:89], v6 offset:25600
    s_add_u32 m0, s79, 64512
    s_nop 0
    buffer_load_dwordx4 v36, s[12:15], s77 offen lds
    s_add_u32 m0, s79, 72704
    s_nop 0
    buffer_load_dwordx4 v36, s[16:19], s77 offen lds
    s_sub_u32 s77, s77, 458752
    v_mfma_f32_16x16x32_bf16 v[220:223], v[92:95], v[44:47], v[220:223]
    ds_read_b64_tr_b16 v[90:91], v6 offset:26112
    v_fma_f32 v148, -v21, v145, v148
    v_fma_f32 v149, v21, v144, v149
    s_waitcnt lgkmcnt(6)
    v_mfma_f32_16x16x32_bf16 v[224:227], v[96:99], v[40:43], v[224:227]
    ds_read_b64_tr_b16 v[92:93], v6 offset:33792
    v_fma_f32 v150, -v23, v147, v150
    v_mfma_f32_16x16x32_bf16 v[228:231], v[96:99], v[44:47], v[228:231]
    ds_read_b64_tr_b16 v[94:95], v6 offset:34304
    v_fma_f32 v151, v23, v146, v151
    v_fma_f32 v144, v20, v148, v117
    v_mfma_f32_16x16x32_bf16 v[232:235], v[100:103], v[40:43], v[232:235]
    ds_read_b64_tr_b16 v[96:97], v7 offset:25600
    v_fma_f32 v145, v20, v149, v133
    v_mfma_f32_16x16x32_bf16 v[236:239], v[100:103], v[44:47], v[236:239]
    ds_read_b64_tr_b16 v[98:99], v7 offset:26112
    v_fma_f32 v146, v22, v150, v125
    v_fma_f32 v147, v22, v151, v141
    s_waitcnt lgkmcnt(6)
    v_mfma_f32_16x16x32_bf16 v[240:243], v[104:107], v[40:43], v[240:243]
    ds_read_b64_tr_b16 v[100:101], v7 offset:33792
    v_fma_f32 v144, -v21, v149, v144
    v_mfma_f32_16x16x32_bf16 v[244:247], v[104:107], v[44:47], v[244:247]
    ds_read_b64_tr_b16 v[102:103], v7 offset:34304
    v_fma_f32 v145, v21, v148, v145
    v_fma_f32 v146, -v23, v151, v146
    v_mfma_f32_16x16x32_bf16 v[248:251], v[108:111], v[40:43], v[248:251]
    ds_read_b64_tr_b16 v[104:105], v8 offset:25600
    v_fma_f32 v147, v23, v150, v147
    v_mfma_f32_16x16x32_bf16 v[252:255], v[108:111], v[44:47], v[252:255]
    ds_read_b64_tr_b16 v[106:107], v8 offset:26112
    v_fma_f32 v148, v20, v144, v118
    v_fma_f32 v149, v20, v145, v134
    s_waitcnt lgkmcnt(6)
    v_mfma_f32_16x16x32_bf16 v[192:195], v[88:91], v[80:83], v[192:195]
    ds_read_b64_tr_b16 v[108:109], v8 offset:33792
    buffer_load_dwordx4 v[40:43], v1, s[8:11], s76 offen
    buffer_load_dwordx4 v[44:47], v1, s[8:11], s76 offen offset:256
    s_sub_u32 s76, s76, 131072
    v_mfma_f32_16x16x32_bf16 v[196:199], v[88:91], v[84:87], v[196:199]
    ds_read_b64_tr_b16 v[110:111], v8 offset:34304
    v_fma_f32 v150, v22, v146, v126
    v_fma_f32 v151, v22, v147, v142
    v_mfma_f32_16x16x32_bf16 v[200:203], v[92:95], v[80:83], v[200:203]
    ds_read_b64_tr_b16 v[88:89], v9 offset:25600
    v_fma_f32 v148, -v21, v145, v148
    v_mfma_f32_16x16x32_bf16 v[204:207], v[92:95], v[84:87], v[204:207]
    ds_read_b64_tr_b16 v[90:91], v9 offset:26112
    v_fma_f32 v149, v21, v144, v149
    v_fma_f32 v150, -v23, v147, v150
    s_waitcnt lgkmcnt(6)
    v_mfma_f32_16x16x32_bf16 v[208:211], v[96:99], v[80:83], v[208:211]
    ds_read_b64_tr_b16 v[92:93], v9 offset:33792
    v_fma_f32 v151, v23, v146, v151
    v_mfma_f32_16x16x32_bf16 v[212:215], v[96:99], v[84:87], v[212:215]
    ds_read_b64_tr_b16 v[94:95], v9 offset:34304
    v_fma_f32 v144, v20, v148, v119
    v_fma_f32 v145, v20, v149, v135
    v_mfma_f32_16x16x32_bf16 v[216:219], v[100:103], v[80:83], v[216:219]
    ds_read_b64_tr_b16 v[96:97], v6 offset:21504
    v_fma_f32 v146, v22, v150, v127
    v_mfma_f32_16x16x32_bf16 v[220:223], v[100:103], v[84:87], v[220:223]
    ds_read_b64_tr_b16 v[98:99], v6 offset:22016
    v_fma_f32 v147, v22, v151, v143
    v_fma_f32 v144, -v21, v149, v144
    s_waitcnt lgkmcnt(6)
    v_mfma_f32_16x16x32_bf16 v[224:227], v[104:107], v[80:83], v[224:227]
    ds_read_b64_tr_b16 v[100:101], v6 offset:29696
    v_fma_f32 v145, v21, v148, v145
    v_mfma_f32_16x16x32_bf16 v[228:231], v[104:107], v[84:87], v[228:231]
    ds_read_b64_tr_b16 v[102:103], v6 offset:30208
    v_fma_f32 v146, -v23, v151, v146
    v_fma_f32 v147, v23, v150, v147
    v_mfma_f32_16x16x32_bf16 v[232:235], v[108:111], v[80:83], v[232:235]
    ds_read_b64_tr_b16 v[104:105], v7 offset:21504
    ds_write_b128 v14, v[144:147] offset:768
    v_mfma_f32_16x16x32_bf16 v[236:239], v[108:111], v[84:87], v[236:239]
    ds_read_b64_tr_b16 v[106:107], v7 offset:22016
    ds_read_b128 v[148:151], v14 offset:0
    ds_read_b128 v[152:155], v14 offset:256
    s_waitcnt lgkmcnt(9)
    v_mfma_f32_16x16x32_bf16 v[240:243], v[88:91], v[80:83], v[240:243]
    ds_read_b64_tr_b16 v[108:109], v7 offset:29696
    ds_read_b128 v[156:159], v14 offset:512
    v_mfma_f32_16x16x32_bf16 v[244:247], v[88:91], v[84:87], v[244:247]
    ds_read_b64_tr_b16 v[110:111], v7 offset:30208
    v_mfma_f32_16x16x32_bf16 v[248:251], v[92:95], v[80:83], v[248:251]
    ds_read_b64_tr_b16 v[88:89], v8 offset:21504
    v_mfma_f32_16x16x32_bf16 v[252:255], v[92:95], v[84:87], v[252:255]
    ds_read_b64_tr_b16 v[90:91], v8 offset:22016
    s_waitcnt lgkmcnt(10)
    v_mfma_f32_16x16x32_bf16 v[192:195], v[96:99], v[72:75], v[192:195]
    ds_read_b64_tr_b16 v[92:93], v8 offset:29696
    buffer_load_dwordx4 v[80:83], v1, s[8:11], s76 offen
    buffer_load_dwordx4 v[84:87], v1, s[8:11], s76 offen offset:256
    s_sub_u32 s76, s76, 131072
    v_mfma_f32_16x16x32_bf16 v[196:199], v[96:99], v[76:79], v[196:199]
    ds_read_b64_tr_b16 v[94:95], v8 offset:30208
    s_waitcnt lgkmcnt(5)
    v_fma_f32 v152, v28, v148, v152
    v_fma_f32 v153, v28, v149, v153
    v_mfma_f32_16x16x32_bf16 v[200:203], v[100:103], v[72:75], v[200:203]
    ds_read_b64_tr_b16 v[96:97], v9 offset:21504
    v_fma_f32 v154, v30, v150, v154
    v_mfma_f32_16x16x32_bf16 v[204:207], v[100:103], v[76:79], v[204:207]
    ds_read_b64_tr_b16 v[98:99], v9 offset:22016
    v_fma_f32 v155, v30, v151, v155
    v_fma_f32 v152, -v29, v149, v152
    s_waitcnt lgkmcnt(6)
    v_mfma_f32_16x16x32_bf16 v[208:211], v[104:107], v[72:75], v[208:211]
    ds_read_b64_tr_b16 v[100:101], v9 offset:29696
    v_fma_f32 v153, v29, v148, v153
    v_mfma_f32_16x16x32_bf16 v[212:215], v[104:107], v[76:79], v[212:215]
    ds_read_b64_tr_b16 v[102:103], v9 offset:30208
    v_fma_f32 v154, -v31, v151, v154
    v_fma_f32 v155, v31, v150, v155
    s_barrier
    v_mfma_f32_16x16x32_bf16 v[216:219], v[108:111], v[72:75], v[216:219]
    v_subrev_u32 v6, 86016, v6
    ds_read_b64_tr_b16 v[104:105], v6 offset:4096
    s_add_u32 m0, s79, 86016
    s_nop 0
    buffer_load_dwordx4 v36, s[12:15], s77 offen lds
    s_add_u32 m0, s79, 94208
    s_nop 0
    buffer_load_dwordx4 v36, s[16:19], s77 offen lds
    s_sub_u32 s77, s77, 458752
    v_mfma_f32_16x16x32_bf16 v[220:223], v[108:111], v[76:79], v[220:223]
    ds_read_b64_tr_b16 v[106:107], v6 offset:4608
    v_fma_f32 v156, v28, v152, v156
    v_fma_f32 v157, v28, v153, v157
    s_waitcnt lgkmcnt(6)
    v_mfma_f32_16x16x32_bf16 v[224:227], v[88:91], v[72:75], v[224:227]
    ds_read_b64_tr_b16 v[108:109], v6 offset:12288
    v_fma_f32 v158, v30, v154, v158
    v_mfma_f32_16x16x32_bf16 v[228:231], v[88:91], v[76:79], v[228:231]
    ds_read_b64_tr_b16 v[110:111], v6 offset:12800
    v_fma_f32 v159, v30, v155, v159
    v_fma_f32 v156, -v29, v153, v156
    v_mfma_f32_16x16x32_bf16 v[232:235], v[92:95], v[72:75], v[232:235]
    v_subrev_u32 v7, 86016, v7
    ds_read_b64_tr_b16 v[88:89], v7 offset:4096
    v_fma_f32 v157, v29, v152, v157
    v_mfma_f32_16x16x32_bf16 v[236:239], v[92:95], v[76:79], v[236:239]
    ds_read_b64_tr_b16 v[90:91], v7 offset:4608
    v_fma_f32 v158, -v31, v155, v158
    v_fma_f32 v159, v31, v154, v159
    s_waitcnt lgkmcnt(6)
    v_mfma_f32_16x16x32_bf16 v[240:243], v[96:99], v[72:75], v[240:243]
    ds_read_b64_tr_b16 v[92:93], v7 offset:12288
    v_fma_f32 v144, v28, v156, v144
    v_mfma_f32_16x16x32_bf16 v[244:247], v[96:99], v[76:79], v[244:247]
    ds_read_b64_tr_b16 v[94:95], v7 offset:12800
    v_fma_f32 v145, v28, v157, v145
    v_fma_f32 v146, v30, v158, v146
    v_mfma_f32_16x16x32_bf16 v[248:251], v[100:103], v[72:75], v[248:251]
    v_subrev_u32 v8, 86016, v8
    ds_read_b64_tr_b16 v[96:97], v8 offset:4096
    v_fma_f32 v147, v30, v159, v147
    v_mfma_f32_16x16x32_bf16 v[252:255], v[100:103], v[76:79], v[252:255]
    ds_read_b64_tr_b16 v[98:99], v8 offset:4608
    v_fma_f32 v144, -v29, v157, v144
    v_fma_f32 v145, v29, v156, v145
    s_waitcnt lgkmcnt(6)
    v_mfma_f32_16x16x32_bf16 v[192:195], v[104:107], v[64:67], v[192:195]
    ds_read_b64_tr_b16 v[100:101], v8 offset:12288
    buffer_load_dwordx4 v[72:75], v1, s[8:11], s76 offen
    buffer_load_dwordx4 v[76:79], v1, s[8:11], s76 offen offset:256
    s_sub_u32 s76, s76, 131072
    v_mfma_f32_16x16x32_bf16 v[196:199], v[104:107], v[68:71], v[196:199]
    ds_read_b64_tr_b16 v[102:103], v8 offset:12800
    v_fma_f32 v146, -v31, v159, v146
    v_fma_f32 v147, v31, v158, v147
    v_mfma_f32_16x16x32_bf16 v[200:203], v[108:111], v[64:67], v[200:203]
    v_subrev_u32 v9, 86016, v9
    ds_read_b64_tr_b16 v[104:105], v9 offset:4096
    s_mov_b32 exec_lo, 0
    s_mov_b32 exec_hi, 0xffff0000
    ds_write_b128 v15, v[144:147] offset:1792
    s_mov_b64 exec, -1
    v_mfma_f32_16x16x32_bf16 v[204:207], v[108:111], v[68:71], v[204:207]
    ds_read_b64_tr_b16 v[106:107], v9 offset:4608
    v_mul_f32 v160, 0xbfb8aa3b, v160
    v_mul_f32 v161, 0xbfb8aa3b, v161
    s_waitcnt lgkmcnt(7)
    v_mfma_f32_16x16x32_bf16 v[208:211], v[88:91], v[64:67], v[208:211]
    ds_read_b64_tr_b16 v[108:109], v9 offset:12288
    v_mul_f32 v162, 0xbfb8aa3b, v162
    v_mfma_f32_16x16x32_bf16 v[212:215], v[88:91], v[68:71], v[212:215]
    ds_read_b64_tr_b16 v[110:111], v9 offset:12800
    v_mul_f32 v163, 0xbfb8aa3b, v163
    v_mul_f32 v164, 0xbfb8aa3b, v164
    v_mfma_f32_16x16x32_bf16 v[216:219], v[92:95], v[64:67], v[216:219]
    ds_read_b64_tr_b16 v[88:89], v6 offset:0
    v_mul_f32 v165, 0xbfb8aa3b, v165
    v_mfma_f32_16x16x32_bf16 v[220:223], v[92:95], v[68:71], v[220:223]
    ds_read_b64_tr_b16 v[90:91], v6 offset:512
    v_mul_f32 v166, 0xbfb8aa3b, v166
    v_mul_f32 v167, 0xbfb8aa3b, v167
    s_waitcnt lgkmcnt(7)
    v_mfma_f32_16x16x32_bf16 v[224:227], v[96:99], v[64:67], v[224:227]
    ds_read_b64_tr_b16 v[92:93], v6 offset:8192
    v_exp_f32 v160, v160
    v_mfma_f32_16x16x32_bf16 v[228:231], v[96:99], v[68:71], v[228:231]
    ds_read_b64_tr_b16 v[94:95], v6 offset:8704
    v_exp_f32 v161, v161
    v_exp_f32 v162, v162
    v_mfma_f32_16x16x32_bf16 v[232:235], v[100:103], v[64:67], v[232:235]
    ds_read_b64_tr_b16 v[96:97], v7 offset:0
    v_exp_f32 v163, v163
    v_mfma_f32_16x16x32_bf16 v[236:239], v[100:103], v[68:71], v[236:239]
    ds_read_b64_tr_b16 v[98:99], v7 offset:512
    v_exp_f32 v164, v164
    v_exp_f32 v165, v165
    s_waitcnt lgkmcnt(6)
    v_mfma_f32_16x16x32_bf16 v[240:243], v[104:107], v[64:67], v[240:243]
    ds_read_b64_tr_b16 v[100:101], v7 offset:8192
    v_exp_f32 v166, v166
    v_mfma_f32_16x16x32_bf16 v[244:247], v[104:107], v[68:71], v[244:247]
    ds_read_b64_tr_b16 v[102:103], v7 offset:8704
    v_exp_f32 v167, v167
    v_add_f32 v160, 1.0, v160
    v_mfma_f32_16x16x32_bf16 v[248:251], v[108:111], v[64:67], v[248:251]
    ds_read_b64_tr_b16 v[104:105], v8 offset:0
    v_add_f32 v161, 1.0, v161
    v_mfma_f32_16x16x32_bf16 v[252:255], v[108:111], v[68:71], v[252:255]
    ds_read_b64_tr_b16 v[106:107], v8 offset:512
    v_add_f32 v162, 1.0, v162
    v_add_f32 v163, 1.0, v163
    s_waitcnt lgkmcnt(6)
    v_mfma_f32_16x16x32_bf16 v[192:195], v[88:91], v[56:59], v[192:195]
    ds_read_b64_tr_b16 v[108:109], v8 offset:8192
    buffer_load_dwordx4 v[64:67], v1, s[8:11], s76 offen
    buffer_load_dwordx4 v[68:71], v1, s[8:11], s76 offen offset:256
    s_sub_u32 s76, s76, 131072
    v_mfma_f32_16x16x32_bf16 v[196:199], v[88:91], v[60:63], v[196:199]
    ds_read_b64_tr_b16 v[110:111], v8 offset:8704
    v_add_f32 v164, 1.0, v164
    v_add_f32 v165, 1.0, v165
    v_mfma_f32_16x16x32_bf16 v[200:203], v[92:95], v[56:59], v[200:203]
    ds_read_b64_tr_b16 v[88:89], v9 offset:0
    v_add_f32 v166, 1.0, v166
    v_mfma_f32_16x16x32_bf16 v[204:207], v[92:95], v[60:63], v[204:207]
    ds_read_b64_tr_b16 v[90:91], v9 offset:512
    v_add_f32 v167, 1.0, v167
    v_rcp_f32 v160, v160
    s_waitcnt lgkmcnt(6)
    v_mfma_f32_16x16x32_bf16 v[208:211], v[96:99], v[56:59], v[208:211]
    ds_read_b64_tr_b16 v[92:93], v9 offset:8192
    v_rcp_f32 v161, v161
    v_mfma_f32_16x16x32_bf16 v[212:215], v[96:99], v[60:63], v[212:215]
    ds_read_b64_tr_b16 v[94:95], v9 offset:8704
    v_rcp_f32 v162, v162
    v_rcp_f32 v163, v163
    s_waitcnt vmcnt(17)
    s_barrier
    v_mfma_f32_16x16x32_bf16 v[216:219], v[100:103], v[56:59], v[216:219]
    ds_read_b64_tr_b16 v[96:97], v6 offset:25600
    s_add_u32 m0, s79, 107520
    s_nop 0
    buffer_load_dwordx4 v36, s[12:15], s77 offen lds
    s_add_u32 m0, s79, 115712
    s_nop 0
    buffer_load_dwordx4 v36, s[16:19], s77 offen lds
    s_sub_u32 s77, s77, 458752
    v_mfma_f32_16x16x32_bf16 v[220:223], v[100:103], v[60:63], v[220:223]
    ds_read_b64_tr_b16 v[98:99], v6 offset:26112
    v_rcp_f32 v164, v164
    v_rcp_f32 v165, v165
    s_waitcnt lgkmcnt(6)
    v_mfma_f32_16x16x32_bf16 v[224:227], v[104:107], v[56:59], v[224:227]
    ds_read_b64_tr_b16 v[100:101], v6 offset:33792
    v_rcp_f32 v166, v166
    v_mfma_f32_16x16x32_bf16 v[228:231], v[104:107], v[60:63], v[228:231]
    ds_read_b64_tr_b16 v[102:103], v6 offset:34304
    v_rcp_f32 v167, v167
    v_mul_f32 v160, v160, v168
    v_mfma_f32_16x16x32_bf16 v[232:235], v[108:111], v[56:59], v[232:235]
    ds_read_b64_tr_b16 v[104:105], v7 offset:25600
    v_mul_f32 v161, v161, v169
    v_mfma_f32_16x16x32_bf16 v[236:239], v[108:111], v[60:63], v[236:239]
    ds_read_b64_tr_b16 v[106:107], v7 offset:26112
    v_mul_f32 v162, v162, v170
    v_mul_f32 v163, v163, v171
    s_waitcnt lgkmcnt(6)
    v_mfma_f32_16x16x32_bf16 v[240:243], v[88:91], v[56:59], v[240:243]
    ds_read_b64_tr_b16 v[108:109], v7 offset:33792
    v_mul_f32 v164, v164, v172
    v_mfma_f32_16x16x32_bf16 v[244:247], v[88:91], v[60:63], v[244:247]
    ds_read_b64_tr_b16 v[110:111], v7 offset:34304
    v_mul_f32 v165, v165, v173
    v_mul_f32 v166, v166, v174
    v_mfma_f32_16x16x32_bf16 v[248:251], v[92:95], v[56:59], v[248:251]
    ds_read_b64_tr_b16 v[88:89], v8 offset:25600
    v_mul_f32 v167, v167, v175
    v_mfma_f32_16x16x32_bf16 v[252:255], v[92:95], v[60:63], v[252:255]
    ds_read_b64_tr_b16 v[90:91], v8 offset:26112
    v_cvt_pk_bf16_f32 v168, v160, v161
    v_cvt_pk_bf16_f32 v169, v162, v163
    s_waitcnt vmcnt(14) lgkmcnt(6)
    v_mfma_f32_16x16x32_bf16 v[192:195], v[96:99], v[48:51], v[192:195]
    ds_read_b64_tr_b16 v[92:93], v8 offset:33792
    buffer_load_dwordx4 v[56:59], v1, s[8:11], s76 offen
    buffer_load_dwordx4 v[60:63], v1, s[8:11], s76 offen offset:256
    s_sub_u32 s76, s76, 131072
    v_mfma_f32_16x16x32_bf16 v[196:199], v[96:99], v[52:55], v[196:199]
    ds_read_b64_tr_b16 v[94:95], v8 offset:34304
    v_cvt_pk_bf16_f32 v170, v164, v165
    v_cvt_pk_bf16_f32 v171, v166, v167
    v_mfma_f32_16x16x32_bf16 v[200:203], v[100:103], v[48:51], v[200:203]
    ds_read_b64_tr_b16 v[96:97], v9 offset:25600
    s_add_u32 s89, s82, 65536
    v_mfma_f32_16x16x32_bf16 v[204:207], v[100:103], v[52:55], v[204:207]
    ds_read_b64_tr_b16 v[98:99], v9 offset:26112
    v_permlane16_swap_b32 v168, v170
    v_permlane16_swap_b32 v169, v171
    s_waitcnt lgkmcnt(6)
    v_mfma_f32_16x16x32_bf16 v[208:211], v[104:107], v[48:51], v[208:211]
    ds_read_b64_tr_b16 v[100:101], v9 offset:33792
    buffer_store_dwordx4 v[168:171], v12, s[32:35], s89 offen sc1
    v_mfma_f32_16x16x32_bf16 v[212:215], v[104:107], v[52:55], v[212:215]
    ds_read_b64_tr_b16 v[102:103], v9 offset:34304
    ds_read_b128 v[160:163], v15 offset:0
    ds_read_b128 v[164:167], v15 offset:256
    v_mfma_f32_16x16x32_bf16 v[216:219], v[108:111], v[48:51], v[216:219]
    ds_read_b64_tr_b16 v[104:105], v6 offset:21504
    ds_read_b128 v[168:171], v15 offset:512
    v_mfma_f32_16x16x32_bf16 v[220:223], v[108:111], v[52:55], v[220:223]
    ds_read_b64_tr_b16 v[106:107], v6 offset:22016
    ds_read_b128 v[172:175], v15 offset:768
    ds_read_b128 v[148:151], v15 offset:1024
    s_waitcnt lgkmcnt(11)
    v_mfma_f32_16x16x32_bf16 v[224:227], v[88:91], v[48:51], v[224:227]
    ds_read_b64_tr_b16 v[108:109], v6 offset:29696
    ds_read_b128 v[152:155], v15 offset:1280
    v_mfma_f32_16x16x32_bf16 v[228:231], v[88:91], v[52:55], v[228:231]
    ds_read_b64_tr_b16 v[110:111], v6 offset:30208
    ds_read_b128 v[2:5], v15 offset:1536
    v_mfma_f32_16x16x32_bf16 v[232:235], v[92:95], v[48:51], v[232:235]
    ds_read_b64_tr_b16 v[88:89], v7 offset:21504
    v_mfma_f32_16x16x32_bf16 v[236:239], v[92:95], v[52:55], v[236:239]
    ds_read_b64_tr_b16 v[90:91], v7 offset:22016
    s_waitcnt lgkmcnt(11)
    v_fma_f32 v164, v32, v160, v164
    v_fma_f32 v165, v32, v161, v165
    v_mfma_f32_16x16x32_bf16 v[240:243], v[96:99], v[48:51], v[240:243]
    ds_read_b64_tr_b16 v[92:93], v7 offset:29696
    v_fma_f32 v166, v34, v162, v166
    v_mfma_f32_16x16x32_bf16 v[244:247], v[96:99], v[52:55], v[244:247]
    ds_read_b64_tr_b16 v[94:95], v7 offset:30208
    v_fma_f32 v167, v34, v163, v167
    v_fma_f32 v164, -v33, v161, v164
    v_mfma_f32_16x16x32_bf16 v[248:251], v[100:103], v[48:51], v[248:251]
    ds_read_b64_tr_b16 v[96:97], v8 offset:21504
    v_fma_f32 v165, v33, v160, v165
    v_mfma_f32_16x16x32_bf16 v[252:255], v[100:103], v[52:55], v[252:255]
    ds_read_b64_tr_b16 v[98:99], v8 offset:22016
    v_fma_f32 v166, -v35, v163, v166
    v_fma_f32 v167, v35, v162, v167
    s_waitcnt vmcnt(13) lgkmcnt(7)
    v_mfma_f32_16x16x32_bf16 v[192:195], v[104:107], v[40:43], v[192:195]
    ds_read_b64_tr_b16 v[100:101], v8 offset:29696
    buffer_load_dwordx4 v[48:51], v1, s[8:11], s76 offen
    buffer_load_dwordx4 v[52:55], v1, s[8:11], s76 offen offset:256
    s_sub_u32 s76, s76, 131072
    v_mfma_f32_16x16x32_bf16 v[196:199], v[104:107], v[44:47], v[196:199]
    ds_read_b64_tr_b16 v[102:103], v8 offset:30208
    v_fma_f32 v168, v32, v164, v168
    v_fma_f32 v169, v32, v165, v169
    v_mfma_f32_16x16x32_bf16 v[200:203], v[108:111], v[40:43], v[200:203]
    ds_read_b64_tr_b16 v[104:105], v9 offset:21504
    v_fma_f32 v170, v34, v166, v170
    v_mfma_f32_16x16x32_bf16 v[204:207], v[108:111], v[44:47], v[204:207]
    ds_read_b64_tr_b16 v[106:107], v9 offset:22016
    v_fma_f32 v171, v34, v167, v171
    v_fma_f32 v168, -v33, v165, v168
    s_waitcnt lgkmcnt(6)
    v_mfma_f32_16x16x32_bf16 v[208:211], v[88:91], v[40:43], v[208:211]
    ds_read_b64_tr_b16 v[108:109], v9 offset:29696
    v_fma_f32 v169, v33, v164, v169
    v_mfma_f32_16x16x32_bf16 v[212:215], v[88:91], v[44:47], v[212:215]
    ds_read_b64_tr_b16 v[110:111], v9 offset:30208
    v_fma_f32 v170, -v35, v167, v170
    v_fma_f32 v171, v35, v166, v171
    s_barrier
    v_mfma_f32_16x16x32_bf16 v[216:219], v[92:95], v[40:43], v[216:219]
    ds_read_b64_tr_b16 v[88:89], v6 offset:47104
    s_add_u32 m0, s79, 0
    s_nop 0
    buffer_load_dwordx4 v36, s[12:15], s77 offen lds
    s_add_u32 m0, s79, 8192
    s_nop 0
    buffer_load_dwordx4 v36, s[16:19], s77 offen lds
    s_sub_u32 s77, s77, 458752
    v_mfma_f32_16x16x32_bf16 v[220:223], v[92:95], v[44:47], v[220:223]
    ds_read_b64_tr_b16 v[90:91], v6 offset:47616
    v_fma_f32 v172, v32, v168, v172
    v_fma_f32 v173, v32, v169, v173
    s_waitcnt lgkmcnt(6)
    v_mfma_f32_16x16x32_bf16 v[224:227], v[96:99], v[40:43], v[224:227]
    ds_read_b64_tr_b16 v[92:93], v6 offset:55296
    v_fma_f32 v174, v34, v170, v174
    v_mfma_f32_16x16x32_bf16 v[228:231], v[96:99], v[44:47], v[228:231]
    ds_read_b64_tr_b16 v[94:95], v6 offset:55808
    v_fma_f32 v175, v34, v171, v175
    v_fma_f32 v172, -v33, v169, v172
    v_mfma_f32_16x16x32_bf16 v[232:235], v[100:103], v[40:43], v[232:235]
    ds_read_b64_tr_b16 v[96:97], v7 offset:47104
    v_fma_f32 v173, v33, v168, v173
    v_mfma_f32_16x16x32_bf16 v[236:239], v[100:103], v[44:47], v[236:239]
    ds_read_b64_tr_b16 v[98:99], v7 offset:47616
    v_fma_f32 v174, -v35, v171, v174
    v_fma_f32 v175, v35, v170, v175
    s_waitcnt lgkmcnt(6)
    v_mfma_f32_16x16x32_bf16 v[240:243], v[104:107], v[40:43], v[240:243]
    ds_read_b64_tr_b16 v[100:101], v7 offset:55296
    v_fma_f32 v148, v32, v172, v148
    v_mfma_f32_16x16x32_bf16 v[244:247], v[104:107], v[44:47], v[244:247]
    ds_read_b64_tr_b16 v[102:103], v7 offset:55808
    v_fma_f32 v149, v32, v173, v149
    v_fma_f32 v150, v34, v174, v150
    v_mfma_f32_16x16x32_bf16 v[248:251], v[108:111], v[40:43], v[248:251]
    ds_read_b64_tr_b16 v[104:105], v8 offset:47104
    v_fma_f32 v151, v34, v175, v151
    v_mfma_f32_16x16x32_bf16 v[252:255], v[108:111], v[44:47], v[252:255]
    ds_read_b64_tr_b16 v[106:107], v8 offset:47616
    v_fma_f32 v148, -v33, v173, v148
    v_fma_f32 v149, v33, v172, v149
    s_waitcnt vmcnt(15) lgkmcnt(6)
    v_mfma_f32_16x16x32_bf16 v[192:195], v[88:91], v[80:83], v[192:195]
    ds_read_b64_tr_b16 v[108:109], v8 offset:55296
    buffer_load_dwordx4 v[40:43], v1, s[8:11], s76 offen
    buffer_load_dwordx4 v[44:47], v1, s[8:11], s76 offen offset:256
    s_sub_u32 s76, s76, 131072
    v_mfma_f32_16x16x32_bf16 v[196:199], v[88:91], v[84:87], v[196:199]
    ds_read_b64_tr_b16 v[110:111], v8 offset:55808
    v_fma_f32 v150, -v35, v175, v150
    v_fma_f32 v151, v35, v174, v151
    v_mfma_f32_16x16x32_bf16 v[200:203], v[92:95], v[80:83], v[200:203]
    ds_read_b64_tr_b16 v[88:89], v9 offset:47104
    v_fma_f32 v152, v32, v148, v152
    v_mfma_f32_16x16x32_bf16 v[204:207], v[92:95], v[84:87], v[204:207]
    ds_read_b64_tr_b16 v[90:91], v9 offset:47616
    v_fma_f32 v153, v32, v149, v153
    v_fma_f32 v154, v34, v150, v154
    s_waitcnt lgkmcnt(6)
    v_mfma_f32_16x16x32_bf16 v[208:211], v[96:99], v[80:83], v[208:211]
    ds_read_b64_tr_b16 v[92:93], v9 offset:55296
    v_fma_f32 v155, v34, v151, v155
    v_mfma_f32_16x16x32_bf16 v[212:215], v[96:99], v[84:87], v[212:215]
    ds_read_b64_tr_b16 v[94:95], v9 offset:55808
    v_fma_f32 v152, -v33, v149, v152
    v_fma_f32 v153, v33, v148, v153
    v_mfma_f32_16x16x32_bf16 v[216:219], v[100:103], v[80:83], v[216:219]
    ds_read_b64_tr_b16 v[96:97], v6 offset:43008
    v_fma_f32 v154, -v35, v151, v154
    v_mfma_f32_16x16x32_bf16 v[220:223], v[100:103], v[84:87], v[220:223]
    ds_read_b64_tr_b16 v[98:99], v6 offset:43520
    v_fma_f32 v155, v35, v150, v155
    v_fma_f32 v2, v32, v152, v2
    s_waitcnt lgkmcnt(6)
    v_mfma_f32_16x16x32_bf16 v[224:227], v[104:107], v[80:83], v[224:227]
    ds_read_b64_tr_b16 v[100:101], v6 offset:51200
    v_fma_f32 v3, v32, v153, v3
    v_mfma_f32_16x16x32_bf16 v[228:231], v[104:107], v[84:87], v[228:231]
    ds_read_b64_tr_b16 v[102:103], v6 offset:51712
    v_fma_f32 v4, v34, v154, v4
    v_fma_f32 v5, v34, v155, v5
    v_mfma_f32_16x16x32_bf16 v[232:235], v[108:111], v[80:83], v[232:235]
    ds_read_b64_tr_b16 v[104:105], v7 offset:43008
    v_fma_f32 v2, -v33, v153, v2
    v_mfma_f32_16x16x32_bf16 v[236:239], v[108:111], v[84:87], v[236:239]
    ds_read_b64_tr_b16 v[106:107], v7 offset:43520
    v_fma_f32 v3, v33, v152, v3
    v_fma_f32 v4, -v35, v155, v4
    s_waitcnt lgkmcnt(6)
    v_mfma_f32_16x16x32_bf16 v[240:243], v[88:91], v[80:83], v[240:243]
    ds_read_b64_tr_b16 v[108:109], v7 offset:51200
    v_fma_f32 v5, v35, v154, v5
    v_mfma_f32_16x16x32_bf16 v[244:247], v[88:91], v[84:87], v[244:247]
    ds_read_b64_tr_b16 v[110:111], v7 offset:51712
    v_fma_f32 v144, v32, v2, v144
    v_fma_f32 v145, v32, v3, v145
    v_mfma_f32_16x16x32_bf16 v[248:251], v[92:95], v[80:83], v[248:251]
    ds_read_b64_tr_b16 v[88:89], v8 offset:43008
    v_fma_f32 v146, v34, v4, v146
    v_mfma_f32_16x16x32_bf16 v[252:255], v[92:95], v[84:87], v[252:255]
    ds_read_b64_tr_b16 v[90:91], v8 offset:43520
    v_fma_f32 v147, v34, v5, v147
    v_fma_f32 v144, -v33, v3, v144
    s_waitcnt vmcnt(13) lgkmcnt(6)
    v_mfma_f32_16x16x32_bf16 v[192:195], v[96:99], v[72:75], v[192:195]
    ds_read_b64_tr_b16 v[92:93], v8 offset:51200
    buffer_load_dwordx4 v[80:83], v1, s[8:11], s76 offen
    buffer_load_dwordx4 v[84:87], v1, s[8:11], s76 offen offset:256
    s_sub_u32 s76, s76, 131072
    v_mfma_f32_16x16x32_bf16 v[196:199], v[96:99], v[76:79], v[196:199]
    ds_read_b64_tr_b16 v[94:95], v8 offset:51712
    v_fma_f32 v145, v33, v2, v145
    v_fma_f32 v146, -v35, v5, v146
    v_mfma_f32_16x16x32_bf16 v[200:203], v[100:103], v[72:75], v[200:203]
    ds_read_b64_tr_b16 v[96:97], v9 offset:43008
    v_fma_f32 v147, v35, v4, v147
    v_mfma_f32_16x16x32_bf16 v[204:207], v[100:103], v[76:79], v[204:207]
    ds_read_b64_tr_b16 v[98:99], v9 offset:43520
    s_mov_b32 s7, 0xfffffffe
    v_min_u32 v144, s7, v144
    s_waitcnt lgkmcnt(6)
    v_mfma_f32_16x16x32_bf16 v[208:211], v[104:107], v[72:75], v[208:211]
    ds_read_b64_tr_b16 v[100:101], v9 offset:51200
    v_min_u32 v145, s7, v145
    v_mfma_f32_16x16x32_bf16 v[212:215], v[104:107], v[76:79], v[212:215]
    ds_read_b64_tr_b16 v[102:103], v9 offset:51712
    v_min_u32 v146, s7, v146
    v_min_u32 v147, s7, v147
    s_barrier
    v_mfma_f32_16x16x32_bf16 v[216:219], v[108:111], v[72:75], v[216:219]
    v_add_u32 v6, 64512, v6
    ds_read_b64_tr_b16 v[104:105], v6 offset:4096
    s_add_u32 m0, s79, 21504
    s_nop 0
    buffer_load_dwordx4 v36, s[12:15], s77 offen lds
    s_add_u32 m0, s79, 29696
    s_nop 0
    buffer_load_dwordx4 v36, s[16:19], s77 offen lds
    s_sub_u32 s77, s77, 458752
    v_mfma_f32_16x16x32_bf16 v[220:223], v[108:111], v[76:79], v[220:223]
    ds_read_b64_tr_b16 v[106:107], v6 offset:4608
    s_mov_b32 exec_lo, 0
    s_mov_b32 exec_hi, 0xffff0000
    buffer_store_dwordx4 v[144:147], v13, s[40:43], s85 offen sc1
    s_mov_b64 exec, -1
    s_waitcnt lgkmcnt(6)
    v_mfma_f32_16x16x32_bf16 v[224:227], v[88:91], v[72:75], v[224:227]
    ds_read_b64_tr_b16 v[108:109], v6 offset:12288
    v_lshrrev_b32 v172, 4, v0
    v_mfma_f32_16x16x32_bf16 v[228:231], v[88:91], v[76:79], v[228:231]
    ds_read_b64_tr_b16 v[110:111], v6 offset:12800
    v_lshlrev_b32 v172, 3, v172
    v_cvt_f32_u32 v173, v172
    v_mfma_f32_16x16x32_bf16 v[232:235], v[92:95], v[72:75], v[232:235]
    v_add_u32 v7, 64512, v7
    ds_read_b64_tr_b16 v[88:89], v7 offset:4096
    v_mul_f32 v164, v173, v16
    v_mfma_f32_16x16x32_bf16 v[236:239], v[92:95], v[76:79], v[236:239]
    ds_read_b64_tr_b16 v[90:91], v7 offset:4608
    v_mul_f32 v165, v173, v18
    v_mul_f32 v167, v173, v17
    s_waitcnt lgkmcnt(6)
    v_mfma_f32_16x16x32_bf16 v[240:243], v[96:99], v[72:75], v[240:243]
    ds_read_b64_tr_b16 v[92:93], v7 offset:12288
    v_mul_f32 v168, v173, v19
    v_mfma_f32_16x16x32_bf16 v[244:247], v[96:99], v[76:79], v[244:247]
    ds_read_b64_tr_b16 v[94:95], v7 offset:12800
    v_exp_f32 v164, v164
    v_fract_f32 v165, v165
    v_mfma_f32_16x16x32_bf16 v[248:251], v[100:103], v[72:75], v[248:251]
    v_add_u32 v8, 64512, v8
    ds_read_b64_tr_b16 v[96:97], v8 offset:4096
    v_exp_f32 v167, v167
    v_mfma_f32_16x16x32_bf16 v[252:255], v[100:103], v[76:79], v[252:255]
    ds_read_b64_tr_b16 v[98:99], v8 offset:4608
    v_fract_f32 v168, v168
    v_cos_f32 v166, v165
    s_waitcnt vmcnt(16) lgkmcnt(6)
    v_mfma_f32_16x16x32_bf16 v[192:195], v[104:107], v[64:67], v[192:195]
    ds_read_b64_tr_b16 v[100:101], v8 offset:12288
    buffer_load_dwordx4 v[72:75], v1, s[8:11], s76 offen
    buffer_load_dwordx4 v[76:79], v1, s[8:11], s76 offen offset:256
    s_sub_u32 s76, s76, 131072
    v_mfma_f32_16x16x32_bf16 v[196:199], v[104:107], v[68:71], v[196:199]
    ds_read_b64_tr_b16 v[102:103], v8 offset:12800
    v_sin_f32 v165, v165
    v_cos_f32 v169, v168
    v_mfma_f32_16x16x32_bf16 v[200:203], v[108:111], v[64:67], v[200:203]
    v_add_u32 v9, 64512, v9
    ds_read_b64_tr_b16 v[104:105], v9 offset:4096
    v_sin_f32 v168, v168
    v_mfma_f32_16x16x32_bf16 v[204:207], v[108:111], v[68:71], v[204:207]
    ds_read_b64_tr_b16 v[106:107], v9 offset:4608
    v_mul_f32 v160, v164, v166
    v_mul_f32 v161, v164, v165
    s_waitcnt lgkmcnt(6)
    v_mfma_f32_16x16x32_bf16 v[208:211], v[88:91], v[64:67], v[208:211]
    ds_read_b64_tr_b16 v[108:109], v9 offset:12288
    v_mul_f32 v162, v167, v169
    v_mfma_f32_16x16x32_bf16 v[212:215], v[88:91], v[68:71], v[212:215]
    ds_read_b64_tr_b16 v[110:111], v9 offset:12800
    v_mul_f32 v163, v167, v168
    v_fma_f32 v156, v160, v2, v156
    v_mfma_f32_16x16x32_bf16 v[216:219], v[92:95], v[64:67], v[216:219]
    ds_read_b64_tr_b16 v[88:89], v6 offset:0
    v_fma_f32 v157, v160, v3, v157
    v_mfma_f32_16x16x32_bf16 v[220:223], v[92:95], v[68:71], v[220:223]
    ds_read_b64_tr_b16 v[90:91], v6 offset:512
    v_fma_f32 v158, v162, v4, v158
    v_fma_f32 v159, v162, v5, v159
    s_waitcnt lgkmcnt(6)
    v_mfma_f32_16x16x32_bf16 v[224:227], v[96:99], v[64:67], v[224:227]
    ds_read_b64_tr_b16 v[92:93], v6 offset:8192
    v_fma_f32 v156, -v161, v3, v156
    v_mfma_f32_16x16x32_bf16 v[228:231], v[96:99], v[68:71], v[228:231]
    ds_read_b64_tr_b16 v[94:95], v6 offset:8704
    v_fma_f32 v157, v161, v2, v157
    v_fma_f32 v158, -v163, v5, v158
    v_mfma_f32_16x16x32_bf16 v[232:235], v[100:103], v[64:67], v[232:235]
    ds_read_b64_tr_b16 v[96:97], v7 offset:0
    v_fma_f32 v159, v163, v4, v159
    v_mfma_f32_16x16x32_bf16 v[236:239], v[100:103], v[68:71], v[236:239]
    ds_read_b64_tr_b16 v[98:99], v7 offset:512
    s_lshl_b32 s7, s3, 5
    v_add_u32 v10, s7, v172
    s_waitcnt lgkmcnt(6)
    v_mfma_f32_16x16x32_bf16 v[240:243], v[104:107], v[64:67], v[240:243]
    ds_read_b64_tr_b16 v[100:101], v7 offset:8192
    v_cvt_f32_u32 v10, v10
    v_mfma_f32_16x16x32_bf16 v[244:247], v[104:107], v[68:71], v[244:247]
    ds_read_b64_tr_b16 v[102:103], v7 offset:8704
    buffer_load_dwordx4 v[160:163], v13, s[36:39], s84 offen offset:0 sc1
    buffer_load_dwordx4 v[164:167], v13, s[36:39], s84 offen offset:256 sc1
    v_mfma_f32_16x16x32_bf16 v[248:251], v[108:111], v[64:67], v[248:251]
    ds_read_b64_tr_b16 v[104:105], v8 offset:0
    buffer_load_dwordx4 v[168:171], v13, s[36:39], s84 offen offset:512 sc1
    v_mfma_f32_16x16x32_bf16 v[252:255], v[108:111], v[68:71], v[252:255]
    ds_read_b64_tr_b16 v[106:107], v8 offset:512
    buffer_load_dwordx4 v[172:175], v13, s[36:39], s84 offen offset:768 sc1
    buffer_load_dwordx4 v[144:147], v13, s[36:39], s84 offen offset:1024 sc1
    s_waitcnt vmcnt(19) lgkmcnt(6)
    v_mfma_f32_16x16x32_bf16 v[192:195], v[88:91], v[56:59], v[192:195]
    ds_read_b64_tr_b16 v[108:109], v8 offset:8192
    buffer_load_dwordx4 v[64:67], v1, s[8:11], s76 offen
    buffer_load_dwordx4 v[68:71], v1, s[8:11], s76 offen offset:256
    s_sub_u32 s76, s76, 131072
    v_mfma_f32_16x16x32_bf16 v[196:199], v[88:91], v[60:63], v[196:199]
    ds_read_b64_tr_b16 v[110:111], v8 offset:8704
    buffer_load_dwordx4 v[148:151], v13, s[36:39], s84 offen offset:1280 sc1
    buffer_load_dwordx4 v[152:155], v13, s[36:39], s84 offen offset:1536 sc1
    v_mfma_f32_16x16x32_bf16 v[200:203], v[92:95], v[56:59], v[200:203]
    ds_read_b64_tr_b16 v[88:89], v9 offset:0
    v_mul_f32 v176, 0xbfb8aa3b, v176
    v_mfma_f32_16x16x32_bf16 v[204:207], v[92:95], v[60:63], v[204:207]
    ds_read_b64_tr_b16 v[90:91], v9 offset:512
    v_mul_f32 v177, 0xbfb8aa3b, v177
    v_mul_f32 v178, 0xbfb8aa3b, v178
    s_waitcnt lgkmcnt(6)
    v_mfma_f32_16x16x32_bf16 v[208:211], v[96:99], v[56:59], v[208:211]
    ds_read_b64_tr_b16 v[92:93], v9 offset:8192
    v_mul_f32 v179, 0xbfb8aa3b, v179
    v_mfma_f32_16x16x32_bf16 v[212:215], v[96:99], v[60:63], v[212:215]
    ds_read_b64_tr_b16 v[94:95], v9 offset:8704
    v_mul_f32 v180, 0xbfb8aa3b, v180
    v_mul_f32 v181, 0xbfb8aa3b, v181
    s_barrier
    v_mfma_f32_16x16x32_bf16 v[216:219], v[100:103], v[56:59], v[216:219]
    ds_read_b64_tr_b16 v[96:97], v6 offset:25600
    s_add_u32 m0, s79, 43008
    s_nop 0
    buffer_load_dwordx4 v36, s[12:15], s77 offen lds
    s_add_u32 m0, s79, 51200
    s_nop 0
    buffer_load_dwordx4 v36, s[16:19], s77 offen lds
    s_sub_u32 s77, s77, 458752
    v_mfma_f32_16x16x32_bf16 v[220:223], v[100:103], v[60:63], v[220:223]
    ds_read_b64_tr_b16 v[98:99], v6 offset:26112
    v_mul_f32 v182, 0xbfb8aa3b, v182
    v_mul_f32 v183, 0xbfb8aa3b, v183
    s_waitcnt lgkmcnt(6)
    v_mfma_f32_16x16x32_bf16 v[224:227], v[104:107], v[56:59], v[224:227]
    ds_read_b64_tr_b16 v[100:101], v6 offset:33792
    v_exp_f32 v176, v176
    v_mfma_f32_16x16x32_bf16 v[228:231], v[104:107], v[60:63], v[228:231]
    ds_read_b64_tr_b16 v[102:103], v6 offset:34304
    v_exp_f32 v177, v177
    v_exp_f32 v178, v178
    v_mfma_f32_16x16x32_bf16 v[232:235], v[108:111], v[56:59], v[232:235]
    ds_read_b64_tr_b16 v[104:105], v7 offset:25600
    v_exp_f32 v179, v179
    v_mfma_f32_16x16x32_bf16 v[236:239], v[108:111], v[60:63], v[236:239]
    ds_read_b64_tr_b16 v[106:107], v7 offset:26112
    v_exp_f32 v180, v180
    v_exp_f32 v181, v181
    s_waitcnt lgkmcnt(6)
    v_mfma_f32_16x16x32_bf16 v[240:243], v[88:91], v[56:59], v[240:243]
    ds_read_b64_tr_b16 v[108:109], v7 offset:33792
    v_exp_f32 v182, v182
    v_mfma_f32_16x16x32_bf16 v[244:247], v[88:91], v[60:63], v[244:247]
    ds_read_b64_tr_b16 v[110:111], v7 offset:34304
    v_exp_f32 v183, v183
    v_add_f32 v176, 1.0, v176
    v_mfma_f32_16x16x32_bf16 v[248:251], v[92:95], v[56:59], v[248:251]
    ds_read_b64_tr_b16 v[88:89], v8 offset:25600
    v_add_f32 v177, 1.0, v177
    v_mfma_f32_16x16x32_bf16 v[252:255], v[92:95], v[60:63], v[252:255]
    ds_read_b64_tr_b16 v[90:91], v8 offset:26112
    v_add_f32 v178, 1.0, v178
    v_add_f32 v179, 1.0, v179
    s_waitcnt vmcnt(22) lgkmcnt(6)
    v_mfma_f32_16x16x32_bf16 v[192:195], v[96:99], v[48:51], v[192:195]
    ds_read_b64_tr_b16 v[92:93], v8 offset:33792
    buffer_load_dwordx4 v[56:59], v1, s[8:11], s76 offen
    buffer_load_dwordx4 v[60:63], v1, s[8:11], s76 offen offset:256
    s_sub_u32 s76, s76, 131072
    v_mfma_f32_16x16x32_bf16 v[196:199], v[96:99], v[52:55], v[196:199]
    ds_read_b64_tr_b16 v[94:95], v8 offset:34304
    v_add_f32 v180, 1.0, v180
    v_add_f32 v181, 1.0, v181
    v_mfma_f32_16x16x32_bf16 v[200:203], v[100:103], v[48:51], v[200:203]
    ds_read_b64_tr_b16 v[96:97], v9 offset:25600
    v_add_f32 v182, 1.0, v182
    v_mfma_f32_16x16x32_bf16 v[204:207], v[100:103], v[52:55], v[204:207]
    ds_read_b64_tr_b16 v[98:99], v9 offset:26112
    v_add_f32 v183, 1.0, v183
    v_rcp_f32 v176, v176
    s_waitcnt lgkmcnt(6)
    v_mfma_f32_16x16x32_bf16 v[208:211], v[104:107], v[48:51], v[208:211]
    ds_read_b64_tr_b16 v[100:101], v9 offset:33792
    v_rcp_f32 v177, v177
    v_mfma_f32_16x16x32_bf16 v[212:215], v[104:107], v[52:55], v[212:215]
    ds_read_b64_tr_b16 v[102:103], v9 offset:34304
    v_rcp_f32 v178, v178
    v_rcp_f32 v179, v179
    v_mfma_f32_16x16x32_bf16 v[216:219], v[108:111], v[48:51], v[216:219]
    ds_read_b64_tr_b16 v[104:105], v6 offset:21504
    v_rcp_f32 v180, v180
    v_mfma_f32_16x16x32_bf16 v[220:223], v[108:111], v[52:55], v[220:223]
    ds_read_b64_tr_b16 v[106:107], v6 offset:22016
    v_rcp_f32 v181, v181
    v_rcp_f32 v182, v182
    s_waitcnt lgkmcnt(6)
    v_mfma_f32_16x16x32_bf16 v[224:227], v[88:91], v[48:51], v[224:227]
    ds_read_b64_tr_b16 v[108:109], v6 offset:29696
    v_rcp_f32 v183, v183
    v_mfma_f32_16x16x32_bf16 v[228:231], v[88:91], v[52:55], v[228:231]
    ds_read_b64_tr_b16 v[110:111], v6 offset:30208
    v_mul_f32 v176, v176, v184
    v_mul_f32 v177, v177, v185
    v_mfma_f32_16x16x32_bf16 v[232:235], v[92:95], v[48:51], v[232:235]
    ds_read_b64_tr_b16 v[88:89], v7 offset:21504
    v_mul_f32 v178, v178, v186
    v_mfma_f32_16x16x32_bf16 v[236:239], v[92:95], v[52:55], v[236:239]
    ds_read_b64_tr_b16 v[90:91], v7 offset:22016
    v_mul_f32 v179, v179, v187
    v_mul_f32 v180, v180, v188
    s_waitcnt lgkmcnt(6)
    v_mfma_f32_16x16x32_bf16 v[240:243], v[96:99], v[48:51], v[240:243]
    ds_read_b64_tr_b16 v[92:93], v7 offset:29696
    v_mul_f32 v181, v181, v189
    v_mfma_f32_16x16x32_bf16 v[244:247], v[96:99], v[52:55], v[244:247]
    ds_read_b64_tr_b16 v[94:95], v7 offset:30208
    v_mul_f32 v182, v182, v190
    v_mul_f32 v183, v183, v191
    v_mfma_f32_16x16x32_bf16 v[248:251], v[100:103], v[48:51], v[248:251]
    ds_read_b64_tr_b16 v[96:97], v8 offset:21504
    v_cvt_pk_bf16_f32 v184, v176, v177
    v_mfma_f32_16x16x32_bf16 v[252:255], v[100:103], v[52:55], v[252:255]
    ds_read_b64_tr_b16 v[98:99], v8 offset:22016
    v_cvt_pk_bf16_f32 v185, v178, v179
    v_cvt_pk_bf16_f32 v186, v180, v181
    s_waitcnt vmcnt(20) lgkmcnt(6)
    v_mfma_f32_16x16x32_bf16 v[192:195], v[104:107], v[40:43], v[192:195]
    ds_read_b64_tr_b16 v[100:101], v8 offset:29696
    buffer_load_dwordx4 v[48:51], v1, s[8:11], s76 offen
    buffer_load_dwordx4 v[52:55], v1, s[8:11], s76 offen offset:256
    s_sub_u32 s76, s76, 131072
    v_mfma_f32_16x16x32_bf16 v[196:199], v[104:107], v[44:47], v[196:199]
    ds_read_b64_tr_b16 v[102:103], v8 offset:30208
    v_cvt_pk_bf16_f32 v187, v182, v183
    s_add_u32 s89, s82, 131072
    v_mfma_f32_16x16x32_bf16 v[200:203], v[108:111], v[40:43], v[200:203]
    ds_read_b64_tr_b16 v[104:105], v9 offset:21504
    v_permlane16_swap_b32 v184, v186
    v_mfma_f32_16x16x32_bf16 v[204:207], v[108:111], v[44:47], v[204:207]
    ds_read_b64_tr_b16 v[106:107], v9 offset:22016
    v_permlane16_swap_b32 v185, v187
    buffer_store_dwordx4 v[184:187], v12, s[32:35], s89 offen sc1
    s_waitcnt lgkmcnt(6)
    v_mfma_f32_16x16x32_bf16 v[208:211], v[88:91], v[40:43], v[208:211]
    ds_read_b64_tr_b16 v[108:109], v9 offset:29696
    v_mul_f32 v184, 0x43800000, v16
    v_mfma_f32_16x16x32_bf16 v[212:215], v[88:91], v[44:47], v[212:215]
    ds_read_b64_tr_b16 v[110:111], v9 offset:30208
    v_mul_f32 v185, 0x43800000, v18
    v_mul_f32 v187, 0x43800000, v17
    s_barrier
    v_mfma_f32_16x16x32_bf16 v[216:219], v[92:95], v[40:43], v[216:219]
    ds_read_b64_tr_b16 v[88:89], v6 offset:47104
    s_add_u32 m0, s79, 64512
    s_nop 0
    buffer_load_dwordx4 v36, s[12:15], s77 offen lds
    s_add_u32 m0, s79, 72704
    s_nop 0
    buffer_load_dwordx4 v36, s[16:19], s77 offen lds
    s_sub_u32 s77, s77, 458752
    v_mfma_f32_16x16x32_bf16 v[220:223], v[92:95], v[44:47], v[220:223]
    ds_read_b64_tr_b16 v[90:91], v6 offset:47616
    v_mul_f32 v188, 0x43800000, v19
    v_exp_f32 v184, v184
    s_waitcnt lgkmcnt(6)
    v_mfma_f32_16x16x32_bf16 v[224:227], v[96:99], v[40:43], v[224:227]
    ds_read_b64_tr_b16 v[92:93], v6 offset:55296
    v_fract_f32 v185, v185
    v_mfma_f32_16x16x32_bf16 v[228:231], v[96:99], v[44:47], v[228:231]
    ds_read_b64_tr_b16 v[94:95], v6 offset:55808
    v_exp_f32 v187, v187
    v_fract_f32 v188, v188
    v_mfma_f32_16x16x32_bf16 v[232:235], v[100:103], v[40:43], v[232:235]
    ds_read_b64_tr_b16 v[96:97], v7 offset:47104
    v_cos_f32 v186, v185
    v_mfma_f32_16x16x32_bf16 v[236:239], v[100:103], v[44:47], v[236:239]
    ds_read_b64_tr_b16 v[98:99], v7 offset:47616
    v_sin_f32 v185, v185
    v_cos_f32 v189, v188
    s_waitcnt lgkmcnt(6)
    v_mfma_f32_16x16x32_bf16 v[240:243], v[104:107], v[40:43], v[240:243]
    ds_read_b64_tr_b16 v[100:101], v7 offset:55296
    v_sin_f32 v188, v188
    v_mfma_f32_16x16x32_bf16 v[244:247], v[104:107], v[44:47], v[244:247]
    ds_read_b64_tr_b16 v[102:103], v7 offset:55808
    v_mul_f32 v176, v184, v186
    v_mul_f32 v177, v184, v185
    v_mfma_f32_16x16x32_bf16 v[248:251], v[108:111], v[40:43], v[248:251]
    ds_read_b64_tr_b16 v[104:105], v8 offset:47104
    v_mul_f32 v178, v187, v189
    v_mfma_f32_16x16x32_bf16 v[252:255], v[108:111], v[44:47], v[252:255]
    ds_read_b64_tr_b16 v[106:107], v8 offset:47616
    v_mul_f32 v179, v187, v188
    v_mul_f32 v184, v10, v16
    s_waitcnt vmcnt(23) lgkmcnt(6)
    v_mfma_f32_16x16x32_bf16 v[192:195], v[88:91], v[80:83], v[192:195]
    ds_read_b64_tr_b16 v[108:109], v8 offset:55296
    buffer_load_dwordx4 v[40:43], v1, s[8:11], s76 offen
    buffer_load_dwordx4 v[44:47], v1, s[8:11], s76 offen offset:256
    s_sub_u32 s76, s76, 131072
    v_mfma_f32_16x16x32_bf16 v[196:199], v[88:91], v[84:87], v[196:199]
    ds_read_b64_tr_b16 v[110:111], v8 offset:55808
    v_mul_f32 v185, v10, v18
    v_mul_f32 v187, v10, v17
    v_mfma_f32_16x16x32_bf16 v[200:203], v[92:95], v[80:83], v[200:203]
    ds_read_b64_tr_b16 v[88:89], v9 offset:47104
    v_mul_f32 v188, v10, v19
    v_mfma_f32_16x16x32_bf16 v[204:207], v[92:95], v[84:87], v[204:207]
    ds_read_b64_tr_b16 v[90:91], v9 offset:47616
    v_exp_f32 v184, v184
    v_fract_f32 v185, v185
    s_waitcnt lgkmcnt(6)
    v_mfma_f32_16x16x32_bf16 v[208:211], v[96:99], v[80:83], v[208:211]
    ds_read_b64_tr_b16 v[92:93], v9 offset:55296
    v_exp_f32 v187, v187
    v_mfma_f32_16x16x32_bf16 v[212:215], v[96:99], v[84:87], v[212:215]
    ds_read_b64_tr_b16 v[94:95], v9 offset:55808
    v_fract_f32 v188, v188
    v_cos_f32 v186, v185
    v_mfma_f32_16x16x32_bf16 v[216:219], v[100:103], v[80:83], v[216:219]
    ds_read_b64_tr_b16 v[96:97], v6 offset:43008
    v_sin_f32 v185, v185
    v_mfma_f32_16x16x32_bf16 v[220:223], v[100:103], v[84:87], v[220:223]
    ds_read_b64_tr_b16 v[98:99], v6 offset:43520
    v_cos_f32 v189, v188
    v_sin_f32 v188, v188
    s_waitcnt lgkmcnt(6)
    v_mfma_f32_16x16x32_bf16 v[224:227], v[104:107], v[80:83], v[224:227]
    ds_read_b64_tr_b16 v[100:101], v6 offset:51200
    v_mul_f32 v180, v184, v186
    v_mfma_f32_16x16x32_bf16 v[228:231], v[104:107], v[84:87], v[228:231]
    ds_read_b64_tr_b16 v[102:103], v6 offset:51712
    v_mul_f32 v181, v184, v185
    v_mul_f32 v182, v187, v189
    v_mfma_f32_16x16x32_bf16 v[232:235], v[108:111], v[80:83], v[232:235]
    ds_read_b64_tr_b16 v[104:105], v7 offset:43008
    v_mul_f32 v183, v187, v188
    v_mfma_f32_16x16x32_bf16 v[236:239], v[108:111], v[84:87], v[236:239]
    ds_read_b64_tr_b16 v[106:107], v7 offset:43520
    s_waitcnt vmcnt(11)
    v_max3_u32 v11, v160, v161, v162
    v_max3_u32 v11, v11, v163, v164
    s_waitcnt lgkmcnt(6)
    v_mfma_f32_16x16x32_bf16 v[240:243], v[88:91], v[80:83], v[240:243]
    ds_read_b64_tr_b16 v[108:109], v7 offset:51200
    v_max3_u32 v11, v11, v165, v166
    v_mfma_f32_16x16x32_bf16 v[244:247], v[88:91], v[84:87], v[244:247]
    ds_read_b64_tr_b16 v[110:111], v7 offset:51712
    v_max3_u32 v11, v11, v167, v168
    v_max3_u32 v11, v11, v169, v170
    v_mfma_f32_16x16x32_bf16 v[248:251], v[92:95], v[80:83], v[248:251]
    ds_read_b64_tr_b16 v[88:89], v8 offset:43008
    v_max3_u32 v11, v11, v171, v172
    v_mfma_f32_16x16x32_bf16 v[252:255], v[92:95], v[84:87], v[252:255]
    ds_read_b64_tr_b16 v[90:91], v8 offset:43520
    v_max3_u32 v11, v11, v173, v174
    v_max3_u32 v11, v11, v175, v144
    s_waitcnt lgkmcnt(6)
    v_mfma_f32_16x16x32_bf16 v[192:195], v[96:99], v[72:75], v[192:195]
    ds_read_b64_tr_b16 v[92:93], v8 offset:51200
    buffer_load_dwordx4 v[80:83], v1, s[8:11], s76 offen
    buffer_load_dwordx4 v[84:87], v1, s[8:11], s76 offen offset:256
    s_sub_u32 s76, s76, 131072
    v_mfma_f32_16x16x32_bf16 v[196:199], v[96:99], v[76:79], v[196:199]
    ds_read_b64_tr_b16 v[94:95], v8 offset:51712
    v_max3_u32 v11, v11, v145, v146
    v_max3_u32 v11, v11, v147, v148
    v_mfma_f32_16x16x32_bf16 v[200:203], v[100:103], v[72:75], v[200:203]
    ds_read_b64_tr_b16 v[96:97], v9 offset:43008
    v_max3_u32 v11, v11, v149, v150
    v_mfma_f32_16x16x32_bf16 v[204:207], v[100:103], v[76:79], v[204:207]
    ds_read_b64_tr_b16 v[98:99], v9 offset:43520
    v_max3_u32 v11, v11, v151, v152
    v_max3_u32 v11, v11, v153, v154
    s_waitcnt lgkmcnt(6)
    v_mfma_f32_16x16x32_bf16 v[208:211], v[104:107], v[72:75], v[208:211]
    ds_read_b64_tr_b16 v[100:101], v9 offset:51200
    v_max_u32 v11, v11, v155
    v_mfma_f32_16x16x32_bf16 v[212:215], v[104:107], v[76:79], v[212:215]
    ds_read_b64_tr_b16 v[102:103], v9 offset:51712
    v_cmp_eq_u32 vcc, -1, v11
    s_nop 3
    s_cmp_eq_u64 vcc, 0
    s_cbranch_scc0 K2_SLOW
K2_BACK:
    s_barrier
    v_mfma_f32_16x16x32_bf16 v[216:219], v[108:111], v[72:75], v[216:219]
    v_subrev_u32 v6, 64512, v6
    ds_read_b64_tr_b16 v[104:105], v6 offset:4096
    s_add_u32 m0, s79, 86016
    s_nop 0
    buffer_load_dwordx4 v36, s[12:15], s77 offen lds
    s_add_u32 m0, s79, 94208
    s_nop 0
    buffer_load_dwordx4 v36, s[16:19], s77 offen lds
    s_sub_u32 s77, s77, 458752
    v_mfma_f32_16x16x32_bf16 v[220:223], v[108:111], v[76:79], v[220:223]
    ds_read_b64_tr_b16 v[106:107], v6 offset:4608
    v_fma_f32 v164, v176, v160, v164
    v_fma_f32 v165, v176, v161, v165
    s_waitcnt lgkmcnt(6)
    v_mfma_f32_16x16x32_bf16 v[224:227], v[88:91], v[72:75], v[224:227]
    ds_read_b64_tr_b16 v[108:109], v6 offset:12288
    v_fma_f32 v166, v178, v162, v166
    v_mfma_f32_16x16x32_bf16 v[228:231], v[88:91], v[76:79], v[228:231]
    ds_read_b64_tr_b16 v[110:111], v6 offset:12800
    v_fma_f32 v167, v178, v163, v167
    v_fma_f32 v164, -v177, v161, v164
    v_mfma_f32_16x16x32_bf16 v[232:235], v[92:95], v[72:75], v[232:235]
    v_subrev_u32 v7, 64512, v7
    ds_read_b64_tr_b16 v[88:89], v7 offset:4096
    v_fma_f32 v165, v177, v160, v165
    v_mfma_f32_16x16x32_bf16 v[236:239], v[92:95], v[76:79], v[236:239]
    ds_read_b64_tr_b16 v[90:91], v7 offset:4608
    v_fma_f32 v166, -v179, v163, v166
    v_fma_f32 v167, v179, v162, v167
    s_waitcnt lgkmcnt(6)
    v_mfma_f32_16x16x32_bf16 v[240:243], v[96:99], v[72:75], v[240:243]
    ds_read_b64_tr_b16 v[92:93], v7 offset:12288
    v_fma_f32 v168, v176, v164, v168
    v_mfma_f32_16x16x32_bf16 v[244:247], v[96:99], v[76:79], v[244:247]
    ds_read_b64_tr_b16 v[94:95], v7 offset:12800
    v_fma_f32 v169, v176, v165, v169
    v_fma_f32 v170, v178, v166, v170
    v_mfma_f32_16x16x32_bf16 v[248:251], v[100:103], v[72:75], v[248:251]
    v_subrev_u32 v8, 64512, v8
    ds_read_b64_tr_b16 v[96:97], v8 offset:4096
    v_fma_f32 v171, v178, v167, v171
    v_mfma_f32_16x16x32_bf16 v[252:255], v[100:103], v[76:79], v[252:255]
    ds_read_b64_tr_b16 v[98:99], v8 offset:4608
    v_fma_f32 v168, -v177, v165, v168
    v_fma_f32 v169, v177, v164, v169
    s_waitcnt lgkmcnt(6)
    v_mfma_f32_16x16x32_bf16 v[192:195], v[104:107], v[64:67], v[192:195]
    ds_read_b64_tr_b16 v[100:101], v8 offset:12288
    buffer_load_dwordx4 v[72:75], v1, s[8:11], s76 offen
    buffer_load_dwordx4 v[76:79], v1, s[8:11], s76 offen offset:256
    s_sub_u32 s76, s76, 131072
    v_mfma_f32_16x16x32_bf16 v[196:199], v[104:107], v[68:71], v[196:199]
    ds_read_b64_tr_b16 v[102:103], v8 offset:12800
    v_fma_f32 v170, -v179, v167, v170
    v_fma_f32 v171, v179, v166, v171
    v_mfma_f32_16x16x32_bf16 v[200:203], v[108:111], v[64:67], v[200:203]
    v_subrev_u32 v9, 64512, v9
    ds_read_b64_tr_b16 v[104:105], v9 offset:4096
    v_fma_f32 v172, v176, v168, v172
    v_mfma_f32_16x16x32_bf16 v[204:207], v[108:111], v[68:71], v[204:207]
    ds_read_b64_tr_b16 v[106:107], v9 offset:4608
    v_fma_f32 v173, v176, v169, v173
    v_fma_f32 v174, v178, v170, v174
    s_waitcnt lgkmcnt(6)
    v_mfma_f32_16x16x32_bf16 v[208:211], v[88:91], v[64:67], v[208:211]
    ds_read_b64_tr_b16 v[108:109], v9 offset:12288
    v_fma_f32 v175, v178, v171, v175
    v_mfma_f32_16x16x32_bf16 v[212:215], v[88:91], v[68:71], v[212:215]
    ds_read_b64_tr_b16 v[110:111], v9 offset:12800
    v_fma_f32 v172, -v177, v169, v172
    v_fma_f32 v173, v177, v168, v173
    v_mfma_f32_16x16x32_bf16 v[216:219], v[92:95], v[64:67], v[216:219]
    ds_read_b64_tr_b16 v[88:89], v6 offset:0
    v_fma_f32 v174, -v179, v171, v174
    v_mfma_f32_16x16x32_bf16 v[220:223], v[92:95], v[68:71], v[220:223]
    ds_read_b64_tr_b16 v[90:91], v6 offset:512
    v_fma_f32 v175, v179, v170, v175
    v_fma_f32 v144, v176, v172, v144
    s_waitcnt lgkmcnt(6)
    v_mfma_f32_16x16x32_bf16 v[224:227], v[96:99], v[64:67], v[224:227]
    ds_read_b64_tr_b16 v[92:93], v6 offset:8192
    v_fma_f32 v145, v176, v173, v145
    v_mfma_f32_16x16x32_bf16 v[228:231], v[96:99], v[68:71], v[228:231]
    ds_read_b64_tr_b16 v[94:95], v6 offset:8704
    v_fma_f32 v146, v178, v174, v146
    v_fma_f32 v147, v178, v175, v147
    v_mfma_f32_16x16x32_bf16 v[232:235], v[100:103], v[64:67], v[232:235]
    ds_read_b64_tr_b16 v[96:97], v7 offset:0
    v_fma_f32 v144, -v177, v173, v144
    v_mfma_f32_16x16x32_bf16 v[236:239], v[100:103], v[68:71], v[236:239]
    ds_read_b64_tr_b16 v[98:99], v7 offset:512
    v_fma_f32 v145, v177, v172, v145
    v_fma_f32 v146, -v179, v175, v146
    s_waitcnt lgkmcnt(6)
    v_mfma_f32_16x16x32_bf16 v[240:243], v[104:107], v[64:67], v[240:243]
    ds_read_b64_tr_b16 v[100:101], v7 offset:8192
    v_fma_f32 v147, v179, v174, v147
    v_mfma_f32_16x16x32_bf16 v[244:247], v[104:107], v[68:71], v[244:247]
    ds_read_b64_tr_b16 v[102:103], v7 offset:8704
    v_fma_f32 v148, v176, v144, v148
    v_fma_f32 v149, v176, v145, v149
    v_mfma_f32_16x16x32_bf16 v[248:251], v[108:111], v[64:67], v[248:251]
    ds_read_b64_tr_b16 v[104:105], v8 offset:0
    v_fma_f32 v150, v178, v146, v150
    v_mfma_f32_16x16x32_bf16 v[252:255], v[108:111], v[68:71], v[252:255]
    ds_read_b64_tr_b16 v[106:107], v8 offset:512
    v_fma_f32 v151, v178, v147, v151
    v_fma_f32 v148, -v177, v145, v148
    s_waitcnt vmcnt(13) lgkmcnt(6)
    v_mfma_f32_16x16x32_bf16 v[192:195], v[88:91], v[56:59], v[192:195]
    ds_read_b64_tr_b16 v[108:109], v8 offset:8192
    buffer_load_dwordx4 v[64:67], v1, s[8:11], s76 offen
    buffer_load_dwordx4 v[68:71], v1, s[8:11], s76 offen offset:256
    s_sub_u32 s76, s76, 131072
    v_mfma_f32_16x16x32_bf16 v[196:199], v[88:91], v[60:63], v[196:199]
    ds_read_b64_tr_b16 v[110:111], v8 offset:8704
    v_fma_f32 v149, v177, v144, v149
    v_fma_f32 v150, -v179, v147, v150
    v_mfma_f32_16x16x32_bf16 v[200:203], v[92:95], v[56:59], v[200:203]
    ds_read_b64_tr_b16 v[88:89], v9 offset:0
    v_fma_f32 v151, v179, v146, v151
    v_mfma_f32_16x16x32_bf16 v[204:207], v[92:95], v[60:63], v[204:207]
    ds_read_b64_tr_b16 v[90:91], v9 offset:512
    v_fma_f32 v152, v176, v148, v152
    v_fma_f32 v153, v176, v149, v153
    s_waitcnt lgkmcnt(6)
    v_mfma_f32_16x16x32_bf16 v[208:211], v[96:99], v[56:59], v[208:211]
    ds_read_b64_tr_b16 v[92:93], v9 offset:8192
    v_fma_f32 v154, v178, v150, v154
    v_mfma_f32_16x16x32_bf16 v[212:215], v[96:99], v[60:63], v[212:215]
    ds_read_b64_tr_b16 v[94:95], v9 offset:8704
    v_fma_f32 v155, v178, v151, v155
    v_fma_f32 v152, -v177, v149, v152
    s_barrier
    v_mfma_f32_16x16x32_bf16 v[216:219], v[100:103], v[56:59], v[216:219]
    ds_read_b64_tr_b16 v[96:97], v6 offset:25600
    s_add_u32 m0, s79, 107520
    s_nop 0
    buffer_load_dwordx4 v36, s[12:15], s77 offen lds
    s_add_u32 m0, s79, 115712
    s_nop 0
    buffer_load_dwordx4 v36, s[16:19], s77 offen lds
    s_sub_u32 s77, s77, 458752
    v_mfma_f32_16x16x32_bf16 v[220:223], v[100:103], v[60:63], v[220:223]
    ds_read_b64_tr_b16 v[98:99], v6 offset:26112
    v_fma_f32 v153, v177, v148, v153
    v_fma_f32 v154, -v179, v151, v154
    s_waitcnt lgkmcnt(6)
    v_mfma_f32_16x16x32_bf16 v[224:227], v[104:107], v[56:59], v[224:227]
    ds_read_b64_tr_b16 v[100:101], v6 offset:33792
    v_fma_f32 v155, v179, v150, v155
    v_mfma_f32_16x16x32_bf16 v[228:231], v[104:107], v[60:63], v[228:231]
    ds_read_b64_tr_b16 v[102:103], v6 offset:34304
    v_fma_f32 v156, v180, v152, v156
    v_fma_f32 v157, v180, v153, v157
    v_mfma_f32_16x16x32_bf16 v[232:235], v[108:111], v[56:59], v[232:235]
    ds_read_b64_tr_b16 v[104:105], v7 offset:25600
    v_fma_f32 v158, v182, v154, v158
    v_mfma_f32_16x16x32_bf16 v[236:239], v[108:111], v[60:63], v[236:239]
    ds_read_b64_tr_b16 v[106:107], v7 offset:26112
    v_fma_f32 v159, v182, v155, v159
    v_fma_f32 v156, -v181, v153, v156
    s_waitcnt lgkmcnt(6)
    v_mfma_f32_16x16x32_bf16 v[240:243], v[88:91], v[56:59], v[240:243]
    ds_read_b64_tr_b16 v[108:109], v7 offset:33792
    v_fma_f32 v157, v181, v152, v157
    v_mfma_f32_16x16x32_bf16 v[244:247], v[88:91], v[60:63], v[244:247]
    ds_read_b64_tr_b16 v[110:111], v7 offset:34304
    v_fma_f32 v158, -v183, v155, v158
    v_fma_f32 v159, v183, v154, v159
    v_mfma_f32_16x16x32_bf16 v[248:251], v[92:95], v[56:59], v[248:251]
    ds_read_b64_tr_b16 v[88:89], v8 offset:25600
    v_fma_f32 v184, v20, v156, v112
    v_mfma_f32_16x16x32_bf16 v[252:255], v[92:95], v[60:63], v[252:255]
    ds_read_b64_tr_b16 v[90:91], v8 offset:26112
    v_fma_f32 v185, v20, v157, v128
    v_fma_f32 v186, v22, v158, v120
    s_waitcnt vmcnt(15) lgkmcnt(6)
    v_mfma_f32_16x16x32_bf16 v[192:195], v[96:99], v[48:51], v[192:195]
    ds_read_b64_tr_b16 v[92:93], v8 offset:33792
    buffer_load_dwordx4 v[56:59], v1, s[8:11], s76 offen
    buffer_load_dwordx4 v[60:63], v1, s[8:11], s76 offen offset:256
    s_sub_u32 s76, s76, 131072
    v_mfma_f32_16x16x32_bf16 v[196:199], v[96:99], v[52:55], v[196:199]
    ds_read_b64_tr_b16 v[94:95], v8 offset:34304
    v_fma_f32 v187, v22, v159, v136
    v_fma_f32 v184, -v21, v157, v184
    v_mfma_f32_16x16x32_bf16 v[200:203], v[100:103], v[48:51], v[200:203]
    ds_read_b64_tr_b16 v[96:97], v9 offset:25600
    v_fma_f32 v185, v21, v156, v185
    v_mfma_f32_16x16x32_bf16 v[204:207], v[100:103], v[52:55], v[204:207]
    ds_read_b64_tr_b16 v[98:99], v9 offset:26112
    v_fma_f32 v186, -v23, v159, v186
    v_fma_f32 v187, v23, v158, v187
    s_waitcnt lgkmcnt(6)
    v_mfma_f32_16x16x32_bf16 v[208:211], v[104:107], v[48:51], v[208:211]
    ds_read_b64_tr_b16 v[100:101], v9 offset:33792
    v_mul_f32 v188, v25, v185
    v_mfma_f32_16x16x32_bf16 v[212:215], v[104:107], v[52:55], v[212:215]
    ds_read_b64_tr_b16 v[102:103], v9 offset:34304
    v_mul_f32 v189, v25, v184
    v_mul_f32 v190, v27, v187
    v_mfma_f32_16x16x32_bf16 v[216:219], v[108:111], v[48:51], v[216:219]
    ds_read_b64_tr_b16 v[104:105], v6 offset:21504
    v_mul_f32 v191, v27, v186
    v_mfma_f32_16x16x32_bf16 v[220:223], v[108:111], v[52:55], v[220:223]
    ds_read_b64_tr_b16 v[106:107], v6 offset:22016
    v_fma_f32 v112, v24, v184, -v188
    v_fma_f32 v128, -v24, v185, -v189
    s_waitcnt lgkmcnt(6)
    v_mfma_f32_16x16x32_bf16 v[224:227], v[88:91], v[48:51], v[224:227]
    ds_read_b64_tr_b16 v[108:109], v6 offset:29696
    v_fma_f32 v120, v26, v186, -v190
    v_mfma_f32_16x16x32_bf16 v[228:231], v[88:91], v[52:55], v[228:231]
    ds_read_b64_tr_b16 v[110:111], v6 offset:30208
    v_fma_f32 v136, -v26, v187, -v191
    v_fma_f32 v156, v20, v184, v113
    v_mfma_f32_16x16x32_bf16 v[232:235], v[92:95], v[48:51], v[232:235]
    ds_read_b64_tr_b16 v[88:89], v7 offset:21504
    v_fma_f32 v157, v20, v185, v129
    v_mfma_f32_16x16x32_bf16 v[236:239], v[92:95], v[52:55], v[236:239]
    ds_read_b64_tr_b16 v[90:91], v7 offset:22016
    v_fma_f32 v158, v22, v186, v121
    v_fma_f32 v159, v22, v187, v137
    s_waitcnt lgkmcnt(6)
    v_mfma_f32_16x16x32_bf16 v[240:243], v[96:99], v[48:51], v[240:243]
    ds_read_b64_tr_b16 v[92:93], v7 offset:29696
    v_fma_f32 v156, -v21, v185, v156
    v_mfma_f32_16x16x32_bf16 v[244:247], v[96:99], v[52:55], v[244:247]
    ds_read_b64_tr_b16 v[94:95], v7 offset:30208
    v_fma_f32 v157, v21, v184, v157
    v_fma_f32 v158, -v23, v187, v158
    v_mfma_f32_16x16x32_bf16 v[248:251], v[100:103], v[48:51], v[248:251]
    ds_read_b64_tr_b16 v[96:97], v8 offset:21504
    v_fma_f32 v159, v23, v186, v159
    v_mfma_f32_16x16x32_bf16 v[252:255], v[100:103], v[52:55], v[252:255]
    ds_read_b64_tr_b16 v[98:99], v8 offset:22016
    v_mul_f32 v188, v25, v157
    v_mul_f32 v189, v25, v156
    s_waitcnt vmcnt(12) lgkmcnt(6)
    v_mfma_f32_16x16x32_bf16 v[192:195], v[104:107], v[40:43], v[192:195]
    ds_read_b64_tr_b16 v[100:101], v8 offset:29696
    buffer_load_dwordx4 v[48:51], v1, s[8:11], s76 offen
    buffer_load_dwordx4 v[52:55], v1, s[8:11], s76 offen offset:256
    s_sub_u32 s76, s76, 131072
    v_mfma_f32_16x16x32_bf16 v[196:199], v[104:107], v[44:47], v[196:199]
    ds_read_b64_tr_b16 v[102:103], v8 offset:30208
    v_mul_f32 v190, v27, v159
    v_mul_f32 v191, v27, v158
    v_mfma_f32_16x16x32_bf16 v[200:203], v[108:111], v[40:43], v[200:203]
    ds_read_b64_tr_b16 v[104:105], v9 offset:21504
    v_fma_f32 v113, v24, v156, -v188
    v_mfma_f32_16x16x32_bf16 v[204:207], v[108:111], v[44:47], v[204:207]
    ds_read_b64_tr_b16 v[106:107], v9 offset:22016
    v_fma_f32 v129, -v24, v157, -v189
    v_fma_f32 v121, v26, v158, -v190
    s_waitcnt lgkmcnt(6)
    v_mfma_f32_16x16x32_bf16 v[208:211], v[88:91], v[40:43], v[208:211]
    ds_read_b64_tr_b16 v[108:109], v9 offset:29696
    v_fma_f32 v137, -v26, v159, -v191
    v_mfma_f32_16x16x32_bf16 v[212:215], v[88:91], v[44:47], v[212:215]
    ds_read_b64_tr_b16 v[110:111], v9 offset:30208
    v_fma_f32 v184, v20, v156, v114
    v_fma_f32 v185, v20, v157, v130
    s_barrier
    v_mfma_f32_16x16x32_bf16 v[216:219], v[92:95], v[40:43], v[216:219]
    ds_read_b64_tr_b16 v[88:89], v6 offset:47104
    s_add_u32 m0, s79, 0
    s_nop 0
    buffer_load_dwordx4 v36, s[12:15], s77 offen lds
    s_add_u32 m0, s79, 8192
    s_nop 0
    buffer_load_dwordx4 v36, s[16:19], s77 offen lds
    s_sub_u32 s77, s77, 458752
    v_mfma_f32_16x16x32_bf16 v[220:223], v[92:95], v[44:47], v[220:223]
    ds_read_b64_tr_b16 v[90:91], v6 offset:47616
    v_fma_f32 v186, v22, v158, v122
    v_fma_f32 v187, v22, v159, v138
    s_waitcnt lgkmcnt(6)
    v_mfma_f32_16x16x32_bf16 v[224:227], v[96:99], v[40:43], v[224:227]
    ds_read_b64_tr_b16 v[92:93], v6 offset:55296
    v_fma_f32 v184, -v21, v157, v184
    v_mfma_f32_16x16x32_bf16 v[228:231], v[96:99], v[44:47], v[228:231]
    ds_read_b64_tr_b16 v[94:95], v6 offset:55808
    v_fma_f32 v185, v21, v156, v185
    v_fma_f32 v186, -v23, v159, v186
    v_mfma_f32_16x16x32_bf16 v[232:235], v[100:103], v[40:43], v[232:235]
    ds_read_b64_tr_b16 v[96:97], v7 offset:47104
    v_fma_f32 v187, v23, v158, v187
    v_mfma_f32_16x16x32_bf16 v[236:239], v[100:103], v[44:47], v[236:239]
    ds_read_b64_tr_b16 v[98:99], v7 offset:47616
    v_mul_f32 v188, v25, v185
    v_mul_f32 v189, v25, v184
    s_waitcnt lgkmcnt(6)
    v_mfma_f32_16x16x32_bf16 v[240:243], v[104:107], v[40:43], v[240:243]
    ds_read_b64_tr_b16 v[100:101], v7 offset:55296
    v_mul_f32 v190, v27, v187
    v_mfma_f32_16x16x32_bf16 v[244:247], v[104:107], v[44:47], v[244:247]
    ds_read_b64_tr_b16 v[102:103], v7 offset:55808
    v_mul_f32 v191, v27, v186
    v_fma_f32 v114, v24, v184, -v188
    v_mfma_f32_16x16x32_bf16 v[248:251], v[108:111], v[40:43], v[248:251]
    ds_read_b64_tr_b16 v[104:105], v8 offset:47104
    v_fma_f32 v130, -v24, v185, -v189
    v_mfma_f32_16x16x32_bf16 v[252:255], v[108:111], v[44:47], v[252:255]
    ds_read_b64_tr_b16 v[106:107], v8 offset:47616
    v_fma_f32 v122, v26, v186, -v190
    v_fma_f32 v138, -v26, v187, -v191
    s_waitcnt vmcnt(14) lgkmcnt(6)
    v_mfma_f32_16x16x32_bf16 v[192:195], v[88:91], v[80:83], v[192:195]
    ds_read_b64_tr_b16 v[108:109], v8 offset:55296
    buffer_load_dwordx4 v[40:43], v1, s[8:11], s76 offen
    buffer_load_dwordx4 v[44:47], v1, s[8:11], s76 offen offset:256
    s_sub_u32 s76, s76, 131072
    v_mfma_f32_16x16x32_bf16 v[196:199], v[88:91], v[84:87], v[196:199]
    ds_read_b64_tr_b16 v[110:111], v8 offset:55808
    v_fma_f32 v156, v20, v184, v115
    v_fma_f32 v157, v20, v185, v131
    v_mfma_f32_16x16x32_bf16 v[200:203], v[92:95], v[80:83], v[200:203]
    ds_read_b64_tr_b16 v[88:89], v9 offset:47104
    v_fma_f32 v158, v22, v186, v123
    v_mfma_f32_16x16x32_bf16 v[204:207], v[92:95], v[84:87], v[204:207]
    ds_read_b64_tr_b16 v[90:91], v9 offset:47616
    v_fma_f32 v159, v22, v187, v139
    v_fma_f32 v156, -v21, v185, v156
    s_waitcnt lgkmcnt(6)
    v_mfma_f32_16x16x32_bf16 v[208:211], v[96:99], v[80:83], v[208:211]
    ds_read_b64_tr_b16 v[92:93], v9 offset:55296
    v_fma_f32 v157, v21, v184, v157
    v_mfma_f32_16x16x32_bf16 v[212:215], v[96:99], v[84:87], v[212:215]
    ds_read_b64_tr_b16 v[94:95], v9 offset:55808
    v_fma_f32 v158, -v23, v187, v158
    v_fma_f32 v159, v23, v186, v159
    v_mfma_f32_16x16x32_bf16 v[216:219], v[100:103], v[80:83], v[216:219]
    ds_read_b64_tr_b16 v[96:97], v6 offset:43008
    v_mul_f32 v188, v25, v157
    v_mfma_f32_16x16x32_bf16 v[220:223], v[100:103], v[84:87], v[220:223]
    ds_read_b64_tr_b16 v[98:99], v6 offset:43520
    v_mul_f32 v189, v25, v156
    v_mul_f32 v190, v27, v159
    s_waitcnt lgkmcnt(6)
    v_mfma_f32_16x16x32_bf16 v[224:227], v[104:107], v[80:83], v[224:227]
    ds_read_b64_tr_b16 v[100:101], v6 offset:51200
    v_mul_f32 v191, v27, v158
    v_mfma_f32_16x16x32_bf16 v[228:231], v[104:107], v[84:87], v[228:231]
    ds_read_b64_tr_b16 v[102:103], v6 offset:51712
    v_fma_f32 v115, v24, v156, -v188
    v_fma_f32 v131, -v24, v157, -v189
    v_mfma_f32_16x16x32_bf16 v[232:235], v[108:111], v[80:83], v[232:235]
    ds_read_b64_tr_b16 v[104:105], v7 offset:43008
    v_fma_f32 v123, v26, v158, -v190
    v_mfma_f32_16x16x32_bf16 v[236:239], v[108:111], v[84:87], v[236:239]
    ds_read_b64_tr_b16 v[106:107], v7 offset:43520
    v_fma_f32 v139, -v26, v159, -v191
    v_fma_f32 v184, v20, v156, v116
    s_waitcnt lgkmcnt(6)
    v_mfma_f32_16x16x32_bf16 v[240:243], v[88:91], v[80:83], v[240:243]
    ds_read_b64_tr_b16 v[108:109], v7 offset:51200
    v_fma_f32 v185, v20, v157, v132
    v_mfma_f32_16x16x32_bf16 v[244:247], v[88:91], v[84:87], v[244:247]
    ds_read_b64_tr_b16 v[110:111], v7 offset:51712
    v_fma_f32 v186, v22, v158, v124
    v_fma_f32 v187, v22, v159, v140
    v_mfma_f32_16x16x32_bf16 v[248:251], v[92:95], v[80:83], v[248:251]
    ds_read_b64_tr_b16 v[88:89], v8 offset:43008
    v_fma_f32 v184, -v21, v157, v184
    v_mfma_f32_16x16x32_bf16 v[252:255], v[92:95], v[84:87], v[252:255]
    ds_read_b64_tr_b16 v[90:91], v8 offset:43520
    v_fma_f32 v185, v21, v156, v185
    v_fma_f32 v186, -v23, v159, v186
    s_waitcnt vmcnt(12) lgkmcnt(6)
    v_mfma_f32_16x16x32_bf16 v[192:195], v[96:99], v[72:75], v[192:195]
    ds_read_b64_tr_b16 v[92:93], v8 offset:51200
    buffer_load_dwordx4 v[80:83], v1, s[8:11], s76 offen
    buffer_load_dwordx4 v[84:87], v1, s[8:11], s76 offen offset:256
    s_sub_u32 s76, s76, 131072
    v_mfma_f32_16x16x32_bf16 v[196:199], v[96:99], v[76:79], v[196:199]
    ds_read_b64_tr_b16 v[94:95], v8 offset:51712
    v_fma_f32 v187, v23, v158, v187
    v_mul_f32 v188, v25, v185
    v_mfma_f32_16x16x32_bf16 v[200:203], v[100:103], v[72:75], v[200:203]
    ds_read_b64_tr_b16 v[96:97], v9 offset:43008
    v_mul_f32 v189, v25, v184
    v_mfma_f32_16x16x32_bf16 v[204:207], v[100:103], v[76:79], v[204:207]
    ds_read_b64_tr_b16 v[98:99], v9 offset:43520
    v_mul_f32 v190, v27, v187
    v_mul_f32 v191, v27, v186
    s_waitcnt lgkmcnt(6)
    v_mfma_f32_16x16x32_bf16 v[208:211], v[104:107], v[72:75], v[208:211]
    ds_read_b64_tr_b16 v[100:101], v9 offset:51200
    v_fma_f32 v116, v24, v184, -v188
    v_mfma_f32_16x16x32_bf16 v[212:215], v[104:107], v[76:79], v[212:215]
    ds_read_b64_tr_b16 v[102:103], v9 offset:51712
    v_fma_f32 v132, -v24, v185, -v189
    v_fma_f32 v124, v26, v186, -v190
    s_barrier
    v_mfma_f32_16x16x32_bf16 v[216:219], v[108:111], v[72:75], v[216:219]
    v_add_u32 v6, 64512, v6
    ds_read_b64_tr_b16 v[104:105], v6 offset:4096
    s_add_u32 m0, s79, 21504
    s_nop 0
    buffer_load_dwordx4 v36, s[12:15], s77 offen lds
    s_add_u32 m0, s79, 29696
    s_nop 0
    buffer_load_dwordx4 v36, s[16:19], s77 offen lds
    s_sub_u32 s77, s77, 458752
    v_mfma_f32_16x16x32_bf16 v[220:223], v[108:111], v[76:79], v[220:223]
    ds_read_b64_tr_b16 v[106:107], v6 offset:4608
    v_fma_f32 v140, -v26, v187, -v191
    v_fma_f32 v156, v20, v184, v117
    s_waitcnt lgkmcnt(6)
    v_mfma_f32_16x16x32_bf16 v[224:227], v[88:91], v[72:75], v[224:227]
    ds_read_b64_tr_b16 v[108:109], v6 offset:12288
    v_fma_f32 v157, v20, v185, v133
    v_mfma_f32_16x16x32_bf16 v[228:231], v[88:91], v[76:79], v[228:231]
    ds_read_b64_tr_b16 v[110:111], v6 offset:12800
    v_fma_f32 v158, v22, v186, v125
    v_fma_f32 v159, v22, v187, v141
    v_mfma_f32_16x16x32_bf16 v[232:235], v[92:95], v[72:75], v[232:235]
    v_add_u32 v7, 64512, v7
    ds_read_b64_tr_b16 v[88:89], v7 offset:4096
    v_fma_f32 v156, -v21, v185, v156
    v_mfma_f32_16x16x32_bf16 v[236:239], v[92:95], v[76:79], v[236:239]
    ds_read_b64_tr_b16 v[90:91], v7 offset:4608
    v_fma_f32 v157, v21, v184, v157
    v_fma_f32 v158, -v23, v187, v158
    s_waitcnt lgkmcnt(6)
    v_mfma_f32_16x16x32_bf16 v[240:243], v[96:99], v[72:75], v[240:243]
    ds_read_b64_tr_b16 v[92:93], v7 offset:12288
    v_fma_f32 v159, v23, v186, v159
    v_mfma_f32_16x16x32_bf16 v[244:247], v[96:99], v[76:79], v[244:247]
    ds_read_b64_tr_b16 v[94:95], v7 offset:12800
    v_mul_f32 v188, v25, v157
    v_mul_f32 v189, v25, v156
    v_mfma_f32_16x16x32_bf16 v[248:251], v[100:103], v[72:75], v[248:251]
    v_add_u32 v8, 64512, v8
    ds_read_b64_tr_b16 v[96:97], v8 offset:4096
    v_mul_f32 v190, v27, v159
    v_mfma_f32_16x16x32_bf16 v[252:255], v[100:103], v[76:79], v[252:255]
    ds_read_b64_tr_b16 v[98:99], v8 offset:4608
    v_mul_f32 v191, v27, v158
    v_fma_f32 v117, v24, v156, -v188
    s_waitcnt vmcnt(14) lgkmcnt(6)
    v_mfma_f32_16x16x32_bf16 v[192:195], v[104:107], v[64:67], v[192:195]
    ds_read_b64_tr_b16 v[100:101], v8 offset:12288
    buffer_load_dwordx4 v[72:75], v1, s[8:11], s76 offen
    buffer_load_dwordx4 v[76:79], v1, s[8:11], s76 offen offset:256
    s_sub_u32 s76, s76, 131072
    v_mfma_f32_16x16x32_bf16 v[196:199], v[104:107], v[68:71], v[196:199]
    ds_read_b64_tr_b16 v[102:103], v8 offset:12800
    v_fma_f32 v133, -v24, v157, -v189
    v_fma_f32 v125, v26, v158, -v190
    v_mfma_f32_16x16x32_bf16 v[200:203], v[108:111], v[64:67], v[200:203]
    v_add_u32 v9, 64512, v9
    ds_read_b64_tr_b16 v[104:105], v9 offset:4096
    v_fma_f32 v141, -v26, v159, -v191
    v_mfma_f32_16x16x32_bf16 v[204:207], v[108:111], v[68:71], v[204:207]
    ds_read_b64_tr_b16 v[106:107], v9 offset:4608
    v_fma_f32 v184, v20, v156, v118
    v_fma_f32 v185, v20, v157, v134
    s_waitcnt lgkmcnt(6)
    v_mfma_f32_16x16x32_bf16 v[208:211], v[88:91], v[64:67], v[208:211]
    ds_read_b64_tr_b16 v[108:109], v9 offset:12288
    v_fma_f32 v186, v22, v158, v126
    v_mfma_f32_16x16x32_bf16 v[212:215], v[88:91], v[68:71], v[212:215]
    ds_read_b64_tr_b16 v[110:111], v9 offset:12800
    v_fma_f32 v187, v22, v159, v142
    v_fma_f32 v184, -v21, v157, v184
    v_mfma_f32_16x16x32_bf16 v[216:219], v[92:95], v[64:67], v[216:219]
    ds_read_b64_tr_b16 v[88:89], v6 offset:0
    v_fma_f32 v185, v21, v156, v185
    v_mfma_f32_16x16x32_bf16 v[220:223], v[92:95], v[68:71], v[220:223]
    ds_read_b64_tr_b16 v[90:91], v6 offset:512
    v_fma_f32 v186, -v23, v159, v186
    v_fma_f32 v187, v23, v158, v187
    s_waitcnt lgkmcnt(6)
    v_mfma_f32_16x16x32_bf16 v[224:227], v[96:99], v[64:67], v[224:227]
    ds_read_b64_tr_b16 v[92:93], v6 offset:8192
    v_mul_f32 v188, v25, v185
    v_mfma_f32_16x16x32_bf16 v[228:231], v[96:99], v[68:71], v[228:231]
    ds_read_b64_tr_b16 v[94:95], v6 offset:8704
    v_mul_f32 v189, v25, v184
    v_mul_f32 v190, v27, v187
    v_mfma_f32_16x16x32_bf16 v[232:235], v[100:103], v[64:67], v[232:235]
    ds_read_b64_tr_b16 v[96:97], v7 offset:0
    v_mul_f32 v191, v27, v186
    v_mfma_f32_16x16x32_bf16 v[236:239], v[100:103], v[68:71], v[236:239]
    ds_read_b64_tr_b16 v[98:99], v7 offset:512
    v_fma_f32 v118, v24, v184, -v188
    v_fma_f32 v134, -v24, v185, -v189
    s_waitcnt lgkmcnt(6)
    v_mfma_f32_16x16x32_bf16 v[240:243], v[104:107], v[64:67], v[240:243]
    ds_read_b64_tr_b16 v[100:101], v7 offset:8192
    v_fma_f32 v126, v26, v186, -v190
    v_mfma_f32_16x16x32_bf16 v[244:247], v[104:107], v[68:71], v[244:247]
    ds_read_b64_tr_b16 v[102:103], v7 offset:8704
    v_fma_f32 v142, -v26, v187, -v191
    v_fma_f32 v156, v20, v184, v119
    v_mfma_f32_16x16x32_bf16 v[248:251], v[108:111], v[64:67], v[248:251]
    ds_read_b64_tr_b16 v[104:105], v8 offset:0
    v_fma_f32 v157, v20, v185, v135
    v_mfma_f32_16x16x32_bf16 v[252:255], v[108:111], v[68:71], v[252:255]
    ds_read_b64_tr_b16 v[106:107], v8 offset:512
    v_fma_f32 v158, v22, v186, v127
    v_fma_f32 v159, v22, v187, v143
    s_waitcnt vmcnt(12) lgkmcnt(6)
    v_mfma_f32_16x16x32_bf16 v[192:195], v[88:91], v[56:59], v[192:195]
    ds_read_b64_tr_b16 v[108:109], v8 offset:8192
    buffer_load_dwordx4 v[64:67], v1, s[8:11], s76 offen
    buffer_load_dwordx4 v[68:71], v1, s[8:11], s76 offen offset:256
    s_sub_u32 s76, s76, 131072
    v_mfma_f32_16x16x32_bf16 v[196:199], v[88:91], v[60:63], v[196:199]
    ds_read_b64_tr_b16 v[110:111], v8 offset:8704
    v_fma_f32 v156, -v21, v185, v156
    v_fma_f32 v157, v21, v184, v157
    v_mfma_f32_16x16x32_bf16 v[200:203], v[92:95], v[56:59], v[200:203]
    ds_read_b64_tr_b16 v[88:89], v9 offset:0
    v_fma_f32 v158, -v23, v187, v158
    v_mfma_f32_16x16x32_bf16 v[204:207], v[92:95], v[60:63], v[204:207]
    ds_read_b64_tr_b16 v[90:91], v9 offset:512
    v_fma_f32 v159, v23, v186, v159
    v_mul_f32 v188, v25, v157
    s_waitcnt lgkmcnt(6)
    v_mfma_f32_16x16x32_bf16 v[208:211], v[96:99], v[56:59], v[208:211]
    ds_read_b64_tr_b16 v[92:93], v9 offset:8192
    v_mul_f32 v189, v25, v156
    v_mfma_f32_16x16x32_bf16 v[212:215], v[96:99], v[60:63], v[212:215]
    ds_read_b64_tr_b16 v[94:95], v9 offset:8704
    v_mul_f32 v190, v27, v159
    v_mul_f32 v191, v27, v158
    s_barrier
    v_mfma_f32_16x16x32_bf16 v[216:219], v[100:103], v[56:59], v[216:219]
    ds_read_b64_tr_b16 v[96:97], v6 offset:25600
    v_fma_f32 v119, v24, v156, -v188
    v_mfma_f32_16x16x32_bf16 v[220:223], v[100:103], v[60:63], v[220:223]
    ds_read_b64_tr_b16 v[98:99], v6 offset:26112
    v_fma_f32 v135, -v24, v157, -v189
    v_fma_f32 v127, v26, v158, -v190
    s_waitcnt lgkmcnt(6)
    v_mfma_f32_16x16x32_bf16 v[224:227], v[104:107], v[56:59], v[224:227]
    ds_read_b64_tr_b16 v[100:101], v6 offset:33792
    v_fma_f32 v143, -v26, v159, -v191
    v_mfma_f32_16x16x32_bf16 v[228:231], v[104:107], v[60:63], v[228:231]
    ds_read_b64_tr_b16 v[102:103], v6 offset:34304
    v_and_b32 v168, 15, v0
    v_lshrrev_b32 v169, 2, v168
    v_mfma_f32_16x16x32_bf16 v[232:235], v[108:111], v[56:59], v[232:235]
    ds_read_b64_tr_b16 v[104:105], v7 offset:25600
    v_lshrrev_b32 v170, 4, v0
    v_mfma_f32_16x16x32_bf16 v[236:239], v[108:111], v[60:63], v[236:239]
    ds_read_b64_tr_b16 v[106:107], v7 offset:26112
    v_and_b32 v171, 1, v0
    v_lshlrev_b32 v171, 4, v171
    s_waitcnt lgkmcnt(6)
    v_mfma_f32_16x16x32_bf16 v[240:243], v[88:91], v[56:59], v[240:243]
    ds_read_b64_tr_b16 v[108:109], v7 offset:33792
    v_mov_b32 v172, 0x3f80
    v_mfma_f32_16x16x32_bf16 v[244:247], v[88:91], v[60:63], v[244:247]
    ds_read_b64_tr_b16 v[110:111], v7 offset:34304
    v_lshlrev_b32 v172, v171, v172
    v_cmp_eq_u32 vcc, v169, v170
    v_mfma_f32_16x16x32_bf16 v[248:251], v[92:95], v[56:59], v[248:251]
    ds_read_b64_tr_b16 v[88:89], v8 offset:25600
    v_mov_b32 v160, 0
    v_mfma_f32_16x16x32_bf16 v[252:255], v[92:95], v[60:63], v[252:255]
    ds_read_b64_tr_b16 v[90:91], v8 offset:26112
    v_mov_b32 v161, 0
    v_cndmask_b32 v172, 0, v172, vcc
    s_waitcnt vmcnt(12) lgkmcnt(6)
    v_mfma_f32_16x16x32_bf16 v[192:195], v[96:99], v[48:51], v[192:195]
    ds_read_b64_tr_b16 v[92:93], v8 offset:33792
    buffer_load_dwordx4 v[56:59], v1, s[8:11], s76 offen
    buffer_load_dwordx4 v[60:63], v1, s[8:11], s76 offen offset:256
    s_sub_u32 s76, s76, 131072
    v_mfma_f32_16x16x32_bf16 v[196:199], v[96:99], v[52:55], v[196:199]
    ds_read_b64_tr_b16 v[94:95], v8 offset:34304
    v_and_b32 v173, 2, v0
    v_cmp_eq_u32 vcc, 0, v173
    v_mfma_f32_16x16x32_bf16 v[200:203], v[100:103], v[48:51], v[200:203]
    ds_read_b64_tr_b16 v[96:97], v9 offset:25600
    v_mov_b32 v164, 0
    v_mfma_f32_16x16x32_bf16 v[204:207], v[100:103], v[52:55], v[204:207]
    ds_read_b64_tr_b16 v[98:99], v9 offset:26112
    v_mov_b32 v165, 0
    v_cndmask_b32 v162, 0, v172, vcc
    s_waitcnt lgkmcnt(6)
    v_mfma_f32_16x16x32_bf16 v[208:211], v[104:107], v[48:51], v[208:211]
    ds_read_b64_tr_b16 v[100:101], v9 offset:33792
    v_cndmask_b32 v163, v172, 0, vcc
    v_mfma_f32_16x16x32_bf16 v[212:215], v[104:107], v[52:55], v[212:215]
    ds_read_b64_tr_b16 v[102:103], v9 offset:34304
    v_cvt_pk_bf16_f32 v112, v112, v113
    v_cvt_pk_bf16_f32 v113, v114, v115
    v_mfma_f32_16x16x32_bf16 v[216:219], v[108:111], v[48:51], v[216:219]
    ds_read_b64_tr_b16 v[104:105], v6 offset:21504
    v_cvt_pk_bf16_f32 v114, v116, v117
    v_mfma_f32_16x16x32_bf16 v[220:223], v[108:111], v[52:55], v[220:223]
    ds_read_b64_tr_b16 v[106:107], v6 offset:22016
    v_cvt_pk_bf16_f32 v115, v118, v119
    v_cvt_pk_bf16_f32 v120, v120, v121
    s_waitcnt lgkmcnt(6)
    v_mfma_f32_16x16x32_bf16 v[224:227], v[88:91], v[48:51], v[224:227]
    ds_read_b64_tr_b16 v[108:109], v6 offset:29696
    v_cvt_pk_bf16_f32 v121, v122, v123
    v_mfma_f32_16x16x32_bf16 v[228:231], v[88:91], v[52:55], v[228:231]
    ds_read_b64_tr_b16 v[110:111], v6 offset:30208
    v_cvt_pk_bf16_f32 v122, v124, v125
    v_cvt_pk_bf16_f32 v123, v126, v127
    v_mfma_f32_16x16x32_bf16 v[232:235], v[92:95], v[48:51], v[232:235]
    ds_read_b64_tr_b16 v[88:89], v7 offset:21504
    v_cvt_pk_bf16_f32 v128, v128, v129
    v_mfma_f32_16x16x32_bf16 v[236:239], v[92:95], v[52:55], v[236:239]
    ds_read_b64_tr_b16 v[90:91], v7 offset:22016
    v_cvt_pk_bf16_f32 v129, v130, v131
    v_cvt_pk_bf16_f32 v130, v132, v133
    s_waitcnt lgkmcnt(6)
    v_mfma_f32_16x16x32_bf16 v[240:243], v[96:99], v[48:51], v[240:243]
    ds_read_b64_tr_b16 v[92:93], v7 offset:29696
    v_cvt_pk_bf16_f32 v131, v134, v135
    v_mfma_f32_16x16x32_bf16 v[244:247], v[96:99], v[52:55], v[244:247]
    ds_read_b64_tr_b16 v[94:95], v7 offset:30208
    v_cvt_pk_bf16_f32 v136, v136, v137
    v_cvt_pk_bf16_f32 v137, v138, v139
    v_mfma_f32_16x16x32_bf16 v[248:251], v[100:103], v[48:51], v[248:251]
    ds_read_b64_tr_b16 v[96:97], v8 offset:21504
    v_cvt_pk_bf16_f32 v138, v140, v141
    v_mfma_f32_16x16x32_bf16 v[252:255], v[100:103], v[52:55], v[252:255]
    ds_read_b64_tr_b16 v[98:99], v8 offset:22016
    v_cvt_pk_bf16_f32 v139, v142, v143
    v_mfma_f32_16x16x32_bf16 v[116:119], v[112:115], v[162:165], 0
    s_waitcnt vmcnt(10) lgkmcnt(6)
    v_mfma_f32_16x16x32_bf16 v[192:195], v[104:107], v[40:43], v[192:195]
    ds_read_b64_tr_b16 v[100:101], v8 offset:29696
    buffer_load_dwordx4 v[48:51], v1, s[8:11], s76 offen
    buffer_load_dwordx4 v[52:55], v1, s[8:11], s76 offen offset:256
    s_sub_u32 s76, s76, 131072
    v_mfma_f32_16x16x32_bf16 v[196:199], v[104:107], v[44:47], v[196:199]
    ds_read_b64_tr_b16 v[102:103], v8 offset:30208
    v_mfma_f32_16x16x32_bf16 v[168:171], v[112:115], v[160:163], 0
    v_mfma_f32_16x16x32_bf16 v[200:203], v[108:111], v[40:43], v[200:203]
    ds_read_b64_tr_b16 v[104:105], v9 offset:21504
    v_mfma_f32_16x16x32_bf16 v[204:207], v[108:111], v[44:47], v[204:207]
    ds_read_b64_tr_b16 v[106:107], v9 offset:22016
    s_waitcnt lgkmcnt(6)
    v_mfma_f32_16x16x32_bf16 v[208:211], v[88:91], v[40:43], v[208:211]
    ds_read_b64_tr_b16 v[108:109], v9 offset:29696
    v_mfma_f32_16x16x32_bf16 v[124:127], v[120:123], v[162:165], 0
    v_mfma_f32_16x16x32_bf16 v[212:215], v[88:91], v[44:47], v[212:215]
    ds_read_b64_tr_b16 v[110:111], v9 offset:30208
    v_mfma_f32_16x16x32_bf16 v[172:175], v[120:123], v[160:163], 0
    v_cvt_pk_bf16_f32 v112, v116, v117
    s_barrier
    v_mfma_f32_16x16x32_bf16 v[216:219], v[92:95], v[40:43], v[216:219]
    ds_read_b64_tr_b16 v[88:89], v6 offset:47104
    v_cvt_pk_bf16_f32 v113, v118, v119
    v_mfma_f32_16x16x32_bf16 v[220:223], v[92:95], v[44:47], v[220:223]
    ds_read_b64_tr_b16 v[90:91], v6 offset:47616
    v_cvt_pk_bf16_f32 v114, v168, v169
    v_cvt_pk_bf16_f32 v115, v170, v171
    s_waitcnt lgkmcnt(6)
    v_mfma_f32_16x16x32_bf16 v[224:227], v[96:99], v[40:43], v[224:227]
    ds_read_b64_tr_b16 v[92:93], v6 offset:55296
    s_add_u32 s89, s83, 0
    v_mfma_f32_16x16x32_bf16 v[228:231], v[96:99], v[44:47], v[228:231]
    ds_read_b64_tr_b16 v[94:95], v6 offset:55808
    v_permlane16_swap_b32 v112, v114
    v_permlane16_swap_b32 v113, v115
    v_mfma_f32_16x16x32_bf16 v[232:235], v[100:103], v[40:43], v[232:235]
    ds_read_b64_tr_b16 v[96:97], v7 offset:47104
    buffer_store_dwordx4 v[112:115], v12, s[32:35], s89 offen sc1
    v_mfma_f32_16x16x32_bf16 v[236:239], v[100:103], v[44:47], v[236:239]
    ds_read_b64_tr_b16 v[98:99], v7 offset:47616
    v_mfma_f32_16x16x32_bf16 v[132:135], v[128:131], v[162:165], 0
    v_mfma_f32_16x16x32_bf16 v[168:171], v[128:131], v[160:163], 0
    s_waitcnt lgkmcnt(6)
    v_mfma_f32_16x16x32_bf16 v[240:243], v[104:107], v[40:43], v[240:243]
    ds_read_b64_tr_b16 v[100:101], v7 offset:55296
    v_cvt_pk_bf16_f32 v120, v124, v125
    v_mfma_f32_16x16x32_bf16 v[244:247], v[104:107], v[44:47], v[244:247]
    ds_read_b64_tr_b16 v[102:103], v7 offset:55808
    v_cvt_pk_bf16_f32 v121, v126, v127
    v_cvt_pk_bf16_f32 v122, v172, v173
    v_mfma_f32_16x16x32_bf16 v[248:251], v[108:111], v[40:43], v[248:251]
    ds_read_b64_tr_b16 v[104:105], v8 offset:47104
    v_cvt_pk_bf16_f32 v123, v174, v175
    v_mfma_f32_16x16x32_bf16 v[252:255], v[108:111], v[44:47], v[252:255]
    ds_read_b64_tr_b16 v[106:107], v8 offset:47616
    s_add_u32 s89, s83, 65536
    v_permlane16_swap_b32 v120, v122
    s_waitcnt vmcnt(11) lgkmcnt(6)
    v_mfma_f32_16x16x32_bf16 v[192:195], v[88:91], v[80:83], v[192:195]
    ds_read_b64_tr_b16 v[108:109], v8 offset:55296
    buffer_load_dwordx4 v[40:43], v1, s[8:11], s76 offen
    buffer_load_dwordx4 v[44:47], v1, s[8:11], s76 offen offset:256
    s_sub_u32 s76, s76, 131072
    v_mfma_f32_16x16x32_bf16 v[196:199], v[88:91], v[84:87], v[196:199]
    ds_read_b64_tr_b16 v[110:111], v8 offset:55808
    v_permlane16_swap_b32 v121, v123
    buffer_store_dwordx4 v[120:123], v12, s[32:35], s89 offen sc1
    v_mfma_f32_16x16x32_bf16 v[200:203], v[92:95], v[80:83], v[200:203]
    ds_read_b64_tr_b16 v[88:89], v9 offset:47104
    v_mfma_f32_16x16x32_bf16 v[140:143], v[136:139], v[162:165], 0
    v_mfma_f32_16x16x32_bf16 v[204:207], v[92:95], v[84:87], v[204:207]
    ds_read_b64_tr_b16 v[90:91], v9 offset:47616
    v_mfma_f32_16x16x32_bf16 v[172:175], v[136:139], v[160:163], 0
    v_cvt_pk_bf16_f32 v128, v132, v133
    s_waitcnt lgkmcnt(6)
    v_mfma_f32_16x16x32_bf16 v[208:211], v[96:99], v[80:83], v[208:211]
    ds_read_b64_tr_b16 v[92:93], v9 offset:55296
    v_cvt_pk_bf16_f32 v129, v134, v135
    v_mfma_f32_16x16x32_bf16 v[212:215], v[96:99], v[84:87], v[212:215]
    ds_read_b64_tr_b16 v[94:95], v9 offset:55808
    v_cvt_pk_bf16_f32 v130, v168, v169
    v_cvt_pk_bf16_f32 v131, v170, v171
    v_mfma_f32_16x16x32_bf16 v[216:219], v[100:103], v[80:83], v[216:219]
    ds_read_b64_tr_b16 v[96:97], v6 offset:43008
    s_add_u32 s89, s83, 4194304
    v_mfma_f32_16x16x32_bf16 v[220:223], v[100:103], v[84:87], v[220:223]
    ds_read_b64_tr_b16 v[98:99], v6 offset:43520
    v_permlane16_swap_b32 v128, v130
    v_permlane16_swap_b32 v129, v131
    s_waitcnt lgkmcnt(6)
    v_mfma_f32_16x16x32_bf16 v[224:227], v[104:107], v[80:83], v[224:227]
    ds_read_b64_tr_b16 v[100:101], v6 offset:51200
    buffer_store_dwordx4 v[128:131], v12, s[32:35], s89 offen sc1
    v_mfma_f32_16x16x32_bf16 v[228:231], v[104:107], v[84:87], v[228:231]
    ds_read_b64_tr_b16 v[102:103], v6 offset:51712
    v_mfma_f32_16x16x32_bf16 v[232:235], v[108:111], v[80:83], v[232:235]
    ds_read_b64_tr_b16 v[104:105], v7 offset:43008
    v_mfma_f32_16x16x32_bf16 v[236:239], v[108:111], v[84:87], v[236:239]
    ds_read_b64_tr_b16 v[106:107], v7 offset:43520
    s_waitcnt lgkmcnt(6)
    v_mfma_f32_16x16x32_bf16 v[240:243], v[88:91], v[80:83], v[240:243]
    ds_read_b64_tr_b16 v[108:109], v7 offset:51200
    v_cvt_pk_bf16_f32 v136, v140, v141
    v_mfma_f32_16x16x32_bf16 v[244:247], v[88:91], v[84:87], v[244:247]
    ds_read_b64_tr_b16 v[110:111], v7 offset:51712
    v_cvt_pk_bf16_f32 v137, v142, v143
    v_cvt_pk_bf16_f32 v138, v172, v173
    v_mfma_f32_16x16x32_bf16 v[248:251], v[92:95], v[80:83], v[248:251]
    ds_read_b64_tr_b16 v[88:89], v8 offset:43008
    v_cvt_pk_bf16_f32 v139, v174, v175
    v_mfma_f32_16x16x32_bf16 v[252:255], v[92:95], v[84:87], v[252:255]
    ds_read_b64_tr_b16 v[90:91], v8 offset:43520
    s_add_u32 s89, s83, 4259840
    v_permlane16_swap_b32 v136, v138
    s_waitcnt vmcnt(11) lgkmcnt(6)
    v_mfma_f32_16x16x32_bf16 v[192:195], v[96:99], v[72:75], v[192:195]
    ds_read_b64_tr_b16 v[92:93], v8 offset:51200
    v_permlane16_swap_b32 v137, v139
    v_mfma_f32_16x16x32_bf16 v[196:199], v[96:99], v[76:79], v[196:199]
    ds_read_b64_tr_b16 v[94:95], v8 offset:51712
    buffer_store_dwordx4 v[136:139], v12, s[32:35], s89 offen sc1
    v_mfma_f32_16x16x32_bf16 v[200:203], v[100:103], v[72:75], v[200:203]
    ds_read_b64_tr_b16 v[96:97], v9 offset:43008
    v_mfma_f32_16x16x32_bf16 v[204:207], v[100:103], v[76:79], v[204:207]
    ds_read_b64_tr_b16 v[98:99], v9 offset:43520
    s_waitcnt lgkmcnt(6)
    v_mfma_f32_16x16x32_bf16 v[208:211], v[104:107], v[72:75], v[208:211]
    ds_read_b64_tr_b16 v[100:101], v9 offset:51200
    v_mfma_f32_16x16x32_bf16 v[212:215], v[104:107], v[76:79], v[212:215]
    ds_read_b64_tr_b16 v[102:103], v9 offset:51712
    s_barrier
    v_mfma_f32_16x16x32_bf16 v[216:219], v[108:111], v[72:75], v[216:219]
    v_subrev_u32 v6, 64512, v6
    ds_read_b64_tr_b16 v[104:105], v6 offset:4096
    v_mfma_f32_16x16x32_bf16 v[220:223], v[108:111], v[76:79], v[220:223]
    ds_read_b64_tr_b16 v[106:107], v6 offset:4608
    s_waitcnt lgkmcnt(6)
    v_mfma_f32_16x16x32_bf16 v[224:227], v[88:91], v[72:75], v[224:227]
    ds_read_b64_tr_b16 v[108:109], v6 offset:12288
    v_mfma_f32_16x16x32_bf16 v[228:231], v[88:91], v[76:79], v[228:231]
    ds_read_b64_tr_b16 v[110:111], v6 offset:12800
    v_mfma_f32_16x16x32_bf16 v[232:235], v[92:95], v[72:75], v[232:235]
    ds_read_b64_tr_b16 v[88:89], v6 offset:0
    v_mfma_f32_16x16x32_bf16 v[236:239], v[92:95], v[76:79], v[236:239]
    ds_read_b64_tr_b16 v[90:91], v6 offset:512
    s_waitcnt lgkmcnt(6)
    v_mfma_f32_16x16x32_bf16 v[240:243], v[96:99], v[72:75], v[240:243]
    ds_read_b64_tr_b16 v[92:93], v6 offset:8192
    v_mfma_f32_16x16x32_bf16 v[244:247], v[96:99], v[76:79], v[244:247]
    ds_read_b64_tr_b16 v[94:95], v6 offset:8704
    s_barrier
    v_mfma_f32_16x16x32_bf16 v[248:251], v[100:103], v[72:75], v[248:251]
    ds_read_b64_tr_b16 v[96:97], v6 offset:25600
    v_mfma_f32_16x16x32_bf16 v[252:255], v[100:103], v[76:79], v[252:255]
    ds_read_b64_tr_b16 v[98:99], v6 offset:26112
    s_waitcnt vmcnt(10) lgkmcnt(6)
    v_mfma_f32_16x16x32_bf16 v[192:195], v[104:107], v[64:67], v[192:195]
    ds_read_b64_tr_b16 v[100:101], v6 offset:33792
    s_and_b32 s87, s5, 3
    s_lshl_b32 s87, s87, 16
    s_add_u32 s87, s87, 589824
    v_mfma_f32_16x16x32_bf16 v[196:199], v[104:107], v[68:71], v[196:199]
    ds_read_b64_tr_b16 v[102:103], v6 offset:34304
    s_add_u32 s82, s82, s87
    v_mfma_f32_16x16x32_bf16 v[200:203], v[108:111], v[64:67], v[200:203]
    ds_read_b64_tr_b16 v[104:105], v6 offset:21504
    v_mfma_f32_16x16x32_bf16 v[204:207], v[108:111], v[68:71], v[204:207]
    ds_read_b64_tr_b16 v[106:107], v6 offset:22016
    s_waitcnt vmcnt(8) lgkmcnt(6)
    v_mfma_f32_16x16x32_bf16 v[192:195], v[88:91], v[56:59], v[192:195]
    ds_read_b64_tr_b16 v[108:109], v6 offset:29696
    v_mfma_f32_16x16x32_bf16 v[196:199], v[88:91], v[60:63], v[196:199]
    ds_read_b64_tr_b16 v[110:111], v6 offset:30208
    v_mfma_f32_16x16x32_bf16 v[200:203], v[92:95], v[56:59], v[200:203]
    v_subrev_u32 v7, 64512, v7
    ds_read_b64_tr_b16 v[88:89], v7 offset:4096
    v_mfma_f32_16x16x32_bf16 v[204:207], v[92:95], v[60:63], v[204:207]
    ds_read_b64_tr_b16 v[90:91], v7 offset:4608
    s_waitcnt vmcnt(6) lgkmcnt(6)
    v_mfma_f32_16x16x32_bf16 v[192:195], v[96:99], v[48:51], v[192:195]
    ds_read_b64_tr_b16 v[92:93], v7 offset:12288
    v_mfma_f32_16x16x32_bf16 v[196:199], v[96:99], v[52:55], v[196:199]
    ds_read_b64_tr_b16 v[94:95], v7 offset:12800
    v_mfma_f32_16x16x32_bf16 v[200:203], v[100:103], v[48:51], v[200:203]
    ds_read_b64_tr_b16 v[96:97], v7 offset:0
    v_mfma_f32_16x16x32_bf16 v[204:207], v[100:103], v[52:55], v[204:207]
    ds_read_b64_tr_b16 v[98:99], v7 offset:512
    s_waitcnt vmcnt(3) lgkmcnt(6)
    v_mfma_f32_16x16x32_bf16 v[192:195], v[104:107], v[40:43], v[192:195]
    ds_read_b64_tr_b16 v[100:101], v7 offset:8192
    v_mfma_f32_16x16x32_bf16 v[196:199], v[104:107], v[44:47], v[196:199]
    ds_read_b64_tr_b16 v[102:103], v7 offset:8704
    v_mfma_f32_16x16x32_bf16 v[200:203], v[108:111], v[40:43], v[200:203]
    ds_read_b64_tr_b16 v[104:105], v7 offset:25600
    v_mfma_f32_16x16x32_bf16 v[204:207], v[108:111], v[44:47], v[204:207]
    ds_read_b64_tr_b16 v[106:107], v7 offset:26112
    s_waitcnt lgkmcnt(6)
    v_mfma_f32_16x16x32_bf16 v[208:211], v[88:91], v[64:67], v[208:211]
    ds_read_b64_tr_b16 v[108:109], v7 offset:33792
    v_mfma_f32_16x16x32_bf16 v[212:215], v[88:91], v[68:71], v[212:215]
    ds_read_b64_tr_b16 v[110:111], v7 offset:34304
    v_mfma_f32_16x16x32_bf16 v[216:219], v[92:95], v[64:67], v[216:219]
    ds_read_b64_tr_b16 v[88:89], v7 offset:21504
    v_mul_f32 v192, 0xbfb8aa3b, v192
    v_mul_f32 v193, 0xbfb8aa3b, v193
    v_mul_f32 v194, 0xbfb8aa3b, v194
    v_mfma_f32_16x16x32_bf16 v[220:223], v[92:95], v[68:71], v[220:223]
    ds_read_b64_tr_b16 v[90:91], v7 offset:22016
    v_mul_f32 v195, 0xbfb8aa3b, v195
    v_mul_f32 v196, 0xbfb8aa3b, v196
    v_mul_f32 v197, 0xbfb8aa3b, v197
    s_waitcnt lgkmcnt(6)
    v_mfma_f32_16x16x32_bf16 v[208:211], v[96:99], v[56:59], v[208:211]
    ds_read_b64_tr_b16 v[92:93], v7 offset:29696
    v_mul_f32 v198, 0xbfb8aa3b, v198
    v_mul_f32 v199, 0xbfb8aa3b, v199
    v_exp_f32 v192, v192
    v_mfma_f32_16x16x32_bf16 v[212:215], v[96:99], v[60:63], v[212:215]
    ds_read_b64_tr_b16 v[94:95], v7 offset:30208
    v_exp_f32 v193, v193
    v_exp_f32 v194, v194
    v_exp_f32 v195, v195
    v_mfma_f32_16x16x32_bf16 v[216:219], v[100:103], v[56:59], v[216:219]
    v_subrev_u32 v8, 64512, v8
    ds_read_b64_tr_b16 v[96:97], v8 offset:4096
    v_exp_f32 v196, v196
    v_exp_f32 v197, v197
    v_exp_f32 v198, v198
    v_mfma_f32_16x16x32_bf16 v[220:223], v[100:103], v[60:63], v[220:223]
    ds_read_b64_tr_b16 v[98:99], v8 offset:4608
    v_exp_f32 v199, v199
    v_add_f32 v192, 1.0, v192
    v_add_f32 v193, 1.0, v193
    s_waitcnt lgkmcnt(6)
    v_mfma_f32_16x16x32_bf16 v[208:211], v[104:107], v[48:51], v[208:211]
    ds_read_b64_tr_b16 v[100:101], v8 offset:12288
    v_add_f32 v194, 1.0, v194
    v_add_f32 v195, 1.0, v195
    v_add_f32 v196, 1.0, v196
    v_mfma_f32_16x16x32_bf16 v[212:215], v[104:107], v[52:55], v[212:215]
    ds_read_b64_tr_b16 v[102:103], v8 offset:12800
    v_add_f32 v197, 1.0, v197
    v_add_f32 v198, 1.0, v198
    v_add_f32 v199, 1.0, v199
    v_mfma_f32_16x16x32_bf16 v[216:219], v[108:111], v[48:51], v[216:219]
    ds_read_b64_tr_b16 v[104:105], v8 offset:0
    v_rcp_f32 v192, v192
    v_rcp_f32 v193, v193
    v_rcp_f32 v194, v194
    v_mfma_f32_16x16x32_bf16 v[220:223], v[108:111], v[52:55], v[220:223]
    ds_read_b64_tr_b16 v[106:107], v8 offset:512
    v_rcp_f32 v195, v195
    v_rcp_f32 v196, v196
    v_rcp_f32 v197, v197
    s_waitcnt lgkmcnt(6)
    v_mfma_f32_16x16x32_bf16 v[208:211], v[88:91], v[40:43], v[208:211]
    ds_read_b64_tr_b16 v[108:109], v8 offset:8192
    v_rcp_f32 v198, v198
    v_rcp_f32 v199, v199
    v_mul_f32 v192, v192, v200
    v_mfma_f32_16x16x32_bf16 v[212:215], v[88:91], v[44:47], v[212:215]
    ds_read_b64_tr_b16 v[110:111], v8 offset:8704
    v_mul_f32 v193, v193, v201
    v_mul_f32 v194, v194, v202
    v_mul_f32 v195, v195, v203
    v_mfma_f32_16x16x32_bf16 v[216:219], v[92:95], v[40:43], v[216:219]
    ds_read_b64_tr_b16 v[88:89], v8 offset:25600
    v_mul_f32 v196, v196, v204
    v_mul_f32 v197, v197, v205
    v_mul_f32 v198, v198, v206
    v_mfma_f32_16x16x32_bf16 v[220:223], v[92:95], v[44:47], v[220:223]
    ds_read_b64_tr_b16 v[90:91], v8 offset:26112
    v_mul_f32 v199, v199, v207
    v_cvt_pk_bf16_f32 v200, v192, v193
    v_cvt_pk_bf16_f32 v201, v194, v195
    s_waitcnt lgkmcnt(6)
    v_mfma_f32_16x16x32_bf16 v[224:227], v[96:99], v[64:67], v[224:227]
    ds_read_b64_tr_b16 v[92:93], v8 offset:33792
    v_cvt_pk_bf16_f32 v202, v196, v197
    v_cvt_pk_bf16_f32 v203, v198, v199
    s_add_u32 s89, s82, 196608
    v_mfma_f32_16x16x32_bf16 v[228:231], v[96:99], v[68:71], v[228:231]
    ds_read_b64_tr_b16 v[94:95], v8 offset:34304
    v_permlane16_swap_b32 v200, v202
    v_permlane16_swap_b32 v201, v203
    buffer_store_dwordx4 v[200:203], v12, s[32:35], s89 offen sc1
    v_mfma_f32_16x16x32_bf16 v[232:235], v[100:103], v[64:67], v[232:235]
    ds_read_b64_tr_b16 v[96:97], v8 offset:21504
    v_mul_f32 v208, 0xbfb8aa3b, v208
    v_mul_f32 v209, 0xbfb8aa3b, v209
    v_mul_f32 v210, 0xbfb8aa3b, v210
    v_mfma_f32_16x16x32_bf16 v[236:239], v[100:103], v[68:71], v[236:239]
    ds_read_b64_tr_b16 v[98:99], v8 offset:22016
    v_mul_f32 v211, 0xbfb8aa3b, v211
    v_mul_f32 v212, 0xbfb8aa3b, v212
    v_mul_f32 v213, 0xbfb8aa3b, v213
    s_waitcnt lgkmcnt(6)
    v_mfma_f32_16x16x32_bf16 v[224:227], v[104:107], v[56:59], v[224:227]
    ds_read_b64_tr_b16 v[100:101], v8 offset:29696
    v_mul_f32 v214, 0xbfb8aa3b, v214
    v_mul_f32 v215, 0xbfb8aa3b, v215
    v_exp_f32 v208, v208
    v_mfma_f32_16x16x32_bf16 v[228:231], v[104:107], v[60:63], v[228:231]
    ds_read_b64_tr_b16 v[102:103], v8 offset:30208
    v_exp_f32 v209, v209
    v_exp_f32 v210, v210
    v_exp_f32 v211, v211
    v_mfma_f32_16x16x32_bf16 v[232:235], v[108:111], v[56:59], v[232:235]
    v_subrev_u32 v9, 64512, v9
    ds_read_b64_tr_b16 v[104:105], v9 offset:4096
    v_exp_f32 v212, v212
    v_exp_f32 v213, v213
    v_exp_f32 v214, v214
    v_mfma_f32_16x16x32_bf16 v[236:239], v[108:111], v[60:63], v[236:239]
    ds_read_b64_tr_b16 v[106:107], v9 offset:4608
    v_exp_f32 v215, v215
    v_add_f32 v208, 1.0, v208
    v_add_f32 v209, 1.0, v209
    s_waitcnt lgkmcnt(6)
    v_mfma_f32_16x16x32_bf16 v[224:227], v[88:91], v[48:51], v[224:227]
    ds_read_b64_tr_b16 v[108:109], v9 offset:12288
    v_add_f32 v210, 1.0, v210
    v_add_f32 v211, 1.0, v211
    v_add_f32 v212, 1.0, v212
    v_mfma_f32_16x16x32_bf16 v[228:231], v[88:91], v[52:55], v[228:231]
    ds_read_b64_tr_b16 v[110:111], v9 offset:12800
    v_add_f32 v213, 1.0, v213
    v_add_f32 v214, 1.0, v214
    v_add_f32 v215, 1.0, v215
    v_mfma_f32_16x16x32_bf16 v[232:235], v[92:95], v[48:51], v[232:235]
    ds_read_b64_tr_b16 v[88:89], v9 offset:0
    v_rcp_f32 v208, v208
    v_rcp_f32 v209, v209
    v_rcp_f32 v210, v210
    v_mfma_f32_16x16x32_bf16 v[236:239], v[92:95], v[52:55], v[236:239]
    ds_read_b64_tr_b16 v[90:91], v9 offset:512
    v_rcp_f32 v211, v211
    v_rcp_f32 v212, v212
    v_rcp_f32 v213, v213
    s_waitcnt lgkmcnt(6)
    v_mfma_f32_16x16x32_bf16 v[224:227], v[96:99], v[40:43], v[224:227]
    ds_read_b64_tr_b16 v[92:93], v9 offset:8192
    v_rcp_f32 v214, v214
    v_rcp_f32 v215, v215
    v_mul_f32 v208, v208, v216
    v_mfma_f32_16x16x32_bf16 v[228:231], v[96:99], v[44:47], v[228:231]
    ds_read_b64_tr_b16 v[94:95], v9 offset:8704
    v_mul_f32 v209, v209, v217
    v_mul_f32 v210, v210, v218
    v_mul_f32 v211, v211, v219
    v_mfma_f32_16x16x32_bf16 v[232:235], v[100:103], v[40:43], v[232:235]
    ds_read_b64_tr_b16 v[96:97], v9 offset:25600
    v_mul_f32 v212, v212, v220
    v_mul_f32 v213, v213, v221
    v_mul_f32 v214, v214, v222
    v_mfma_f32_16x16x32_bf16 v[236:239], v[100:103], v[44:47], v[236:239]
    ds_read_b64_tr_b16 v[98:99], v9 offset:26112
    v_mul_f32 v215, v215, v223
    v_cvt_pk_bf16_f32 v216, v208, v209
    v_cvt_pk_bf16_f32 v217, v210, v211
    s_waitcnt lgkmcnt(6)
    v_mfma_f32_16x16x32_bf16 v[240:243], v[104:107], v[64:67], v[240:243]
    ds_read_b64_tr_b16 v[100:101], v9 offset:33792
    v_cvt_pk_bf16_f32 v218, v212, v213
    v_cvt_pk_bf16_f32 v219, v214, v215
    s_add_u32 s89, s82, 262144
    v_mfma_f32_16x16x32_bf16 v[244:247], v[104:107], v[68:71], v[244:247]
    ds_read_b64_tr_b16 v[102:103], v9 offset:34304
    v_permlane16_swap_b32 v216, v218
    v_permlane16_swap_b32 v217, v219
    buffer_store_dwordx4 v[216:219], v12, s[32:35], s89 offen sc1
    v_mfma_f32_16x16x32_bf16 v[248:251], v[108:111], v[64:67], v[248:251]
    ds_read_b64_tr_b16 v[104:105], v9 offset:21504
    v_mul_f32 v224, 0xbfb8aa3b, v224
    v_mul_f32 v225, 0xbfb8aa3b, v225
    v_mul_f32 v226, 0xbfb8aa3b, v226
    v_mfma_f32_16x16x32_bf16 v[252:255], v[108:111], v[68:71], v[252:255]
    ds_read_b64_tr_b16 v[106:107], v9 offset:22016
    v_mul_f32 v227, 0xbfb8aa3b, v227
    v_mul_f32 v228, 0xbfb8aa3b, v228
    v_mul_f32 v229, 0xbfb8aa3b, v229
    s_waitcnt lgkmcnt(6)
    v_mfma_f32_16x16x32_bf16 v[240:243], v[88:91], v[56:59], v[240:243]
    ds_read_b64_tr_b16 v[108:109], v9 offset:29696
    v_mul_f32 v230, 0xbfb8aa3b, v230
    v_mul_f32 v231, 0xbfb8aa3b, v231
    v_exp_f32 v224, v224
    v_mfma_f32_16x16x32_bf16 v[244:247], v[88:91], v[60:63], v[244:247]
    ds_read_b64_tr_b16 v[110:111], v9 offset:30208
    v_exp_f32 v225, v225
    v_exp_f32 v226, v226
    v_exp_f32 v227, v227
    v_mfma_f32_16x16x32_bf16 v[248:251], v[92:95], v[56:59], v[248:251]
    v_exp_f32 v228, v228
    v_exp_f32 v229, v229
    v_exp_f32 v230, v230
    v_mfma_f32_16x16x32_bf16 v[252:255], v[92:95], v[60:63], v[252:255]
    v_exp_f32 v231, v231
    v_add_f32 v224, 1.0, v224
    v_add_f32 v225, 1.0, v225
    s_waitcnt lgkmcnt(4)
    v_mfma_f32_16x16x32_bf16 v[240:243], v[96:99], v[48:51], v[240:243]
    v_add_f32 v226, 1.0, v226
    v_add_f32 v227, 1.0, v227
    v_add_f32 v228, 1.0, v228
    v_mfma_f32_16x16x32_bf16 v[244:247], v[96:99], v[52:55], v[244:247]
    v_add_f32 v229, 1.0, v229
    v_add_f32 v230, 1.0, v230
    v_add_f32 v231, 1.0, v231
    v_mfma_f32_16x16x32_bf16 v[248:251], v[100:103], v[48:51], v[248:251]
    v_rcp_f32 v224, v224
    v_rcp_f32 v225, v225
    v_rcp_f32 v226, v226
    v_mfma_f32_16x16x32_bf16 v[252:255], v[100:103], v[52:55], v[252:255]
    v_rcp_f32 v227, v227
    v_rcp_f32 v228, v228
    v_rcp_f32 v229, v229
    s_waitcnt lgkmcnt(0)
    v_mfma_f32_16x16x32_bf16 v[240:243], v[104:107], v[40:43], v[240:243]
    v_rcp_f32 v230, v230
    v_rcp_f32 v231, v231
    v_mul_f32 v224, v224, v232
    v_mfma_f32_16x16x32_bf16 v[244:247], v[104:107], v[44:47], v[244:247]
    v_mul_f32 v225, v225, v233
    v_mul_f32 v226, v226, v234
    v_mul_f32 v227, v227, v235
    v_mfma_f32_16x16x32_bf16 v[248:251], v[108:111], v[40:43], v[248:251]
    v_mul_f32 v228, v228, v236
    v_mul_f32 v229, v229, v237
    v_mul_f32 v230, v230, v238
    v_mfma_f32_16x16x32_bf16 v[252:255], v[108:111], v[44:47], v[252:255]
    v_mul_f32 v231, v231, v239
    v_cvt_pk_bf16_f32 v232, v224, v225
    v_cvt_pk_bf16_f32 v233, v226, v227
    s_nop 7
    v_cvt_pk_bf16_f32 v234, v228, v229
    v_cvt_pk_bf16_f32 v235, v230, v231
    s_add_u32 s89, s82, 327680
    v_permlane16_swap_b32 v232, v234
    v_permlane16_swap_b32 v233, v235
    buffer_store_dwordx4 v[232:235], v12, s[32:35], s89 offen sc1
    v_mul_f32 v240, 0xbfb8aa3b, v240
    v_mul_f32 v241, 0xbfb8aa3b, v241
    v_mul_f32 v242, 0xbfb8aa3b, v242
    v_mul_f32 v243, 0xbfb8aa3b, v243
    v_mul_f32 v244, 0xbfb8aa3b, v244
    v_mul_f32 v245, 0xbfb8aa3b, v245
    v_mul_f32 v246, 0xbfb8aa3b, v246
    v_mul_f32 v247, 0xbfb8aa3b, v247
    v_exp_f32 v240, v240
    v_exp_f32 v241, v241
    v_exp_f32 v242, v242
    v_exp_f32 v243, v243
    v_exp_f32 v244, v244
    v_exp_f32 v245, v245
    v_exp_f32 v246, v246
    v_exp_f32 v247, v247
    v_add_f32 v240, 1.0, v240
    v_add_f32 v241, 1.0, v241
    v_add_f32 v242, 1.0, v242
    v_add_f32 v243, 1.0, v243
    v_add_f32 v244, 1.0, v244
    v_add_f32 v245, 1.0, v245
    v_add_f32 v246, 1.0, v246
    v_add_f32 v247, 1.0, v247
    v_rcp_f32 v240, v240
    v_rcp_f32 v241, v241
    v_rcp_f32 v242, v242
    v_rcp_f32 v243, v243
    v_rcp_f32 v244, v244
    v_rcp_f32 v245, v245
    v_rcp_f32 v246, v246
    v_rcp_f32 v247, v247
    v_mul_f32 v240, v240, v248
    v_mul_f32 v241, v241, v249
    v_mul_f32 v242, v242, v250
    v_mul_f32 v243, v243, v251
    v_mul_f32 v244, v244, v252
    v_mul_f32 v245, v245, v253
    v_mul_f32 v246, v246, v254
    v_mul_f32 v247, v247, v255
    v_cvt_pk_bf16_f32 v248, v240, v241
    v_cvt_pk_bf16_f32 v249, v242, v243
    v_cvt_pk_bf16_f32 v250, v244, v245
    v_cvt_pk_bf16_f32 v251, v246, v247
    s_add_u32 s89, s82, 393216
    v_permlane16_swap_b32 v248, v250
    v_permlane16_swap_b32 v249, v251
    buffer_store_dwordx4 v[248:251], v12, s[32:35], s89 offen sc1
    s_endpgm
K2_SLOW:
    s_mov_b32 s88, 0
K2_SLOWL:
    buffer_load_dwordx4 v[160:163], v13, s[36:39], s84 offen offset:0 sc1
    buffer_load_dwordx4 v[164:167], v13, s[36:39], s84 offen offset:256 sc1
    buffer_load_dwordx4 v[168:171], v13, s[36:39], s84 offen offset:512 sc1
    buffer_load_dwordx4 v[172:175], v13, s[36:39], s84 offen offset:768 sc1
    buffer_load_dwordx4 v[144:147], v13, s[36:39], s84 offen offset:1024 sc1
    buffer_load_dwordx4 v[148:151], v13, s[36:39], s84 offen offset:1280 sc1
    buffer_load_dwordx4 v[152:155], v13, s[36:39], s84 offen offset:1536 sc1
    s_waitcnt vmcnt(0)
    v_max3_u32 v11, v160, v161, v162
    v_max3_u32 v11, v11, v163, v164
    v_max3_u32 v11, v11, v165, v166
    v_max3_u32 v11, v11, v167, v168
    v_max3_u32 v11, v11, v169, v170
    v_max3_u32 v11, v11, v171, v172
    v_max3_u32 v11, v11, v173, v174
    v_max3_u32 v11, v11, v175, v144
    v_max3_u32 v11, v11, v145, v146
    v_max3_u32 v11, v11, v147, v148
    v_max3_u32 v11, v11, v149, v150
    v_max3_u32 v11, v11, v151, v152
    v_max3_u32 v11, v11, v153, v154
    v_max_u32 v11, v11, v155
    v_cmp_eq_u32 vcc, -1, v11
    s_add_u32 s88, s88, 1
    s_nop 3
    s_cmp_eq_u64 vcc, 0
    s_cbranch_scc1 K2_BACK
    s_cmp_lt_u32 s88, 100000
    s_cbranch_scc1 K2_SLOWL
    s_branch K2_BACK
K2_END:
    s_endpgm
.globl ssm_gemm2_kernel
.p2align 8
.type ssm_gemm2_kernel,@function
ssm_gemm2_kernel:
    s_cmp_ge_u32 s2, 256
    s_cbranch_scc1 K3_END
    s_load_dwordx2 s[48:49], s[0:1], 96
    s_load_dwordx4 s[52:55], s[0:1], 40
    s_load_dwordx2 s[56:57], s[0:1], 120
    s_load_dwordx2 s[58:59], s[0:1], 0
    s_load_dwordx2 s[60:61], s[0:1], 64
    s_load_dwordx2 s[62:63], s[0:1], 104
    v_lshrrev_b32 v16, 6, v0
    v_and_b32 v0, 63, v0
    v_readfirstlane_b32 s3, v16
    s_and_b32 s7, s2, 7
    s_lshr_b32 s77, s2, 3
    s_and_b32 s6, s7, 1
    s_lshr_b32 s78, s7, 1
    s_and_b32 s78, s78, 1
    s_lshr_b32 s79, s7, 2
    s_and_b32 s4, s77, 7
    s_lshl_b32 s79, s79, 3
    s_add_u32 s4, s4, s79
    s_lshr_b32 s5, s77, 3
    s_lshl_b32 s78, s78, 2
    s_add_u32 s5, s5, s78
    s_lshl_b32 s64, s4, 7
    s_lshl_b32 s65, s5, 7
    s_mov_b32 s80, 32768
    s_mov_b32 s81, -131072
    s_mov_b32 s75, 0xfffffffe
    v_and_b32 v17, 15, v0
    v_lshrrev_b32 v18, 4, v0
    s_cmp_lt_u32 s3, 4
    s_cbranch_scc0 K3_PROD
    v_lshlrev_b32 v19, 4, v17
    v_lshl_add_u32 v1, v18, 15, v19
    s_lshl_b32 s77, s3, 5
    s_add_u32 s77, s77, s64
    s_mul_i32 s66, s6, 11534336
    s_lshl_b32 s7, s77, 4
    s_add_u32 s66, s66, s7
    s_waitcnt lgkmcnt(0)
    s_add_u32 s20, s56, 0x400000
    s_addc_u32 s21, s57, 0
    s_mov_b32 s22, 0x1600000
    s_mov_b32 s23, 0x00020000
    buffer_load_dwordx4 v[48:51], v1, s[20:23], s66 offen
    buffer_load_dwordx4 v[52:55], v1, s[20:23], s66 offen offset:256
    s_add_u32 s66, s66, 131072
    buffer_load_dwordx4 v[56:59], v1, s[20:23], s66 offen
    buffer_load_dwordx4 v[60:63], v1, s[20:23], s66 offen offset:256
    s_add_u32 s66, s66, 131072
    buffer_load_dwordx4 v[64:67], v1, s[20:23], s66 offen
    buffer_load_dwordx4 v[68:71], v1, s[20:23], s66 offen offset:256
    s_add_u32 s66, s66, 131072
    buffer_load_dwordx4 v[72:75], v1, s[20:23], s66 offen
    buffer_load_dwordx4 v[76:79], v1, s[20:23], s66 offen offset:256
    s_add_u32 s66, s66, 131072
    buffer_load_dwordx4 v[80:83], v1, s[20:23], s66 offen
    buffer_load_dwordx4 v[84:87], v1, s[20:23], s66 offen offset:256
    s_add_u32 s66, s66, 131072
    buffer_load_dwordx4 v[88:91], v1, s[20:23], s66 offen
    buffer_load_dwordx4 v[92:95], v1, s[20:23], s66 offen offset:256
    s_add_u32 s66, s66, 131072
    buffer_load_dwordx4 v[96:99], v1, s[20:23], s66 offen
    buffer_load_dwordx4 v[100:103], v1, s[20:23], s66 offen offset:256
    s_add_u32 s66, s66, 131072
    v_lshlrev_b32 v20, 11, v17
    v_lshl_add_u32 v216, v18, 3, v20
    v_lshrrev_b32 v21, 2, v17
    v_and_b32 v21, 1, v21
    v_lshlrev_b32 v21, 2, v21
    v_lshrrev_b32 v22, 3, v17
    v_add_u32 v21, v21, v22
    v_and_b32 v22, 3, v17
    v_lshl_add_u32 v21, v21, 2, v22
    v_lshlrev_b32 v21, 4, v21
    v_lshrrev_b32 v22, 1, v18
    v_lshl_add_u32 v21, v22, 15, v21
    v_and_b32 v22, 1, v18
    v_lshl_add_u32 v217, v22, 3, v21
    v_lshlrev_b32 v218, 3, v18
    s_lshl_b32 s78, s6, 6
    s_add_u32 s78, s78, s65
    s_lshl_b32 s79, s77, 11
    s_lshl_b32 s7, s78, 1
    s_add_u32 s79, s79, s7
    s_add_u32 s74, s79, 32768
    s_lshl_b32 s82, s78, 12
    s_lshl_b32 s7, s77, 4
    s_add_u32 s82, s82, s7
    s_lshl_b32 s83, s78, 1
    s_lshl_b32 s76, s77, 12
    s_lshl_b32 s7, s78, 2
    s_add_u32 s76, s76, s7
    s_mov_b32 s24, s58
    s_mov_b32 s25, s59
    s_mov_b32 s26, 0x400000
    s_mov_b32 s27, 0x00020000
    s_mov_b32 s28, s56
    s_mov_b32 s29, s57
    s_mov_b32 s30, 0x400000
    s_mov_b32 s31, 0x00020000
    s_mov_b32 s32, s60
    s_mov_b32 s33, s61
    s_mov_b32 s34, 0x800
    s_mov_b32 s35, 0x00020000
    s_add_u32 s36, s56, 0x1b00000
    s_addc_u32 s37, s57, 0
    s_mov_b32 s38, 0xc00000
    s_mov_b32 s39, 0x00020000
    s_mov_b32 s44, s62
    s_mov_b32 s45, s63
    s_mov_b32 s46, 0x800000
    s_mov_b32 s47, 0x00020000
    v_lshrrev_b32 v23, 2, v0
    v_and_b32 v23, 3, v23
    v_and_b32 v24, 3, v0
    v_lshl_add_u32 v25, v18, 3, v23
    v_lshlrev_b32 v25, 8, v25
    v_lshl_add_u32 v25, v24, 3, v25
    v_and_b32 v26, 1, v18
    v_lshl_add_u32 v26, v26, 2, v23
    s_lshl_b32 s7, s6, 2
    v_xor_b32 v26, s7, v26
    v_xor_b32 v27, 0, v26
    v_lshl_add_u32 v2, v27, 5, v25
    v_xor_b32 v27, 1, v26
    v_lshl_add_u32 v3, v27, 5, v25
    v_xor_b32 v27, 2, v26
    v_lshl_add_u32 v4, v27, 5, v25
    v_xor_b32 v27, 3, v26
    v_lshl_add_u32 v5, v27, 5, v25
    v_xor_b32 v27, 4, v26
    v_lshl_add_u32 v6, v27, 5, v25
    v_xor_b32 v27, 5, v26
    v_lshl_add_u32 v7, v27, 5, v25
    v_xor_b32 v27, 6, v26
    v_lshl_add_u32 v8, v27, 5, v25
    v_xor_b32 v27, 7, v26
    v_lshl_add_u32 v9, v27, 5, v25
    v_xor_b32 v27, v18, v17
    v_lshlrev_b32 v28, 8, v17
    v_xor_b32 v29, 0, v27
    v_lshl_add_u32 v10, v29, 4, v28
    v_xor_b32 v29, 4, v27
    v_lshl_add_u32 v11, v29, 4, v28
    v_xor_b32 v29, 8, v27
    v_lshl_add_u32 v12, v29, 4, v28
    v_xor_b32 v29, 12, v27
    v_lshl_add_u32 v13, v29, 4, v28
    v_lshlrev_b32 v14, 12, v17
    v_lshl_add_u32 v14, v18, 4, v14
    v_lshlrev_b32 v15, 4, v0
    s_lshl_b32 s7, s2, 2
    s_add_u32 s7, s7, s3
    s_lshl_b32 s72, s7, 12
    s_xor_b32 s73, s72, 16384
    s_mov_b32 s40, 0x00003f80
    s_mov_b32 s41, 0x3f800000
    s_mov_b32 s67, 0
    v_and_b32 v27, 7, v17
    v_lshlrev_b32 v27, 12, v27
    v_lshrrev_b32 v28, 3, v17
    v_lshl_add_u32 v27, v28, 6, v27
    v_lshl_add_u32 v14, v18, 4, v27
    v_and_b32 v27, 7, v17
    s_lshl_b32 s7, s3, 5
    v_add_u32 v27, s7, v27
    v_mul_u32_u24 v27, 272, v27
    v_lshl_add_u32 v27, v28, 6, v27
    v_lshl_add_u32 v27, v18, 4, v27
    v_add_u32 v216, 98304, v27
    v_mov_b32 v112, 0
    v_mov_b32 v113, 0
    v_mov_b32 v114, 0
    v_mov_b32 v115, 0
    v_mov_b32 v116, 0
    v_mov_b32 v117, 0
    v_mov_b32 v118, 0
    v_mov_b32 v119, 0
    v_mov_b32 v120, 0
    v_mov_b32 v121, 0
    v_mov_b32 v122, 0
    v_mov_b32 v123, 0
    v_mov_b32 v124, 0
    v_mov_b32 v125, 0
    v_mov_b32 v126, 0
    v_mov_b32 v127, 0
    v_mov_b32 v128, 0
    v_mov_b32 v129, 0
    v_mov_b32 v130, 0
    v_mov_b32 v131, 0
    v_mov_b32 v132, 0
    v_mov_b32 v133, 0
    v_mov_b32 v134, 0
    v_mov_b32 v135, 0
    v_mov_b32 v136, 0
    v_mov_b32 v137, 0
    v_mov_b32 v138, 0
    v_mov_b32 v139, 0
    v_mov_b32 v140, 0
    v_mov_b32 v141, 0
    v_mov_b32 v142, 0
    v_mov_b32 v143, 0
    v_mov_b32 v144, 0
    v_mov_b32 v145, 0
    v_mov_b32 v146, 0
    v_mov_b32 v147, 0
    v_mov_b32 v148, 0
    v_mov_b32 v149, 0
    v_mov_b32 v150, 0
    v_mov_b32 v151, 0
    v_mov_b32 v152, 0
    v_mov_b32 v153, 0
    v_mov_b32 v154, 0
    v_mov_b32 v155, 0
    v_mov_b32 v156, 0
    v_mov_b32 v157, 0
    v_mov_b32 v158, 0
    v_mov_b32 v159, 0
    v_mov_b32 v160, 0
    v_mov_b32 v161, 0
    v_mov_b32 v162, 0
    v_mov_b32 v163, 0
    v_mov_b32 v164, 0
    v_mov_b32 v165, 0
    v_mov_b32 v166, 0
    v_mov_b32 v167, 0
    v_mov_b32 v168, 0
    v_mov_b32 v169, 0
    v_mov_b32 v170, 0
    v_mov_b32 v171, 0
    v_mov_b32 v172, 0
    v_mov_b32 v173, 0
    v_mov_b32 v174, 0
    v_mov_b32 v175, 0
    s_barrier
    ds_read_b64_tr_b16 v[16:17], v2 offset:0
    ds_read_b64_tr_b16 v[18:19], v2 offset:1024
    ds_read_b64_tr_b16 v[20:21], v3 offset:0
    ds_read_b64_tr_b16 v[22:23], v3 offset:1024
    ds_read_b64_tr_b16 v[24:25], v4 offset:0
    ds_read_b64_tr_b16 v[26:27], v4 offset:1024
    ds_read_b64_tr_b16 v[28:29], v5 offset:0
    ds_read_b64_tr_b16 v[30:31], v5 offset:1024
    ds_read_b64_tr_b16 v[32:33], v6 offset:0
    ds_read_b64_tr_b16 v[34:35], v6 offset:1024
    ds_read_b64_tr_b16 v[36:37], v7 offset:0
    ds_read_b64_tr_b16 v[38:39], v7 offset:1024
    ds_read_b64_tr_b16 v[40:41], v8 offset:0
    ds_read_b64_tr_b16 v[42:43], v8 offset:1024
    s_cmp_eq_u32 s6, 0
    s_cbranch_scc0 K3_H1
    s_mov_b32 s69, 10
K3_CL_1:
    s_waitcnt vmcnt(12) lgkmcnt(10)
    v_mfma_f32_16x16x32_bf16 v[112:115], v[16:19], v[48:51], v[112:115]
    ds_read_b64_tr_b16 v[44:45], v9 offset:0
    s_cmp_eq_u32 s67, 131072
    v_mfma_f32_16x16x32_bf16 v[116:119], v[16:19], v[52:55], v[116:119]
    ds_read_b64_tr_b16 v[46:47], v9 offset:1024
    s_cselect_b32 s68, s81, s80
    v_mfma_f32_16x16x32_bf16 v[120:123], v[20:23], v[48:51], v[120:123]
    ds_read_b64_tr_b16 v[16:17], v2 offset:8192
    buffer_load_dwordx4 v[104:107], v1, s[20:23], s66 offen
    v_mfma_f32_16x16x32_bf16 v[124:127], v[20:23], v[52:55], v[124:127]
    ds_read_b64_tr_b16 v[18:19], v2 offset:9216
    s_waitcnt lgkmcnt(10)
    v_mfma_f32_16x16x32_bf16 v[128:131], v[24:27], v[48:51], v[128:131]
    ds_read_b64_tr_b16 v[20:21], v3 offset:8192
    buffer_load_dwordx4 v[108:111], v1, s[20:23], s66 offen offset:256
    v_mfma_f32_16x16x32_bf16 v[132:135], v[24:27], v[52:55], v[132:135]
    ds_read_b64_tr_b16 v[22:23], v3 offset:9216
    s_add_u32 s66, s66, 131072
    v_mfma_f32_16x16x32_bf16 v[136:139], v[28:31], v[48:51], v[136:139]
    ds_read_b64_tr_b16 v[24:25], v4 offset:8192
    v_mfma_f32_16x16x32_bf16 v[140:143], v[28:31], v[52:55], v[140:143]
    ds_read_b64_tr_b16 v[26:27], v4 offset:9216
    s_waitcnt lgkmcnt(10)
    v_mfma_f32_16x16x32_bf16 v[144:147], v[32:35], v[48:51], v[144:147]
    ds_read_b64_tr_b16 v[28:29], v5 offset:8192
    v_mfma_f32_16x16x32_bf16 v[148:151], v[32:35], v[52:55], v[148:151]
    ds_read_b64_tr_b16 v[30:31], v5 offset:9216
    v_mfma_f32_16x16x32_bf16 v[152:155], v[36:39], v[48:51], v[152:155]
    ds_read_b64_tr_b16 v[32:33], v6 offset:8192
    v_mfma_f32_16x16x32_bf16 v[156:159], v[36:39], v[52:55], v[156:159]
    ds_read_b64_tr_b16 v[34:35], v6 offset:9216
    s_waitcnt lgkmcnt(10)
    v_mfma_f32_16x16x32_bf16 v[160:163], v[40:43], v[48:51], v[160:163]
    ds_read_b64_tr_b16 v[36:37], v7 offset:8192
    v_mfma_f32_16x16x32_bf16 v[164:167], v[40:43], v[52:55], v[164:167]
    ds_read_b64_tr_b16 v[38:39], v7 offset:9216
    v_mfma_f32_16x16x32_bf16 v[168:171], v[44:47], v[48:51], v[168:171]
    ds_read_b64_tr_b16 v[40:41], v8 offset:8192
    v_mfma_f32_16x16x32_bf16 v[172:175], v[44:47], v[52:55], v[172:175]
    ds_read_b64_tr_b16 v[42:43], v8 offset:9216
    s_waitcnt vmcnt(12) lgkmcnt(10)
    v_mfma_f32_16x16x32_bf16 v[112:115], v[16:19], v[56:59], v[112:115]
    ds_read_b64_tr_b16 v[44:45], v9 offset:8192
    v_mfma_f32_16x16x32_bf16 v[116:119], v[16:19], v[60:63], v[116:119]
    ds_read_b64_tr_b16 v[46:47], v9 offset:9216
    v_mfma_f32_16x16x32_bf16 v[120:123], v[20:23], v[56:59], v[120:123]
    ds_read_b64_tr_b16 v[16:17], v2 offset:16384
    buffer_load_dwordx4 v[48:51], v1, s[20:23], s66 offen
    v_mfma_f32_16x16x32_bf16 v[124:127], v[20:23], v[60:63], v[124:127]
    ds_read_b64_tr_b16 v[18:19], v2 offset:17408
    s_waitcnt lgkmcnt(10)
    v_mfma_f32_16x16x32_bf16 v[128:131], v[24:27], v[56:59], v[128:131]
    ds_read_b64_tr_b16 v[20:21], v3 offset:16384
    buffer_load_dwordx4 v[52:55], v1, s[20:23], s66 offen offset:256
    v_mfma_f32_16x16x32_bf16 v[132:135], v[24:27], v[60:63], v[132:135]
    ds_read_b64_tr_b16 v[22:23], v3 offset:17408
    s_add_u32 s66, s66, 131072
    v_mfma_f32_16x16x32_bf16 v[136:139], v[28:31], v[56:59], v[136:139]
    ds_read_b64_tr_b16 v[24:25], v4 offset:16384
    v_mfma_f32_16x16x32_bf16 v[140:143], v[28:31], v[60:63], v[140:143]
    ds_read_b64_tr_b16 v[26:27], v4 offset:17408
    s_waitcnt lgkmcnt(10)
    v_mfma_f32_16x16x32_bf16 v[144:147], v[32:35], v[56:59], v[144:147]
    ds_read_b64_tr_b16 v[28:29], v5 offset:16384
    s_add_u32 s67, s67, s68
    v_mfma_f32_16x16x32_bf16 v[148:151], v[32:35], v[60:63], v[148:151]
    ds_read_b64_tr_b16 v[30:31], v5 offset:17408
    v_mfma_f32_16x16x32_bf16 v[152:155], v[36:39], v[56:59], v[152:155]
    ds_read_b64_tr_b16 v[32:33], v6 offset:16384
    v_mfma_f32_16x16x32_bf16 v[156:159], v[36:39], v[60:63], v[156:159]
    ds_read_b64_tr_b16 v[34:35], v6 offset:17408
    s_waitcnt lgkmcnt(10)
    v_mfma_f32_16x16x32_bf16 v[160:163], v[40:43], v[56:59], v[160:163]
    ds_read_b64_tr_b16 v[36:37], v7 offset:16384
    v_mfma_f32_16x16x32_bf16 v[164:167], v[40:43], v[60:63], v[164:167]
    ds_read_b64_tr_b16 v[38:39], v7 offset:17408
    v_mfma_f32_16x16x32_bf16 v[168:171], v[44:47], v[56:59], v[168:171]
    ds_read_b64_tr_b16 v[40:41], v8 offset:16384
    v_mfma_f32_16x16x32_bf16 v[172:175], v[44:47], v[60:63], v[172:175]
    ds_read_b64_tr_b16 v[42:43], v8 offset:17408
    s_waitcnt vmcnt(12) lgkmcnt(10)
    v_mfma_f32_16x16x32_bf16 v[112:115], v[16:19], v[64:67], v[112:115]
    ds_read_b64_tr_b16 v[44:45], v9 offset:16384
    v_mfma_f32_16x16x32_bf16 v[116:119], v[16:19], v[68:71], v[116:119]
    ds_read_b64_tr_b16 v[46:47], v9 offset:17408
    v_mfma_f32_16x16x32_bf16 v[120:123], v[20:23], v[64:67], v[120:123]
    ds_read_b64_tr_b16 v[16:17], v2 offset:24576
    buffer_load_dwordx4 v[56:59], v1, s[20:23], s66 offen
    v_mfma_f32_16x16x32_bf16 v[124:127], v[20:23], v[68:71], v[124:127]
    ds_read_b64_tr_b16 v[18:19], v2 offset:25600
    s_waitcnt lgkmcnt(10)
    v_mfma_f32_16x16x32_bf16 v[128:131], v[24:27], v[64:67], v[128:131]
    ds_read_b64_tr_b16 v[20:21], v3 offset:24576
    buffer_load_dwordx4 v[60:63], v1, s[20:23], s66 offen offset:256
    v_mfma_f32_16x16x32_bf16 v[132:135], v[24:27], v[68:71], v[132:135]
    ds_read_b64_tr_b16 v[22:23], v3 offset:25600
    s_add_u32 s66, s66, 131072
    v_mfma_f32_16x16x32_bf16 v[136:139], v[28:31], v[64:67], v[136:139]
    ds_read_b64_tr_b16 v[24:25], v4 offset:24576
    v_add_u32 v2, s68, v2
    v_mfma_f32_16x16x32_bf16 v[140:143], v[28:31], v[68:71], v[140:143]
    ds_read_b64_tr_b16 v[26:27], v4 offset:25600
    s_waitcnt lgkmcnt(10)
    v_mfma_f32_16x16x32_bf16 v[144:147], v[32:35], v[64:67], v[144:147]
    ds_read_b64_tr_b16 v[28:29], v5 offset:24576
    v_add_u32 v3, s68, v3
    v_mfma_f32_16x16x32_bf16 v[148:151], v[32:35], v[68:71], v[148:151]
    ds_read_b64_tr_b16 v[30:31], v5 offset:25600
    v_add_u32 v4, s68, v4
    v_mfma_f32_16x16x32_bf16 v[152:155], v[36:39], v[64:67], v[152:155]
    ds_read_b64_tr_b16 v[32:33], v6 offset:24576
    v_add_u32 v5, s68, v5
    v_mfma_f32_16x16x32_bf16 v[156:159], v[36:39], v[68:71], v[156:159]
    ds_read_b64_tr_b16 v[34:35], v6 offset:25600
    s_waitcnt lgkmcnt(10)
    v_mfma_f32_16x16x32_bf16 v[160:163], v[40:43], v[64:67], v[160:163]
    ds_read_b64_tr_b16 v[36:37], v7 offset:24576
    v_add_u32 v6, s68, v6
    v_mfma_f32_16x16x32_bf16 v[164:167], v[40:43], v[68:71], v[164:167]
    ds_read_b64_tr_b16 v[38:39], v7 offset:25600
    v_mfma_f32_16x16x32_bf16 v[168:171], v[44:47], v[64:67], v[168:171]
    ds_read_b64_tr_b16 v[40:41], v8 offset:24576
    v_add_u32 v7, s68, v7
    v_mfma_f32_16x16x32_bf16 v[172:175], v[44:47], v[68:71], v[172:175]
    ds_read_b64_tr_b16 v[42:43], v8 offset:25600
    s_waitcnt vmcnt(12) lgkmcnt(10)
    v_mfma_f32_16x16x32_bf16 v[112:115], v[16:19], v[72:75], v[112:115]
    ds_read_b64_tr_b16 v[44:45], v9 offset:24576
    v_mfma_f32_16x16x32_bf16 v[116:119], v[16:19], v[76:79], v[116:119]
    ds_read_b64_tr_b16 v[46:47], v9 offset:25600
    s_barrier
    v_mfma_f32_16x16x32_bf16 v[120:123], v[20:23], v[72:75], v[120:123]
    ds_read_b64_tr_b16 v[16:17], v2 offset:0
    buffer_load_dwordx4 v[64:67], v1, s[20:23], s66 offen
    v_mfma_f32_16x16x32_bf16 v[124:127], v[20:23], v[76:79], v[124:127]
    ds_read_b64_tr_b16 v[18:19], v2 offset:1024
    s_waitcnt lgkmcnt(10)
    v_mfma_f32_16x16x32_bf16 v[128:131], v[24:27], v[72:75], v[128:131]
    ds_read_b64_tr_b16 v[20:21], v3 offset:0
    buffer_load_dwordx4 v[68:71], v1, s[20:23], s66 offen offset:256
    v_mfma_f32_16x16x32_bf16 v[132:135], v[24:27], v[76:79], v[132:135]
    ds_read_b64_tr_b16 v[22:23], v3 offset:1024
    s_add_u32 s66, s66, 131072
    v_mfma_f32_16x16x32_bf16 v[136:139], v[28:31], v[72:75], v[136:139]
    ds_read_b64_tr_b16 v[24:25], v4 offset:0
    v_add_u32 v8, s68, v8
    v_mfma_f32_16x16x32_bf16 v[140:143], v[28:31], v[76:79], v[140:143]
    ds_read_b64_tr_b16 v[26:27], v4 offset:1024
    s_waitcnt lgkmcnt(10)
    v_mfma_f32_16x16x32_bf16 v[144:147], v[32:35], v[72:75], v[144:147]
    ds_read_b64_tr_b16 v[28:29], v5 offset:0
    v_add_u32 v9, s68, v9
    v_mfma_f32_16x16x32_bf16 v[148:151], v[32:35], v[76:79], v[148:151]
    ds_read_b64_tr_b16 v[30:31], v5 offset:1024
    v_mfma_f32_16x16x32_bf16 v[152:155], v[36:39], v[72:75], v[152:155]
    ds_read_b64_tr_b16 v[32:33], v6 offset:0
    v_mfma_f32_16x16x32_bf16 v[156:159], v[36:39], v[76:79], v[156:159]
    ds_read_b64_tr_b16 v[34:35], v6 offset:1024
    s_waitcnt lgkmcnt(10)
    v_mfma_f32_16x16x32_bf16 v[160:163], v[40:43], v[72:75], v[160:163]
    ds_read_b64_tr_b16 v[36:37], v7 offset:0
    v_mfma_f32_16x16x32_bf16 v[164:167], v[40:43], v[76:79], v[164:167]
    ds_read_b64_tr_b16 v[38:39], v7 offset:1024
    v_mfma_f32_16x16x32_bf16 v[168:171], v[44:47], v[72:75], v[168:171]
    ds_read_b64_tr_b16 v[40:41], v8 offset:0
    v_mfma_f32_16x16x32_bf16 v[172:175], v[44:47], v[76:79], v[172:175]
    ds_read_b64_tr_b16 v[42:43], v8 offset:1024
    s_waitcnt vmcnt(12) lgkmcnt(10)
    v_mfma_f32_16x16x32_bf16 v[112:115], v[16:19], v[80:83], v[112:115]
    ds_read_b64_tr_b16 v[44:45], v9 offset:0
    s_cmp_eq_u32 s67, 131072
    v_mfma_f32_16x16x32_bf16 v[116:119], v[16:19], v[84:87], v[116:119]
    ds_read_b64_tr_b16 v[46:47], v9 offset:1024
    s_cselect_b32 s68, s81, s80
    v_mfma_f32_16x16x32_bf16 v[120:123], v[20:23], v[80:83], v[120:123]
    ds_read_b64_tr_b16 v[16:17], v2 offset:8192
    buffer_load_dwordx4 v[72:75], v1, s[20:23], s66 offen
    v_mfma_f32_16x16x32_bf16 v[124:127], v[20:23], v[84:87], v[124:127]
    ds_read_b64_tr_b16 v[18:19], v2 offset:9216
    s_waitcnt lgkmcnt(10)
    v_mfma_f32_16x16x32_bf16 v[128:131], v[24:27], v[80:83], v[128:131]
    ds_read_b64_tr_b16 v[20:21], v3 offset:8192
    buffer_load_dwordx4 v[76:79], v1, s[20:23], s66 offen offset:256
    v_mfma_f32_16x16x32_bf16 v[132:135], v[24:27], v[84:87], v[132:135]
    ds_read_b64_tr_b16 v[22:23], v3 offset:9216
    s_add_u32 s66, s66, 131072
    v_mfma_f32_16x16x32_bf16 v[136:139], v[28:31], v[80:83], v[136:139]
    ds_read_b64_tr_b16 v[24:25], v4 offset:8192
    v_mfma_f32_16x16x32_bf16 v[140:143], v[28:31], v[84:87], v[140:143]
    ds_read_b64_tr_b16 v[26:27], v4 offset:9216
    s_waitcnt lgkmcnt(10)
    v_mfma_f32_16x16x32_bf16 v[144:147], v[32:35], v[80:83], v[144:147]
    ds_read_b64_tr_b16 v[28:29], v5 offset:8192
    v_mfma_f32_16x16x32_bf16 v[148:151], v[32:35], v[84:87], v[148:151]
    ds_read_b64_tr_b16 v[30:31], v5 offset:9216
    v_mfma_f32_16x16x32_bf16 v[152:155], v[36:39], v[80:83], v[152:155]
    ds_read_b64_tr_b16 v[32:33], v6 offset:8192
    v_mfma_f32_16x16x32_bf16 v[156:159], v[36:39], v[84:87], v[156:159]
    ds_read_b64_tr_b16 v[34:35], v6 offset:9216
    s_waitcnt lgkmcnt(10)
    v_mfma_f32_16x16x32_bf16 v[160:163], v[40:43], v[80:83], v[160:163]
    ds_read_b64_tr_b16 v[36:37], v7 offset:8192
    v_mfma_f32_16x16x32_bf16 v[164:167], v[40:43], v[84:87], v[164:167]
    ds_read_b64_tr_b16 v[38:39], v7 offset:9216
    v_mfma_f32_16x16x32_bf16 v[168:171], v[44:47], v[80:83], v[168:171]
    ds_read_b64_tr_b16 v[40:41], v8 offset:8192
    v_mfma_f32_16x16x32_bf16 v[172:175], v[44:47], v[84:87], v[172:175]
    ds_read_b64_tr_b16 v[42:43], v8 offset:9216
    s_waitcnt vmcnt(12) lgkmcnt(10)
    v_mfma_f32_16x16x32_bf16 v[112:115], v[16:19], v[88:91], v[112:115]
    ds_read_b64_tr_b16 v[44:45], v9 offset:8192
    v_mfma_f32_16x16x32_bf16 v[116:119], v[16:19], v[92:95], v[116:119]
    ds_read_b64_tr_b16 v[46:47], v9 offset:9216
    v_mfma_f32_16x16x32_bf16 v[120:123], v[20:23], v[88:91], v[120:123]
    ds_read_b64_tr_b16 v[16:17], v2 offset:16384
    buffer_load_dwordx4 v[80:83], v1, s[20:23], s66 offen
    v_mfma_f32_16x16x32_bf16 v[124:127], v[20:23], v[92:95], v[124:127]
    ds_read_b64_tr_b16 v[18:19], v2 offset:17408
    s_waitcnt lgkmcnt(10)
    v_mfma_f32_16x16x32_bf16 v[128:131], v[24:27], v[88:91], v[128:131]
    ds_read_b64_tr_b16 v[20:21], v3 offset:16384
    buffer_load_dwordx4 v[84:87], v1, s[20:23], s66 offen offset:256
    v_mfma_f32_16x16x32_bf16 v[132:135], v[24:27], v[92:95], v[132:135]
    ds_read_b64_tr_b16 v[22:23], v3 offset:17408
    s_add_u32 s66, s66, 131072
    v_mfma_f32_16x16x32_bf16 v[136:139], v[28:31], v[88:91], v[136:139]
    ds_read_b64_tr_b16 v[24:25], v4 offset:16384
    v_mfma_f32_16x16x32_bf16 v[140:143], v[28:31], v[92:95], v[140:143]
    ds_read_b64_tr_b16 v[26:27], v4 offset:17408
    s_waitcnt lgkmcnt(10)
    v_mfma_f32_16x16x32_bf16 v[144:147], v[32:35], v[88:91], v[144:147]
    ds_read_b64_tr_b16 v[28:29], v5 offset:16384
    s_add_u32 s67, s67, s68
    v_mfma_f32_16x16x32_bf16 v[148:151], v[32:35], v[92:95], v[148:151]
    ds_read_b64_tr_b16 v[30:31], v5 offset:17408
    v_mfma_f32_16x16x32_bf16 v[152:155], v[36:39], v[88:91], v[152:155]
    ds_read_b64_tr_b16 v[32:33], v6 offset:16384
    v_mfma_f32_16x16x32_bf16 v[156:159], v[36:39], v[92:95], v[156:159]
    ds_read_b64_tr_b16 v[34:35], v6 offset:17408
    s_waitcnt lgkmcnt(10)
    v_mfma_f32_16x16x32_bf16 v[160:163], v[40:43], v[88:91], v[160:163]
    ds_read_b64_tr_b16 v[36:37], v7 offset:16384
    v_mfma_f32_16x16x32_bf16 v[164:167], v[40:43], v[92:95], v[164:167]
    ds_read_b64_tr_b16 v[38:39], v7 offset:17408
    v_mfma_f32_16x16x32_bf16 v[168:171], v[44:47], v[88:91], v[168:171]
    ds_read_b64_tr_b16 v[40:41], v8 offset:16384
    v_mfma_f32_16x16x32_bf16 v[172:175], v[44:47], v[92:95], v[172:175]
    ds_read_b64_tr_b16 v[42:43], v8 offset:17408
    s_waitcnt vmcnt(12) lgkmcnt(10)
    v_mfma_f32_16x16x32_bf16 v[112:115], v[16:19], v[96:99], v[112:115]
    ds_read_b64_tr_b16 v[44:45], v9 offset:16384
    v_mfma_f32_16x16x32_bf16 v[116:119], v[16:19], v[100:103], v[116:119]
    ds_read_b64_tr_b16 v[46:47], v9 offset:17408
    v_mfma_f32_16x16x32_bf16 v[120:123], v[20:23], v[96:99], v[120:123]
    ds_read_b64_tr_b16 v[16:17], v2 offset:24576
    buffer_load_dwordx4 v[88:91], v1, s[20:23], s66 offen
    v_mfma_f32_16x16x32_bf16 v[124:127], v[20:23], v[100:103], v[124:127]
    ds_read_b64_tr_b16 v[18:19], v2 offset:25600
    s_waitcnt lgkmcnt(10)
    v_mfma_f32_16x16x32_bf16 v[128:131], v[24:27], v[96:99], v[128:131]
    ds_read_b64_tr_b16 v[20:21], v3 offset:24576
    buffer_load_dwordx4 v[92:95], v1, s[20:23], s66 offen offset:256
    v_mfma_f32_16x16x32_bf16 v[132:135], v[24:27], v[100:103], v[132:135]
    ds_read_b64_tr_b16 v[22:23], v3 offset:25600
    s_add_u32 s66, s66, 131072
    v_mfma_f32_16x16x32_bf16 v[136:139], v[28:31], v[96:99], v[136:139]
    ds_read_b64_tr_b16 v[24:25], v4 offset:24576
    v_add_u32 v2, s68, v2
    v_mfma_f32_16x16x32_bf16 v[140:143], v[28:31], v[100:103], v[140:143]
    ds_read_b64_tr_b16 v[26:27], v4 offset:25600
    s_waitcnt lgkmcnt(10)
    v_mfma_f32_16x16x32_bf16 v[144:147], v[32:35], v[96:99], v[144:147]
    ds_read_b64_tr_b16 v[28:29], v5 offset:24576
    v_add_u32 v3, s68, v3
    v_mfma_f32_16x16x32_bf16 v[148:151], v[32:35], v[100:103], v[148:151]
    ds_read_b64_tr_b16 v[30:31], v5 offset:25600
    v_add_u32 v4, s68, v4
    v_mfma_f32_16x16x32_bf16 v[152:155], v[36:39], v[96:99], v[152:155]
    ds_read_b64_tr_b16 v[32:33], v6 offset:24576
    v_add_u32 v5, s68, v5
    v_mfma_f32_16x16x32_bf16 v[156:159], v[36:39], v[100:103], v[156:159]
    ds_read_b64_tr_b16 v[34:35], v6 offset:25600
    s_waitcnt lgkmcnt(10)
    v_mfma_f32_16x16x32_bf16 v[160:163], v[40:43], v[96:99], v[160:163]
    ds_read_b64_tr_b16 v[36:37], v7 offset:24576
    v_add_u32 v6, s68, v6
    v_mfma_f32_16x16x32_bf16 v[164:167], v[40:43], v[100:103], v[164:167]
    ds_read_b64_tr_b16 v[38:39], v7 offset:25600
    v_mfma_f32_16x16x32_bf16 v[168:171], v[44:47], v[96:99], v[168:171]
    ds_read_b64_tr_b16 v[40:41], v8 offset:24576
    v_add_u32 v7, s68, v7
    v_mfma_f32_16x16x32_bf16 v[172:175], v[44:47], v[100:103], v[172:175]
    ds_read_b64_tr_b16 v[42:43], v8 offset:25600
    s_waitcnt vmcnt(12) lgkmcnt(10)
    v_mfma_f32_16x16x32_bf16 v[112:115], v[16:19], v[104:107], v[112:115]
    ds_read_b64_tr_b16 v[44:45], v9 offset:24576
    v_mfma_f32_16x16x32_bf16 v[116:119], v[16:19], v[108:111], v[116:119]
    ds_read_b64_tr_b16 v[46:47], v9 offset:25600
    s_barrier
    v_mfma_f32_16x16x32_bf16 v[120:123], v[20:23], v[104:107], v[120:123]
    ds_read_b64_tr_b16 v[16:17], v2 offset:0
    buffer_load_dwordx4 v[96:99], v1, s[20:23], s66 offen
    v_mfma_f32_16x16x32_bf16 v[124:127], v[20:23], v[108:111], v[124:127]
    ds_read_b64_tr_b16 v[18:19], v2 offset:1024
    s_waitcnt lgkmcnt(10)
    v_mfma_f32_16x16x32_bf16 v[128:131], v[24:27], v[104:107], v[128:131]
    ds_read_b64_tr_b16 v[20:21], v3 offset:0
    buffer_load_dwordx4 v[100:103], v1, s[20:23], s66 offen offset:256
    v_mfma_f32_16x16x32_bf16 v[132:135], v[24:27], v[108:111], v[132:135]
    ds_read_b64_tr_b16 v[22:23], v3 offset:1024
    s_add_u32 s66, s66, 131072
    v_mfma_f32_16x16x32_bf16 v[136:139], v[28:31], v[104:107], v[136:139]
    ds_read_b64_tr_b16 v[24:25], v4 offset:0
    v_add_u32 v8, s68, v8
    v_mfma_f32_16x16x32_bf16 v[140:143], v[28:31], v[108:111], v[140:143]
    ds_read_b64_tr_b16 v[26:27], v4 offset:1024
    s_waitcnt lgkmcnt(10)
    v_mfma_f32_16x16x32_bf16 v[144:147], v[32:35], v[104:107], v[144:147]
    ds_read_b64_tr_b16 v[28:29], v5 offset:0
    v_add_u32 v9, s68, v9
    v_mfma_f32_16x16x32_bf16 v[148:151], v[32:35], v[108:111], v[148:151]
    ds_read_b64_tr_b16 v[30:31], v5 offset:1024
    v_mfma_f32_16x16x32_bf16 v[152:155], v[36:39], v[104:107], v[152:155]
    ds_read_b64_tr_b16 v[32:33], v6 offset:0
    s_sub_u32 s69, s69, 1
    v_mfma_f32_16x16x32_bf16 v[156:159], v[36:39], v[108:111], v[156:159]
    ds_read_b64_tr_b16 v[34:35], v6 offset:1024
    s_waitcnt lgkmcnt(10)
    v_mfma_f32_16x16x32_bf16 v[160:163], v[40:43], v[104:107], v[160:163]
    ds_read_b64_tr_b16 v[36:37], v7 offset:0
    s_cmp_lg_u32 s69, 0
    v_mfma_f32_16x16x32_bf16 v[164:167], v[40:43], v[108:111], v[164:167]
    ds_read_b64_tr_b16 v[38:39], v7 offset:1024
    v_mfma_f32_16x16x32_bf16 v[168:171], v[44:47], v[104:107], v[168:171]
    ds_read_b64_tr_b16 v[40:41], v8 offset:0
    v_mfma_f32_16x16x32_bf16 v[172:175], v[44:47], v[108:111], v[172:175]
    ds_read_b64_tr_b16 v[42:43], v8 offset:1024
    s_cbranch_scc1 K3_CL_1
    s_waitcnt vmcnt(12) lgkmcnt(10)
    v_mfma_f32_16x16x32_bf16 v[112:115], v[16:19], v[48:51], v[112:115]
    ds_read_b64_tr_b16 v[44:45], v9 offset:0
    v_mfma_f32_16x16x32_bf16 v[116:119], v[16:19], v[52:55], v[116:119]
    ds_read_b64_tr_b16 v[46:47], v9 offset:1024
    v_mfma_f32_16x16x32_bf16 v[120:123], v[20:23], v[48:51], v[120:123]
    ds_read_b64_tr_b16 v[16:17], v6 offset:8192
    buffer_load_dwordx4 v[104:107], v1, s[20:23], s66 offen
    v_mfma_f32_16x16x32_bf16 v[124:127], v[20:23], v[52:55], v[124:127]
    ds_read_b64_tr_b16 v[18:19], v6 offset:9216
    s_waitcnt lgkmcnt(10)
    v_mfma_f32_16x16x32_bf16 v[128:131], v[24:27], v[48:51], v[128:131]
    ds_read_b64_tr_b16 v[20:21], v7 offset:8192
    buffer_load_dwordx4 v[108:111], v1, s[20:23], s66 offen offset:256
    v_mfma_f32_16x16x32_bf16 v[132:135], v[24:27], v[52:55], v[132:135]
    ds_read_b64_tr_b16 v[22:23], v7 offset:9216
    v_mfma_f32_16x16x32_bf16 v[136:139], v[28:31], v[48:51], v[136:139]
    ds_read_b64_tr_b16 v[24:25], v8 offset:8192
    v_mfma_f32_16x16x32_bf16 v[140:143], v[28:31], v[52:55], v[140:143]
    ds_read_b64_tr_b16 v[26:27], v8 offset:9216
    s_waitcnt lgkmcnt(10)
    v_mfma_f32_16x16x32_bf16 v[144:147], v[32:35], v[48:51], v[144:147]
    ds_read_b64_tr_b16 v[28:29], v9 offset:8192
    v_mfma_f32_16x16x32_bf16 v[148:151], v[32:35], v[52:55], v[148:151]
    ds_read_b64_tr_b16 v[30:31], v9 offset:9216
    v_mfma_f32_16x16x32_bf16 v[152:155], v[36:39], v[48:51], v[152:155]
    ds_read_b64_tr_b16 v[32:33], v6 offset:16384
    v_mfma_f32_16x16x32_bf16 v[156:159], v[36:39], v[52:55], v[156:159]
    ds_read_b64_tr_b16 v[34:35], v6 offset:17408
    s_waitcnt lgkmcnt(10)
    v_mfma_f32_16x16x32_bf16 v[160:163], v[40:43], v[48:51], v[160:163]
    ds_read_b64_tr_b16 v[36:37], v7 offset:16384
    v_mfma_f32_16x16x32_bf16 v[164:167], v[40:43], v[52:55], v[164:167]
    ds_read_b64_tr_b16 v[38:39], v7 offset:17408
    v_mfma_f32_16x16x32_bf16 v[168:171], v[44:47], v[48:51], v[168:171]
    ds_read_b64_tr_b16 v[40:41], v8 offset:16384
    v_mfma_f32_16x16x32_bf16 v[172:175], v[44:47], v[52:55], v[172:175]
    ds_read_b64_tr_b16 v[42:43], v8 offset:17408
    s_waitcnt vmcnt(12) lgkmcnt(10)
    v_mfma_f32_16x16x32_bf16 v[144:147], v[16:19], v[56:59], v[144:147]
    ds_read_b64_tr_b16 v[44:45], v9 offset:16384
    v_mfma_f32_16x16x32_bf16 v[148:151], v[16:19], v[60:63], v[148:151]
    ds_read_b64_tr_b16 v[46:47], v9 offset:17408
    v_mfma_f32_16x16x32_bf16 v[152:155], v[20:23], v[56:59], v[152:155]
    ds_read_b64_tr_b16 v[16:17], v6 offset:24576
    v_mfma_f32_16x16x32_bf16 v[156:159], v[20:23], v[60:63], v[156:159]
    ds_read_b64_tr_b16 v[18:19], v6 offset:25600
    s_waitcnt lgkmcnt(10)
    v_mfma_f32_16x16x32_bf16 v[160:163], v[24:27], v[56:59], v[160:163]
    ds_read_b64_tr_b16 v[20:21], v7 offset:24576
    v_mfma_f32_16x16x32_bf16 v[164:167], v[24:27], v[60:63], v[164:167]
    ds_read_b64_tr_b16 v[22:23], v7 offset:25600
    v_mfma_f32_16x16x32_bf16 v[168:171], v[28:31], v[56:59], v[168:171]
    ds_read_b64_tr_b16 v[24:25], v8 offset:24576
    v_mfma_f32_16x16x32_bf16 v[172:175], v[28:31], v[60:63], v[172:175]
    ds_read_b64_tr_b16 v[26:27], v8 offset:25600
    s_waitcnt vmcnt(10) lgkmcnt(10)
    v_mfma_f32_16x16x32_bf16 v[144:147], v[32:35], v[64:67], v[144:147]
    ds_read_b64_tr_b16 v[28:29], v9 offset:24576
    v_mfma_f32_16x16x32_bf16 v[148:151], v[32:35], v[68:71], v[148:151]
    ds_read_b64_tr_b16 v[30:31], v9 offset:25600
    s_barrier
    v_mfma_f32_16x16x32_bf16 v[152:155], v[36:39], v[64:67], v[152:155]
    ds_read_b64_tr_b16 v[32:33], v6 offset:32768
    v_mfma_f32_16x16x32_bf16 v[156:159], v[36:39], v[68:71], v[156:159]
    ds_read_b64_tr_b16 v[34:35], v6 offset:33792
    s_waitcnt lgkmcnt(10)
    v_mfma_f32_16x16x32_bf16 v[160:163], v[40:43], v[64:67], v[160:163]
    ds_read_b64_tr_b16 v[36:37], v7 offset:32768
    v_mfma_f32_16x16x32_bf16 v[164:167], v[40:43], v[68:71], v[164:167]
    ds_read_b64_tr_b16 v[38:39], v7 offset:33792
    v_mfma_f32_16x16x32_bf16 v[168:171], v[44:47], v[64:67], v[168:171]
    ds_read_b64_tr_b16 v[40:41], v8 offset:32768
    v_mfma_f32_16x16x32_bf16 v[172:175], v[44:47], v[68:71], v[172:175]
    ds_read_b64_tr_b16 v[42:43], v8 offset:33792
    s_waitcnt vmcnt(8) lgkmcnt(10)
    v_mfma_f32_16x16x32_bf16 v[144:147], v[16:19], v[72:75], v[144:147]
    ds_read_b64_tr_b16 v[44:45], v9 offset:32768
    v_mfma_f32_16x16x32_bf16 v[148:151], v[16:19], v[76:79], v[148:151]
    ds_read_b64_tr_b16 v[46:47], v9 offset:33792
    v_mfma_f32_16x16x32_bf16 v[152:155], v[20:23], v[72:75], v[152:155]
    ds_read_b64_tr_b16 v[16:17], v6 offset:40960
    v_mfma_f32_16x16x32_bf16 v[156:159], v[20:23], v[76:79], v[156:159]
    ds_read_b64_tr_b16 v[18:19], v6 offset:41984
    s_waitcnt lgkmcnt(10)
    v_mfma_f32_16x16x32_bf16 v[160:163], v[24:27], v[72:75], v[160:163]
    ds_read_b64_tr_b16 v[20:21], v7 offset:40960
    v_mfma_f32_16x16x32_bf16 v[164:167], v[24:27], v[76:79], v[164:167]
    ds_read_b64_tr_b16 v[22:23], v7 offset:41984
    v_mfma_f32_16x16x32_bf16 v[168:171], v[28:31], v[72:75], v[168:171]
    ds_read_b64_tr_b16 v[24:25], v8 offset:40960
    v_mfma_f32_16x16x32_bf16 v[172:175], v[28:31], v[76:79], v[172:175]
    ds_read_b64_tr_b16 v[26:27], v8 offset:41984
    s_waitcnt vmcnt(6) lgkmcnt(10)
    v_mfma_f32_16x16x32_bf16 v[144:147], v[32:35], v[80:83], v[144:147]
    ds_read_b64_tr_b16 v[28:29], v9 offset:40960
    v_mfma_f32_16x16x32_bf16 v[148:151], v[32:35], v[84:87], v[148:151]
    ds_read_b64_tr_b16 v[30:31], v9 offset:41984
    v_mfma_f32_16x16x32_bf16 v[152:155], v[36:39], v[80:83], v[152:155]
    ds_read_b64_tr_b16 v[32:33], v6 offset:49152
    v_mfma_f32_16x16x32_bf16 v[156:159], v[36:39], v[84:87], v[156:159]
    ds_read_b64_tr_b16 v[34:35], v6 offset:50176
    s_waitcnt lgkmcnt(10)
    v_mfma_f32_16x16x32_bf16 v[160:163], v[40:43], v[80:83], v[160:163]
    ds_read_b64_tr_b16 v[36:37], v7 offset:49152
    v_mfma_f32_16x16x32_bf16 v[164:167], v[40:43], v[84:87], v[164:167]
    ds_read_b64_tr_b16 v[38:39], v7 offset:50176
    v_mfma_f32_16x16x32_bf16 v[168:171], v[44:47], v[80:83], v[168:171]
    ds_read_b64_tr_b16 v[40:41], v8 offset:49152
    v_mfma_f32_16x16x32_bf16 v[172:175], v[44:47], v[84:87], v[172:175]
    ds_read_b64_tr_b16 v[42:43], v8 offset:50176
    s_waitcnt vmcnt(4) lgkmcnt(10)
    v_mfma_f32_16x16x32_bf16 v[144:147], v[16:19], v[88:91], v[144:147]
    ds_read_b64_tr_b16 v[44:45], v9 offset:49152
    v_mfma_f32_16x16x32_bf16 v[148:151], v[16:19], v[92:95], v[148:151]
    ds_read_b64_tr_b16 v[46:47], v9 offset:50176
    v_mfma_f32_16x16x32_bf16 v[152:155], v[20:23], v[88:91], v[152:155]
    ds_read_b64_tr_b16 v[16:17], v6 offset:57344
    v_mfma_f32_16x16x32_bf16 v[156:159], v[20:23], v[92:95], v[156:159]
    ds_read_b64_tr_b16 v[18:19], v6 offset:58368
    s_waitcnt lgkmcnt(10)
    v_mfma_f32_16x16x32_bf16 v[160:163], v[24:27], v[88:91], v[160:163]
    ds_read_b64_tr_b16 v[20:21], v7 offset:57344
    v_mfma_f32_16x16x32_bf16 v[164:167], v[24:27], v[92:95], v[164:167]
    ds_read_b64_tr_b16 v[22:23], v7 offset:58368
    v_mfma_f32_16x16x32_bf16 v[168:171], v[28:31], v[88:91], v[168:171]
    ds_read_b64_tr_b16 v[24:25], v8 offset:57344
    v_mfma_f32_16x16x32_bf16 v[172:175], v[28:31], v[92:95], v[172:175]
    ds_read_b64_tr_b16 v[26:27], v8 offset:58368
    s_waitcnt vmcnt(2) lgkmcnt(10)
    v_mfma_f32_16x16x32_bf16 v[144:147], v[32:35], v[96:99], v[144:147]
    ds_read_b64_tr_b16 v[28:29], v9 offset:57344
    v_mfma_f32_16x16x32_bf16 v[148:151], v[32:35], v[100:103], v[148:151]
    ds_read_b64_tr_b16 v[30:31], v9 offset:58368
    v_mfma_f32_16x16x32_bf16 v[152:155], v[36:39], v[96:99], v[152:155]
    ds_read_b64_tr_b16 v[32:33], v2 offset:8192
    v_mfma_f32_16x16x32_bf16 v[156:159], v[36:39], v[100:103], v[156:159]
    ds_read_b64_tr_b16 v[34:35], v2 offset:9216
    s_waitcnt lgkmcnt(10)
    v_mfma_f32_16x16x32_bf16 v[160:163], v[40:43], v[96:99], v[160:163]
    ds_read_b64_tr_b16 v[36:37], v3 offset:8192
    v_mfma_f32_16x16x32_bf16 v[164:167], v[40:43], v[100:103], v[164:167]
    ds_read_b64_tr_b16 v[38:39], v3 offset:9216
    v_mfma_f32_16x16x32_bf16 v[168:171], v[44:47], v[96:99], v[168:171]
    ds_read_b64_tr_b16 v[40:41], v4 offset:8192
    v_mfma_f32_16x16x32_bf16 v[172:175], v[44:47], v[100:103], v[172:175]
    ds_read_b64_tr_b16 v[42:43], v4 offset:9216
    s_waitcnt vmcnt(0) lgkmcnt(10)
    v_mfma_f32_16x16x32_bf16 v[144:147], v[16:19], v[104:107], v[144:147]
    ds_read_b64_tr_b16 v[44:45], v5 offset:8192
    v_mfma_f32_16x16x32_bf16 v[148:151], v[16:19], v[108:111], v[148:151]
    ds_read_b64_tr_b16 v[46:47], v5 offset:9216
    v_mfma_f32_16x16x32_bf16 v[152:155], v[20:23], v[104:107], v[152:155]
    ds_read_b64_tr_b16 v[16:17], v2 offset:16384
    v_mfma_f32_16x16x32_bf16 v[156:159], v[20:23], v[108:111], v[156:159]
    ds_read_b64_tr_b16 v[18:19], v2 offset:17408
    s_waitcnt lgkmcnt(10)
    v_mfma_f32_16x16x32_bf16 v[160:163], v[24:27], v[104:107], v[160:163]
    ds_read_b64_tr_b16 v[20:21], v3 offset:16384
    v_mfma_f32_16x16x32_bf16 v[164:167], v[24:27], v[108:111], v[164:167]
    ds_read_b64_tr_b16 v[22:23], v3 offset:17408
    v_mfma_f32_16x16x32_bf16 v[168:171], v[28:31], v[104:107], v[168:171]
    ds_read_b64_tr_b16 v[24:25], v4 offset:16384
    v_mfma_f32_16x16x32_bf16 v[172:175], v[28:31], v[108:111], v[172:175]
    ds_read_b64_tr_b16 v[26:27], v4 offset:17408
    s_waitcnt lgkmcnt(10)
    v_mfma_f32_16x16x32_bf16 v[112:115], v[32:35], v[56:59], v[112:115]
    ds_read_b64_tr_b16 v[28:29], v5 offset:16384
    v_mfma_f32_16x16x32_bf16 v[116:119], v[32:35], v[60:63], v[116:119]
    ds_read_b64_tr_b16 v[30:31], v5 offset:17408
    v_mfma_f32_16x16x32_bf16 v[120:123], v[36:39], v[56:59], v[120:123]
    ds_read_b64_tr_b16 v[32:33], v2 offset:24576
    v_mfma_f32_16x16x32_bf16 v[124:127], v[36:39], v[60:63], v[124:127]
    ds_read_b64_tr_b16 v[34:35], v2 offset:25600
    s_waitcnt lgkmcnt(10)
    v_mfma_f32_16x16x32_bf16 v[128:131], v[40:43], v[56:59], v[128:131]
    ds_read_b64_tr_b16 v[36:37], v3 offset:24576
    v_mfma_f32_16x16x32_bf16 v[132:135], v[40:43], v[60:63], v[132:135]
    ds_read_b64_tr_b16 v[38:39], v3 offset:25600
    v_mfma_f32_16x16x32_bf16 v[136:139], v[44:47], v[56:59], v[136:139]
    ds_read_b64_tr_b16 v[40:41], v4 offset:24576
    v_cvt_pk_bf16_f32 v144, v144, v145
    v_cvt_pk_bf16_f32 v145, v146, v147
    v_cvt_pk_bf16_f32 v146, v148, v149
    v_cvt_pk_bf16_f32 v147, v150, v151
    v_mfma_f32_16x16x32_bf16 v[140:143], v[44:47], v[60:63], v[140:143]
    ds_read_b64_tr_b16 v[42:43], v4 offset:25600
    v_min_u32 v144, s75, v144
    v_min_u32 v145, s75, v145
    v_min_u32 v146, s75, v146
    v_min_u32 v147, s75, v147
    s_waitcnt lgkmcnt(10)
    v_mfma_f32_16x16x32_bf16 v[112:115], v[16:19], v[64:67], v[112:115]
    ds_read_b64_tr_b16 v[44:45], v5 offset:24576
    v_cvt_pk_bf16_f32 v152, v152, v153
    v_cvt_pk_bf16_f32 v153, v154, v155
    v_cvt_pk_bf16_f32 v154, v156, v157
    v_cvt_pk_bf16_f32 v155, v158, v159
    v_mfma_f32_16x16x32_bf16 v[116:119], v[16:19], v[68:71], v[116:119]
    ds_read_b64_tr_b16 v[46:47], v5 offset:25600
    v_min_u32 v152, s75, v152
    v_min_u32 v153, s75, v153
    v_min_u32 v154, s75, v154
    v_mfma_f32_16x16x32_bf16 v[120:123], v[20:23], v[64:67], v[120:123]
    ds_read_b64_tr_b16 v[16:17], v2 offset:32768
    v_min_u32 v155, s75, v155
    v_mov_b32 v220, v144
    v_mov_b32 v221, v145
    v_mov_b32 v222, v146
    v_mfma_f32_16x16x32_bf16 v[124:127], v[20:23], v[68:71], v[124:127]
    ds_read_b64_tr_b16 v[18:19], v2 offset:33792
    v_mov_b32 v223, v147
    v_mov_b32_dpp v144, v152 row_ror:8 row_mask:0xf bank_mask:0xc
    v_mov_b32_dpp v145, v153 row_ror:8 row_mask:0xf bank_mask:0xc
    v_mov_b32_dpp v146, v154 row_ror:8 row_mask:0xf bank_mask:0xc
    s_waitcnt lgkmcnt(10)
    v_mfma_f32_16x16x32_bf16 v[128:131], v[24:27], v[64:67], v[128:131]
    ds_read_b64_tr_b16 v[20:21], v3 offset:32768
    v_mov_b32_dpp v147, v155 row_ror:8 row_mask:0xf bank_mask:0xc
    v_mov_b32_dpp v152, v220 row_ror:8 row_mask:0xf bank_mask:0x3
    v_mov_b32_dpp v153, v221 row_ror:8 row_mask:0xf bank_mask:0x3
    v_mov_b32_dpp v154, v222 row_ror:8 row_mask:0xf bank_mask:0x3
    v_mfma_f32_16x16x32_bf16 v[132:135], v[24:27], v[68:71], v[132:135]
    ds_read_b64_tr_b16 v[22:23], v3 offset:33792
    v_mov_b32_dpp v155, v223 row_ror:8 row_mask:0xf bank_mask:0x3
    buffer_store_dwordx4 v[144:147], v15, s[36:39], s72 offen offset:0 sc1
    buffer_store_dwordx4 v[152:155], v15, s[36:39], s72 offen offset:1024 sc1
    v_mfma_f32_16x16x32_bf16 v[136:139], v[28:31], v[64:67], v[136:139]
    ds_read_b64_tr_b16 v[24:25], v4 offset:32768
    v_cvt_pk_bf16_f32 v160, v160, v161
    v_cvt_pk_bf16_f32 v161, v162, v163
    v_cvt_pk_bf16_f32 v162, v164, v165
    v_cvt_pk_bf16_f32 v163, v166, v167
    v_mfma_f32_16x16x32_bf16 v[140:143], v[28:31], v[68:71], v[140:143]
    ds_read_b64_tr_b16 v[26:27], v4 offset:33792
    v_min_u32 v160, s75, v160
    v_min_u32 v161, s75, v161
    v_min_u32 v162, s75, v162
    v_min_u32 v163, s75, v163
    s_waitcnt lgkmcnt(10)
    v_mfma_f32_16x16x32_bf16 v[112:115], v[32:35], v[72:75], v[112:115]
    ds_read_b64_tr_b16 v[28:29], v5 offset:32768
    v_cvt_pk_bf16_f32 v168, v168, v169
    v_cvt_pk_bf16_f32 v169, v170, v171
    v_cvt_pk_bf16_f32 v170, v172, v173
    v_cvt_pk_bf16_f32 v171, v174, v175
    v_mfma_f32_16x16x32_bf16 v[116:119], v[32:35], v[76:79], v[116:119]
    ds_read_b64_tr_b16 v[30:31], v5 offset:33792
    v_min_u32 v168, s75, v168
    v_min_u32 v169, s75, v169
    v_min_u32 v170, s75, v170
    v_mfma_f32_16x16x32_bf16 v[120:123], v[36:39], v[72:75], v[120:123]
    ds_read_b64_tr_b16 v[32:33], v2 offset:40960
    v_min_u32 v171, s75, v171
    v_mov_b32 v220, v160
    v_mov_b32 v221, v161
    v_mov_b32 v222, v162
    v_mfma_f32_16x16x32_bf16 v[124:127], v[36:39], v[76:79], v[124:127]
    ds_read_b64_tr_b16 v[34:35], v2 offset:41984
    v_mov_b32 v223, v163
    v_mov_b32_dpp v160, v168 row_ror:8 row_mask:0xf bank_mask:0xc
    v_mov_b32_dpp v161, v169 row_ror:8 row_mask:0xf bank_mask:0xc
    v_mov_b32_dpp v162, v170 row_ror:8 row_mask:0xf bank_mask:0xc
    s_waitcnt lgkmcnt(10)
    v_mfma_f32_16x16x32_bf16 v[128:131], v[40:43], v[72:75], v[128:131]
    ds_read_b64_tr_b16 v[36:37], v3 offset:40960
    v_mov_b32_dpp v163, v171 row_ror:8 row_mask:0xf bank_mask:0xc
    v_mov_b32_dpp v168, v220 row_ror:8 row_mask:0xf bank_mask:0x3
    v_mov_b32_dpp v169, v221 row_ror:8 row_mask:0xf bank_mask:0x3
    v_mov_b32_dpp v170, v222 row_ror:8 row_mask:0xf bank_mask:0x3
    v_mfma_f32_16x16x32_bf16 v[132:135], v[40:43], v[76:79], v[132:135]
    ds_read_b64_tr_b16 v[38:39], v3 offset:41984
    v_mov_b32_dpp v171, v223 row_ror:8 row_mask:0xf bank_mask:0x3
    buffer_store_dwordx4 v[160:163], v15, s[36:39], s72 offen offset:2048 sc1
    buffer_store_dwordx4 v[168:171], v15, s[36:39], s72 offen offset:3072 sc1
    v_mfma_f32_16x16x32_bf16 v[136:139], v[44:47], v[72:75], v[136:139]
    ds_read_b64_tr_b16 v[40:41], v4 offset:40960
    v_mfma_f32_16x16x32_bf16 v[140:143], v[44:47], v[76:79], v[140:143]
    ds_read_b64_tr_b16 v[42:43], v4 offset:41984
    s_waitcnt lgkmcnt(10)
    v_mfma_f32_16x16x32_bf16 v[112:115], v[16:19], v[80:83], v[112:115]
    ds_read_b64_tr_b16 v[44:45], v5 offset:40960
    v_mfma_f32_16x16x32_bf16 v[116:119], v[16:19], v[84:87], v[116:119]
    ds_read_b64_tr_b16 v[46:47], v5 offset:41984
    v_mfma_f32_16x16x32_bf16 v[120:123], v[20:23], v[80:83], v[120:123]
    ds_read_b64_tr_b16 v[16:17], v2 offset:49152
    v_mfma_f32_16x16x32_bf16 v[124:127], v[20:23], v[84:87], v[124:127]
    ds_read_b64_tr_b16 v[18:19], v2 offset:50176
    s_waitcnt lgkmcnt(10)
    v_mfma_f32_16x16x32_bf16 v[128:131], v[24:27], v[80:83], v[128:131]
    ds_read_b64_tr_b16 v[20:21], v3 offset:49152
    v_mfma_f32_16x16x32_bf16 v[132:135], v[24:27], v[84:87], v[132:135]
    ds_read_b64_tr_b16 v[22:23], v3 offset:50176
    v_mfma_f32_16x16x32_bf16 v[136:139], v[28:31], v[80:83], v[136:139]
    ds_read_b64_tr_b16 v[24:25], v4 offset:49152
    v_mfma_f32_16x16x32_bf16 v[140:143], v[28:31], v[84:87], v[140:143]
    ds_read_b64_tr_b16 v[26:27], v4 offset:50176
    s_waitcnt lgkmcnt(10)
    v_mfma_f32_16x16x32_bf16 v[112:115], v[32:35], v[88:91], v[112:115]
    ds_read_b64_tr_b16 v[28:29], v5 offset:49152
    v_mfma_f32_16x16x32_bf16 v[116:119], v[32:35], v[92:95], v[116:119]
    ds_read_b64_tr_b16 v[30:31], v5 offset:50176
    v_mfma_f32_16x16x32_bf16 v[120:123], v[36:39], v[88:91], v[120:123]
    ds_read_b64_tr_b16 v[32:33], v2 offset:57344
    v_mfma_f32_16x16x32_bf16 v[124:127], v[36:39], v[92:95], v[124:127]
    ds_read_b64_tr_b16 v[34:35], v2 offset:58368
    s_waitcnt lgkmcnt(10)
    v_mfma_f32_16x16x32_bf16 v[128:131], v[40:43], v[88:91], v[128:131]
    ds_read_b64_tr_b16 v[36:37], v3 offset:57344
    v_mfma_f32_16x16x32_bf16 v[132:135], v[40:43], v[92:95], v[132:135]
    ds_read_b64_tr_b16 v[38:39], v3 offset:58368
    v_mfma_f32_16x16x32_bf16 v[136:139], v[44:47], v[88:91], v[136:139]
    ds_read_b64_tr_b16 v[40:41], v4 offset:57344
    v_mfma_f32_16x16x32_bf16 v[140:143], v[44:47], v[92:95], v[140:143]
    ds_read_b64_tr_b16 v[42:43], v4 offset:58368
    s_waitcnt lgkmcnt(10)
    v_mfma_f32_16x16x32_bf16 v[112:115], v[16:19], v[96:99], v[112:115]
    ds_read_b64_tr_b16 v[44:45], v5 offset:57344
    v_mfma_f32_16x16x32_bf16 v[116:119], v[16:19], v[100:103], v[116:119]
    ds_read_b64_tr_b16 v[46:47], v5 offset:58368
    v_mfma_f32_16x16x32_bf16 v[120:123], v[20:23], v[96:99], v[120:123]
    v_mfma_f32_16x16x32_bf16 v[124:127], v[20:23], v[100:103], v[124:127]
    s_waitcnt lgkmcnt(8)
    v_mfma_f32_16x16x32_bf16 v[128:131], v[24:27], v[96:99], v[128:131]
    v_mfma_f32_16x16x32_bf16 v[132:135], v[24:27], v[100:103], v[132:135]
    v_mfma_f32_16x16x32_bf16 v[136:139], v[28:31], v[96:99], v[136:139]
    v_mfma_f32_16x16x32_bf16 v[140:143], v[28:31], v[100:103], v[140:143]
    s_waitcnt lgkmcnt(4)
    v_mfma_f32_16x16x32_bf16 v[112:115], v[32:35], v[104:107], v[112:115]
    buffer_load_dwordx4 v[148:151], v15, s[36:39], s73 offen offset:0 sc1
    v_mfma_f32_16x16x32_bf16 v[116:119], v[32:35], v[108:111], v[116:119]
    buffer_load_dwordx4 v[156:159], v15, s[36:39], s73 offen offset:1024 sc1
    v_mfma_f32_16x16x32_bf16 v[120:123], v[36:39], v[104:107], v[120:123]
    buffer_load_dwordx4 v[164:167], v15, s[36:39], s73 offen offset:2048 sc1
    v_mfma_f32_16x16x32_bf16 v[124:127], v[36:39], v[108:111], v[124:127]
    buffer_load_dwordx4 v[172:175], v15, s[36:39], s73 offen offset:3072 sc1
    s_waitcnt lgkmcnt(0)
    v_mfma_f32_16x16x32_bf16 v[128:131], v[40:43], v[104:107], v[128:131]
    v_mfma_f32_16x16x32_bf16 v[132:135], v[40:43], v[108:111], v[132:135]
    v_mfma_f32_16x16x32_bf16 v[136:139], v[44:47], v[104:107], v[136:139]
    v_mfma_f32_16x16x32_bf16 v[140:143], v[44:47], v[108:111], v[140:143]
    s_branch K3_EPI
K3_H1:
    s_mov_b32 s69, 2
K3_CL_2:
    s_waitcnt vmcnt(12) lgkmcnt(10)
    v_mfma_f32_16x16x32_bf16 v[112:115], v[16:19], v[48:51], v[112:115]
    ds_read_b64_tr_b16 v[44:45], v9 offset:0
    s_cmp_eq_u32 s67, 131072
    v_mfma_f32_16x16x32_bf16 v[116:119], v[16:19], v[52:55], v[116:119]
    ds_read_b64_tr_b16 v[46:47], v9 offset:1024
    s_cselect_b32 s68, s81, s80
    v_mfma_f32_16x16x32_bf16 v[120:123], v[20:23], v[48:51], v[120:123]
    ds_read_b64_tr_b16 v[16:17], v2 offset:8192
    buffer_load_dwordx4 v[104:107], v1, s[20:23], s66 offen
    v_mfma_f32_16x16x32_bf16 v[124:127], v[20:23], v[52:55], v[124:127]
    ds_read_b64_tr_b16 v[18:19], v2 offset:9216
    s_waitcnt lgkmcnt(10)
    v_mfma_f32_16x16x32_bf16 v[128:131], v[24:27], v[48:51], v[128:131]
    ds_read_b64_tr_b16 v[20:21], v3 offset:8192
    buffer_load_dwordx4 v[108:111], v1, s[20:23], s66 offen offset:256
    v_mfma_f32_16x16x32_bf16 v[132:135], v[24:27], v[52:55], v[132:135]
    ds_read_b64_tr_b16 v[22:23], v3 offset:9216
    s_add_u32 s66, s66, 131072
    v_mfma_f32_16x16x32_bf16 v[136:139], v[28:31], v[48:51], v[136:139]
    ds_read_b64_tr_b16 v[24:25], v4 offset:8192
    v_mfma_f32_16x16x32_bf16 v[140:143], v[28:31], v[52:55], v[140:143]
    ds_read_b64_tr_b16 v[26:27], v4 offset:9216
    s_waitcnt lgkmcnt(10)
    v_mfma_f32_16x16x32_bf16 v[144:147], v[32:35], v[48:51], v[144:147]
    ds_read_b64_tr_b16 v[28:29], v5 offset:8192
    v_mfma_f32_16x16x32_bf16 v[148:151], v[32:35], v[52:55], v[148:151]
    ds_read_b64_tr_b16 v[30:31], v5 offset:9216
    v_mfma_f32_16x16x32_bf16 v[152:155], v[36:39], v[48:51], v[152:155]
    ds_read_b64_tr_b16 v[32:33], v6 offset:8192
    v_mfma_f32_16x16x32_bf16 v[156:159], v[36:39], v[52:55], v[156:159]
    ds_read_b64_tr_b16 v[34:35], v6 offset:9216
    s_waitcnt lgkmcnt(10)
    v_mfma_f32_16x16x32_bf16 v[160:163], v[40:43], v[48:51], v[160:163]
    ds_read_b64_tr_b16 v[36:37], v7 offset:8192
    v_mfma_f32_16x16x32_bf16 v[164:167], v[40:43], v[52:55], v[164:167]
    ds_read_b64_tr_b16 v[38:39], v7 offset:9216
    v_mfma_f32_16x16x32_bf16 v[168:171], v[44:47], v[48:51], v[168:171]
    ds_read_b64_tr_b16 v[40:41], v8 offset:8192
    v_mfma_f32_16x16x32_bf16 v[172:175], v[44:47], v[52:55], v[172:175]
    ds_read_b64_tr_b16 v[42:43], v8 offset:9216
    s_waitcnt vmcnt(12) lgkmcnt(10)
    v_mfma_f32_16x16x32_bf16 v[112:115], v[16:19], v[56:59], v[112:115]
    ds_read_b64_tr_b16 v[44:45], v9 offset:8192
    v_mfma_f32_16x16x32_bf16 v[116:119], v[16:19], v[60:63], v[116:119]
    ds_read_b64_tr_b16 v[46:47], v9 offset:9216
    v_mfma_f32_16x16x32_bf16 v[120:123], v[20:23], v[56:59], v[120:123]
    ds_read_b64_tr_b16 v[16:17], v2 offset:16384
    buffer_load_dwordx4 v[48:51], v1, s[20:23], s66 offen
    v_mfma_f32_16x16x32_bf16 v[124:127], v[20:23], v[60:63], v[124:127]
    ds_read_b64_tr_b16 v[18:19], v2 offset:17408
    s_waitcnt lgkmcnt(10)
    v_mfma_f32_16x16x32_bf16 v[128:131], v[24:27], v[56:59], v[128:131]
    ds_read_b64_tr_b16 v[20:21], v3 offset:16384
    buffer_load_dwordx4 v[52:55], v1, s[20:23], s66 offen offset:256
    v_mfma_f32_16x16x32_bf16 v[132:135], v[24:27], v[60:63], v[132:135]
    ds_read_b64_tr_b16 v[22:23], v3 offset:17408
    s_add_u32 s66, s66, 131072
    v_mfma_f32_16x16x32_bf16 v[136:139], v[28:31], v[56:59], v[136:139]
    ds_read_b64_tr_b16 v[24:25], v4 offset:16384
    v_mfma_f32_16x16x32_bf16 v[140:143], v[28:31], v[60:63], v[140:143]
    ds_read_b64_tr_b16 v[26:27], v4 offset:17408
    s_waitcnt lgkmcnt(10)
    v_mfma_f32_16x16x32_bf16 v[144:147], v[32:35], v[56:59], v[144:147]
    ds_read_b64_tr_b16 v[28:29], v5 offset:16384
    s_add_u32 s67, s67, s68
    v_mfma_f32_16x16x32_bf16 v[148:151], v[32:35], v[60:63], v[148:151]
    ds_read_b64_tr_b16 v[30:31], v5 offset:17408
    v_mfma_f32_16x16x32_bf16 v[152:155], v[36:39], v[56:59], v[152:155]
    ds_read_b64_tr_b16 v[32:33], v6 offset:16384
    v_mfma_f32_16x16x32_bf16 v[156:159], v[36:39], v[60:63], v[156:159]
    ds_read_b64_tr_b16 v[34:35], v6 offset:17408
    s_waitcnt lgkmcnt(10)
    v_mfma_f32_16x16x32_bf16 v[160:163], v[40:43], v[56:59], v[160:163]
    ds_read_b64_tr_b16 v[36:37], v7 offset:16384
    v_mfma_f32_16x16x32_bf16 v[164:167], v[40:43], v[60:63], v[164:167]
    ds_read_b64_tr_b16 v[38:39], v7 offset:17408
    v_mfma_f32_16x16x32_bf16 v[168:171], v[44:47], v[56:59], v[168:171]
    ds_read_b64_tr_b16 v[40:41], v8 offset:16384
    v_mfma_f32_16x16x32_bf16 v[172:175], v[44:47], v[60:63], v[172:175]
    ds_read_b64_tr_b16 v[42:43], v8 offset:17408
    s_waitcnt vmcnt(12) lgkmcnt(10)
    v_mfma_f32_16x16x32_bf16 v[112:115], v[16:19], v[64:67], v[112:115]
    ds_read_b64_tr_b16 v[44:45], v9 offset:16384
    v_mfma_f32_16x16x32_bf16 v[116:119], v[16:19], v[68:71], v[116:119]
    ds_read_b64_tr_b16 v[46:47], v9 offset:17408
    v_mfma_f32_16x16x32_bf16 v[120:123], v[20:23], v[64:67], v[120:123]
    ds_read_b64_tr_b16 v[16:17], v2 offset:24576
    buffer_load_dwordx4 v[56:59], v1, s[20:23], s66 offen
    v_mfma_f32_16x16x32_bf16 v[124:127], v[20:23], v[68:71], v[124:127]
    ds_read_b64_tr_b16 v[18:19], v2 offset:25600
    s_waitcnt lgkmcnt(10)
    v_mfma_f32_16x16x32_bf16 v[128:131], v[24:27], v[64:67], v[128:131]
    ds_read_b64_tr_b16 v[20:21], v3 offset:24576
    buffer_load_dwordx4 v[60:63], v1, s[20:23], s66 offen offset:256
    v_mfma_f32_16x16x32_bf16 v[132:135], v[24:27], v[68:71], v[132:135]
    ds_read_b64_tr_b16 v[22:23], v3 offset:25600
    s_add_u32 s66, s66, 131072
    v_mfma_f32_16x16x32_bf16 v[136:139], v[28:31], v[64:67], v[136:139]
    ds_read_b64_tr_b16 v[24:25], v4 offset:24576
    v_add_u32 v2, s68, v2
    v_mfma_f32_16x16x32_bf16 v[140:143], v[28:31], v[68:71], v[140:143]
    ds_read_b64_tr_b16 v[26:27], v4 offset:25600
    s_waitcnt lgkmcnt(10)
    v_mfma_f32_16x16x32_bf16 v[144:147], v[32:35], v[64:67], v[144:147]
    ds_read_b64_tr_b16 v[28:29], v5 offset:24576
    v_add_u32 v3, s68, v3
    v_mfma_f32_16x16x32_bf16 v[148:151], v[32:35], v[68:71], v[148:151]
    ds_read_b64_tr_b16 v[30:31], v5 offset:25600
    v_add_u32 v4, s68, v4
    v_mfma_f32_16x16x32_bf16 v[152:155], v[36:39], v[64:67], v[152:155]
    ds_read_b64_tr_b16 v[32:33], v6 offset:24576
    v_add_u32 v5, s68, v5
    v_mfma_f32_16x16x32_bf16 v[156:159], v[36:39], v[68:71], v[156:159]
    ds_read_b64_tr_b16 v[34:35], v6 offset:25600
    s_waitcnt lgkmcnt(10)
    v_mfma_f32_16x16x32_bf16 v[160:163], v[40:43], v[64:67], v[160:163]
    ds_read_b64_tr_b16 v[36:37], v7 offset:24576
    v_add_u32 v6, s68, v6
    v_mfma_f32_16x16x32_bf16 v[164:167], v[40:43], v[68:71], v[164:167]
    ds_read_b64_tr_b16 v[38:39], v7 offset:25600
    v_mfma_f32_16x16x32_bf16 v[168:171], v[44:47], v[64:67], v[168:171]
    ds_read_b64_tr_b16 v[40:41], v8 offset:24576
    v_add_u32 v7, s68, v7
    v_mfma_f32_16x16x32_bf16 v[172:175], v[44:47], v[68:71], v[172:175]
    ds_read_b64_tr_b16 v[42:43], v8 offset:25600
    s_waitcnt vmcnt(12) lgkmcnt(10)
    v_mfma_f32_16x16x32_bf16 v[112:115], v[16:19], v[72:75], v[112:115]
    ds_read_b64_tr_b16 v[44:45], v9 offset:24576
    v_mfma_f32_16x16x32_bf16 v[116:119], v[16:19], v[76:79], v[116:119]
    ds_read_b64_tr_b16 v[46:47], v9 offset:25600
    s_barrier
    v_mfma_f32_16x16x32_bf16 v[120:123], v[20:23], v[72:75], v[120:123]
    ds_read_b64_tr_b16 v[16:17], v2 offset:0
    buffer_load_dwordx4 v[64:67], v1, s[20:23], s66 offen
    v_mfma_f32_16x16x32_bf16 v[124:127], v[20:23], v[76:79], v[124:127]
    ds_read_b64_tr_b16 v[18:19], v2 offset:1024
    s_waitcnt lgkmcnt(10)
    v_mfma_f32_16x16x32_bf16 v[128:131], v[24:27], v[72:75], v[128:131]
    ds_read_b64_tr_b16 v[20:21], v3 offset:0
    buffer_load_dwordx4 v[68:71], v1, s[20:23], s66 offen offset:256
    v_mfma_f32_16x16x32_bf16 v[132:135], v[24:27], v[76:79], v[132:135]
    ds_read_b64_tr_b16 v[22:23], v3 offset:1024
    s_add_u32 s66, s66, 131072
    v_mfma_f32_16x16x32_bf16 v[136:139], v[28:31], v[72:75], v[136:139]
    ds_read_b64_tr_b16 v[24:25], v4 offset:0
    v_add_u32 v8, s68, v8
    v_mfma_f32_16x16x32_bf16 v[140:143], v[28:31], v[76:79], v[140:143]
    ds_read_b64_tr_b16 v[26:27], v4 offset:1024
    s_waitcnt lgkmcnt(10)
    v_mfma_f32_16x16x32_bf16 v[144:147], v[32:35], v[72:75], v[144:147]
    ds_read_b64_tr_b16 v[28:29], v5 offset:0
    v_add_u32 v9, s68, v9
    v_mfma_f32_16x16x32_bf16 v[148:151], v[32:35], v[76:79], v[148:151]
    ds_read_b64_tr_b16 v[30:31], v5 offset:1024
    v_mfma_f32_16x16x32_bf16 v[152:155], v[36:39], v[72:75], v[152:155]
    ds_read_b64_tr_b16 v[32:33], v6 offset:0
    v_mfma_f32_16x16x32_bf16 v[156:159], v[36:39], v[76:79], v[156:159]
    ds_read_b64_tr_b16 v[34:35], v6 offset:1024
    s_waitcnt lgkmcnt(10)
    v_mfma_f32_16x16x32_bf16 v[160:163], v[40:43], v[72:75], v[160:163]
    ds_read_b64_tr_b16 v[36:37], v7 offset:0
    v_mfma_f32_16x16x32_bf16 v[164:167], v[40:43], v[76:79], v[164:167]
    ds_read_b64_tr_b16 v[38:39], v7 offset:1024
    v_mfma_f32_16x16x32_bf16 v[168:171], v[44:47], v[72:75], v[168:171]
    ds_read_b64_tr_b16 v[40:41], v8 offset:0
    v_mfma_f32_16x16x32_bf16 v[172:175], v[44:47], v[76:79], v[172:175]
    ds_read_b64_tr_b16 v[42:43], v8 offset:1024
    s_waitcnt vmcnt(12) lgkmcnt(10)
    v_mfma_f32_16x16x32_bf16 v[112:115], v[16:19], v[80:83], v[112:115]
    ds_read_b64_tr_b16 v[44:45], v9 offset:0
    s_cmp_eq_u32 s67, 131072
    v_mfma_f32_16x16x32_bf16 v[116:119], v[16:19], v[84:87], v[116:119]
    ds_read_b64_tr_b16 v[46:47], v9 offset:1024
    s_cselect_b32 s68, s81, s80
    v_mfma_f32_16x16x32_bf16 v[120:123], v[20:23], v[80:83], v[120:123]
    ds_read_b64_tr_b16 v[16:17], v2 offset:8192
    buffer_load_dwordx4 v[72:75], v1, s[20:23], s66 offen
    v_mfma_f32_16x16x32_bf16 v[124:127], v[20:23], v[84:87], v[124:127]
    ds_read_b64_tr_b16 v[18:19], v2 offset:9216
    s_waitcnt lgkmcnt(10)
    v_mfma_f32_16x16x32_bf16 v[128:131], v[24:27], v[80:83], v[128:131]
    ds_read_b64_tr_b16 v[20:21], v3 offset:8192
    buffer_load_dwordx4 v[76:79], v1, s[20:23], s66 offen offset:256
    v_mfma_f32_16x16x32_bf16 v[132:135], v[24:27], v[84:87], v[132:135]
    ds_read_b64_tr_b16 v[22:23], v3 offset:9216
    s_add_u32 s66, s66, 131072
    v_mfma_f32_16x16x32_bf16 v[136:139], v[28:31], v[80:83], v[136:139]
    ds_read_b64_tr_b16 v[24:25], v4 offset:8192
    v_mfma_f32_16x16x32_bf16 v[140:143], v[28:31], v[84:87], v[140:143]
    ds_read_b64_tr_b16 v[26:27], v4 offset:9216
    s_waitcnt lgkmcnt(10)
    v_mfma_f32_16x16x32_bf16 v[144:147], v[32:35], v[80:83], v[144:147]
    ds_read_b64_tr_b16 v[28:29], v5 offset:8192
    v_mfma_f32_16x16x32_bf16 v[148:151], v[32:35], v[84:87], v[148:151]
    ds_read_b64_tr_b16 v[30:31], v5 offset:9216
    v_mfma_f32_16x16x32_bf16 v[152:155], v[36:39], v[80:83], v[152:155]
    ds_read_b64_tr_b16 v[32:33], v6 offset:8192
    v_mfma_f32_16x16x32_bf16 v[156:159], v[36:39], v[84:87], v[156:159]
    ds_read_b64_tr_b16 v[34:35], v6 offset:9216
    s_waitcnt lgkmcnt(10)
    v_mfma_f32_16x16x32_bf16 v[160:163], v[40:43], v[80:83], v[160:163]
    ds_read_b64_tr_b16 v[36:37], v7 offset:8192
    v_mfma_f32_16x16x32_bf16 v[164:167], v[40:43], v[84:87], v[164:167]
    ds_read_b64_tr_b16 v[38:39], v7 offset:9216
    v_mfma_f32_16x16x32_bf16 v[168:171], v[44:47], v[80:83], v[168:171]
    ds_read_b64_tr_b16 v[40:41], v8 offset:8192
    v_mfma_f32_16x16x32_bf16 v[172:175], v[44:47], v[84:87], v[172:175]
    ds_read_b64_tr_b16 v[42:43], v8 offset:9216
    s_waitcnt vmcnt(12) lgkmcnt(10)
    v_mfma_f32_16x16x32_bf16 v[112:115], v[16:19], v[88:91], v[112:115]
    ds_read_b64_tr_b16 v[44:45], v9 offset:8192
    v_mfma_f32_16x16x32_bf16 v[116:119], v[16:19], v[92:95], v[116:119]
    ds_read_b64_tr_b16 v[46:47], v9 offset:9216
    v_mfma_f32_16x16x32_bf16 v[120:123], v[20:23], v[88:91], v[120:123]
    ds_read_b64_tr_b16 v[16:17], v2 offset:16384
    buffer_load_dwordx4 v[80:83], v1, s[20:23], s66 offen
    v_mfma_f32_16x16x32_bf16 v[124:127], v[20:23], v[92:95], v[124:127]
    ds_read_b64_tr_b16 v[18:19], v2 offset:17408
    s_waitcnt lgkmcnt(10)
    v_mfma_f32_16x16x32_bf16 v[128:131], v[24:27], v[88:91], v[128:131]
    ds_read_b64_tr_b16 v[20:21], v3 offset:16384
    buffer_load_dwordx4 v[84:87], v1, s[20:23], s66 offen offset:256
    v_mfma_f32_16x16x32_bf16 v[132:135], v[24:27], v[92:95], v[132:135]
    ds_read_b64_tr_b16 v[22:23], v3 offset:17408
    s_add_u32 s66, s66, 131072
    v_mfma_f32_16x16x32_bf16 v[136:139], v[28:31], v[88:91], v[136:139]
    ds_read_b64_tr_b16 v[24:25], v4 offset:16384
    v_mfma_f32_16x16x32_bf16 v[140:143], v[28:31], v[92:95], v[140:143]
    ds_read_b64_tr_b16 v[26:27], v4 offset:17408
    s_waitcnt lgkmcnt(10)
    v_mfma_f32_16x16x32_bf16 v[144:147], v[32:35], v[88:91], v[144:147]
    ds_read_b64_tr_b16 v[28:29], v5 offset:16384
    s_add_u32 s67, s67, s68
    v_mfma_f32_16x16x32_bf16 v[148:151], v[32:35], v[92:95], v[148:151]
    ds_read_b64_tr_b16 v[30:31], v5 offset:17408
    v_mfma_f32_16x16x32_bf16 v[152:155], v[36:39], v[88:91], v[152:155]
    ds_read_b64_tr_b16 v[32:33], v6 offset:16384
    v_mfma_f32_16x16x32_bf16 v[156:159], v[36:39], v[92:95], v[156:159]
    ds_read_b64_tr_b16 v[34:35], v6 offset:17408
    s_waitcnt lgkmcnt(10)
    v_mfma_f32_16x16x32_bf16 v[160:163], v[40:43], v[88:91], v[160:163]
    ds_read_b64_tr_b16 v[36:37], v7 offset:16384
    v_mfma_f32_16x16x32_bf16 v[164:167], v[40:43], v[92:95], v[164:167]
    ds_read_b64_tr_b16 v[38:39], v7 offset:17408
    v_mfma_f32_16x16x32_bf16 v[168:171], v[44:47], v[88:91], v[168:171]
    ds_read_b64_tr_b16 v[40:41], v8 offset:16384
    v_mfma_f32_16x16x32_bf16 v[172:175], v[44:47], v[92:95], v[172:175]
    ds_read_b64_tr_b16 v[42:43], v8 offset:17408
    s_waitcnt vmcnt(12) lgkmcnt(10)
    v_mfma_f32_16x16x32_bf16 v[112:115], v[16:19], v[96:99], v[112:115]
    ds_read_b64_tr_b16 v[44:45], v9 offset:16384
    v_mfma_f32_16x16x32_bf16 v[116:119], v[16:19], v[100:103], v[116:119]
    ds_read_b64_tr_b16 v[46:47], v9 offset:17408
    v_mfma_f32_16x16x32_bf16 v[120:123], v[20:23], v[96:99], v[120:123]
    ds_read_b64_tr_b16 v[16:17], v2 offset:24576
    buffer_load_dwordx4 v[88:91], v1, s[20:23], s66 offen
    v_mfma_f32_16x16x32_bf16 v[124:127], v[20:23], v[100:103], v[124:127]
    ds_read_b64_tr_b16 v[18:19], v2 offset:25600
    s_waitcnt lgkmcnt(10)
    v_mfma_f32_16x16x32_bf16 v[128:131], v[24:27], v[96:99], v[128:131]
    ds_read_b64_tr_b16 v[20:21], v3 offset:24576
    buffer_load_dwordx4 v[92:95], v1, s[20:23], s66 offen offset:256
    v_mfma_f32_16x16x32_bf16 v[132:135], v[24:27], v[100:103], v[132:135]
    ds_read_b64_tr_b16 v[22:23], v3 offset:25600
    s_add_u32 s66, s66, 131072
    v_mfma_f32_16x16x32_bf16 v[136:139], v[28:31], v[96:99], v[136:139]
    ds_read_b64_tr_b16 v[24:25], v4 offset:24576
    v_add_u32 v2, s68, v2
    v_mfma_f32_16x16x32_bf16 v[140:143], v[28:31], v[100:103], v[140:143]
    ds_read_b64_tr_b16 v[26:27], v4 offset:25600
    s_waitcnt lgkmcnt(10)
    v_mfma_f32_16x16x32_bf16 v[144:147], v[32:35], v[96:99], v[144:147]
    ds_read_b64_tr_b16 v[28:29], v5 offset:24576
    v_add_u32 v3, s68, v3
    v_mfma_f32_16x16x32_bf16 v[148:151], v[32:35], v[100:103], v[148:151]
    ds_read_b64_tr_b16 v[30:31], v5 offset:25600
    v_add_u32 v4, s68, v4
    v_mfma_f32_16x16x32_bf16 v[152:155], v[36:39], v[96:99], v[152:155]
    ds_read_b64_tr_b16 v[32:33], v6 offset:24576
    v_add_u32 v5, s68, v5
    v_mfma_f32_16x16x32_bf16 v[156:159], v[36:39], v[100:103], v[156:159]
    ds_read_b64_tr_b16 v[34:35], v6 offset:25600
    s_waitcnt lgkmcnt(10)
    v_mfma_f32_16x16x32_bf16 v[160:163], v[40:43], v[96:99], v[160:163]
    ds_read_b64_tr_b16 v[36:37], v7 offset:24576
    v_add_u32 v6, s68, v6
    v_mfma_f32_16x16x32_bf16 v[164:167], v[40:43], v[100:103], v[164:167]
    ds_read_b64_tr_b16 v[38:39], v7 offset:25600
    v_mfma_f32_16x16x32_bf16 v[168:171], v[44:47], v[96:99], v[168:171]
    ds_read_b64_tr_b16 v[40:41], v8 offset:24576
    v_add_u32 v7, s68, v7
    v_mfma_f32_16x16x32_bf16 v[172:175], v[44:47], v[100:103], v[172:175]
    ds_read_b64_tr_b16 v[42:43], v8 offset:25600
    s_waitcnt vmcnt(12) lgkmcnt(10)
    v_mfma_f32_16x16x32_bf16 v[112:115], v[16:19], v[104:107], v[112:115]
    ds_read_b64_tr_b16 v[44:45], v9 offset:24576
    v_mfma_f32_16x16x32_bf16 v[116:119], v[16:19], v[108:111], v[116:119]
    ds_read_b64_tr_b16 v[46:47], v9 offset:25600
    s_barrier
    v_mfma_f32_16x16x32_bf16 v[120:123], v[20:23], v[104:107], v[120:123]
    ds_read_b64_tr_b16 v[16:17], v2 offset:0
    buffer_load_dwordx4 v[96:99], v1, s[20:23], s66 offen
    v_mfma_f32_16x16x32_bf16 v[124:127], v[20:23], v[108:111], v[124:127]
    ds_read_b64_tr_b16 v[18:19], v2 offset:1024
    s_waitcnt lgkmcnt(10)
    v_mfma_f32_16x16x32_bf16 v[128:131], v[24:27], v[104:107], v[128:131]
    ds_read_b64_tr_b16 v[20:21], v3 offset:0
    buffer_load_dwordx4 v[100:103], v1, s[20:23], s66 offen offset:256
    v_mfma_f32_16x16x32_bf16 v[132:135], v[24:27], v[108:111], v[132:135]
    ds_read_b64_tr_b16 v[22:23], v3 offset:1024
    s_add_u32 s66, s66, 131072
    v_mfma_f32_16x16x32_bf16 v[136:139], v[28:31], v[104:107], v[136:139]
    ds_read_b64_tr_b16 v[24:25], v4 offset:0
    v_add_u32 v8, s68, v8
    v_mfma_f32_16x16x32_bf16 v[140:143], v[28:31], v[108:111], v[140:143]
    ds_read_b64_tr_b16 v[26:27], v4 offset:1024
    s_waitcnt lgkmcnt(10)
    v_mfma_f32_16x16x32_bf16 v[144:147], v[32:35], v[104:107], v[144:147]
    ds_read_b64_tr_b16 v[28:29], v5 offset:0
    v_add_u32 v9, s68, v9
    v_mfma_f32_16x16x32_bf16 v[148:151], v[32:35], v[108:111], v[148:151]
    ds_read_b64_tr_b16 v[30:31], v5 offset:1024
    v_mfma_f32_16x16x32_bf16 v[152:155], v[36:39], v[104:107], v[152:155]
    ds_read_b64_tr_b16 v[32:33], v6 offset:0
    s_sub_u32 s69, s69, 1
    v_mfma_f32_16x16x32_bf16 v[156:159], v[36:39], v[108:111], v[156:159]
    ds_read_b64_tr_b16 v[34:35], v6 offset:1024
    s_waitcnt lgkmcnt(10)
    v_mfma_f32_16x16x32_bf16 v[160:163], v[40:43], v[104:107], v[160:163]
    ds_read_b64_tr_b16 v[36:37], v7 offset:0
    s_cmp_lg_u32 s69, 0
    v_mfma_f32_16x16x32_bf16 v[164:167], v[40:43], v[108:111], v[164:167]
    ds_read_b64_tr_b16 v[38:39], v7 offset:1024
    v_mfma_f32_16x16x32_bf16 v[168:171], v[44:47], v[104:107], v[168:171]
    ds_read_b64_tr_b16 v[40:41], v8 offset:0
    v_mfma_f32_16x16x32_bf16 v[172:175], v[44:47], v[108:111], v[172:175]
    ds_read_b64_tr_b16 v[42:43], v8 offset:1024
    s_cbranch_scc1 K3_CL_2
    s_waitcnt vmcnt(12) lgkmcnt(10)
    v_mfma_f32_16x16x32_bf16 v[112:115], v[16:19], v[48:51], v[112:115]
    ds_read_b64_tr_b16 v[44:45], v9 offset:0
    s_cmp_eq_u32 s67, 131072
    v_mfma_f32_16x16x32_bf16 v[116:119], v[16:19], v[52:55], v[116:119]
    ds_read_b64_tr_b16 v[46:47], v9 offset:1024
    s_cselect_b32 s68, s81, s80
    v_mfma_f32_16x16x32_bf16 v[120:123], v[20:23], v[48:51], v[120:123]
    ds_read_b64_tr_b16 v[16:17], v2 offset:8192
    buffer_load_dwordx4 v[104:107], v1, s[20:23], s66 offen
    v_mfma_f32_16x16x32_bf16 v[124:127], v[20:23], v[52:55], v[124:127]
    ds_read_b64_tr_b16 v[18:19], v2 offset:9216
    s_waitcnt lgkmcnt(10)
    v_mfma_f32_16x16x32_bf16 v[128:131], v[24:27], v[48:51], v[128:131]
    ds_read_b64_tr_b16 v[20:21], v3 offset:8192
    buffer_load_dwordx4 v[108:111], v1, s[20:23], s66 offen offset:256
    v_mfma_f32_16x16x32_bf16 v[132:135], v[24:27], v[52:55], v[132:135]
    ds_read_b64_tr_b16 v[22:23], v3 offset:9216
    s_add_u32 s66, s66, 131072
    v_mfma_f32_16x16x32_bf16 v[136:139], v[28:31], v[48:51], v[136:139]
    ds_read_b64_tr_b16 v[24:25], v4 offset:8192
    v_mfma_f32_16x16x32_bf16 v[140:143], v[28:31], v[52:55], v[140:143]
    ds_read_b64_tr_b16 v[26:27], v4 offset:9216
    s_waitcnt lgkmcnt(10)
    v_mfma_f32_16x16x32_bf16 v[144:147], v[32:35], v[48:51], v[144:147]
    ds_read_b64_tr_b16 v[28:29], v5 offset:8192
    v_mfma_f32_16x16x32_bf16 v[148:151], v[32:35], v[52:55], v[148:151]
    ds_read_b64_tr_b16 v[30:31], v5 offset:9216
    v_mfma_f32_16x16x32_bf16 v[152:155], v[36:39], v[48:51], v[152:155]
    ds_read_b64_tr_b16 v[32:33], v6 offset:8192
    v_mfma_f32_16x16x32_bf16 v[156:159], v[36:39], v[52:55], v[156:159]
    ds_read_b64_tr_b16 v[34:35], v6 offset:9216
    s_waitcnt lgkmcnt(10)
    v_mfma_f32_16x16x32_bf16 v[160:163], v[40:43], v[48:51], v[160:163]
    ds_read_b64_tr_b16 v[36:37], v7 offset:8192
    v_mfma_f32_16x16x32_bf16 v[164:167], v[40:43], v[52:55], v[164:167]
    ds_read_b64_tr_b16 v[38:39], v7 offset:9216
    v_mfma_f32_16x16x32_bf16 v[168:171], v[44:47], v[48:51], v[168:171]
    ds_read_b64_tr_b16 v[40:41], v8 offset:8192
    v_mfma_f32_16x16x32_bf16 v[172:175], v[44:47], v[52:55], v[172:175]
    ds_read_b64_tr_b16 v[42:43], v8 offset:9216
    s_waitcnt vmcnt(12) lgkmcnt(10)
    v_mfma_f32_16x16x32_bf16 v[112:115], v[16:19], v[56:59], v[112:115]
    ds_read_b64_tr_b16 v[44:45], v9 offset:8192
    v_mfma_f32_16x16x32_bf16 v[116:119], v[16:19], v[60:63], v[116:119]
    ds_read_b64_tr_b16 v[46:47], v9 offset:9216
    v_mfma_f32_16x16x32_bf16 v[120:123], v[20:23], v[56:59], v[120:123]
    ds_read_b64_tr_b16 v[16:17], v2 offset:16384
    buffer_load_dwordx4 v[48:51], v1, s[20:23], s66 offen
    v_mfma_f32_16x16x32_bf16 v[124:127], v[20:23], v[60:63], v[124:127]
    ds_read_b64_tr_b16 v[18:19], v2 offset:17408
    s_waitcnt lgkmcnt(10)
    v_mfma_f32_16x16x32_bf16 v[128:131], v[24:27], v[56:59], v[128:131]
    ds_read_b64_tr_b16 v[20:21], v3 offset:16384
    buffer_load_dwordx4 v[52:55], v1, s[20:23], s66 offen offset:256
    v_mfma_f32_16x16x32_bf16 v[132:135], v[24:27], v[60:63], v[132:135]
    ds_read_b64_tr_b16 v[22:23], v3 offset:17408
    s_add_u32 s66, s66, 131072
    v_mfma_f32_16x16x32_bf16 v[136:139], v[28:31], v[56:59], v[136:139]
    ds_read_b64_tr_b16 v[24:25], v4 offset:16384
    v_mfma_f32_16x16x32_bf16 v[140:143], v[28:31], v[60:63], v[140:143]
    ds_read_b64_tr_b16 v[26:27], v4 offset:17408
    s_waitcnt lgkmcnt(10)
    v_mfma_f32_16x16x32_bf16 v[144:147], v[32:35], v[56:59], v[144:147]
    ds_read_b64_tr_b16 v[28:29], v5 offset:16384
    s_add_u32 s67, s67, s68
    v_mfma_f32_16x16x32_bf16 v[148:151], v[32:35], v[60:63], v[148:151]
    ds_read_b64_tr_b16 v[30:31], v5 offset:17408
    v_mfma_f32_16x16x32_bf16 v[152:155], v[36:39], v[56:59], v[152:155]
    ds_read_b64_tr_b16 v[32:33], v6 offset:16384
    v_mfma_f32_16x16x32_bf16 v[156:159], v[36:39], v[60:63], v[156:159]
    ds_read_b64_tr_b16 v[34:35], v6 offset:17408
    s_waitcnt lgkmcnt(10)
    v_mfma_f32_16x16x32_bf16 v[160:163], v[40:43], v[56:59], v[160:163]
    ds_read_b64_tr_b16 v[36:37], v7 offset:16384
    v_mfma_f32_16x16x32_bf16 v[164:167], v[40:43], v[60:63], v[164:167]
    ds_read_b64_tr_b16 v[38:39], v7 offset:17408
    v_mfma_f32_16x16x32_bf16 v[168:171], v[44:47], v[56:59], v[168:171]
    ds_read_b64_tr_b16 v[40:41], v8 offset:16384
    v_mfma_f32_16x16x32_bf16 v[172:175], v[44:47], v[60:63], v[172:175]
    ds_read_b64_tr_b16 v[42:43], v8 offset:17408
    s_waitcnt vmcnt(12) lgkmcnt(10)
    v_mfma_f32_16x16x32_bf16 v[112:115], v[16:19], v[64:67], v[112:115]
    ds_read_b64_tr_b16 v[44:45], v9 offset:16384
    v_mfma_f32_16x16x32_bf16 v[116:119], v[16:19], v[68:71], v[116:119]
    ds_read_b64_tr_b16 v[46:47], v9 offset:17408
    v_mfma_f32_16x16x32_bf16 v[120:123], v[20:23], v[64:67], v[120:123]
    ds_read_b64_tr_b16 v[16:17], v2 offset:24576
    buffer_load_dwordx4 v[56:59], v1, s[20:23], s66 offen
    v_mfma_f32_16x16x32_bf16 v[124:127], v[20:23], v[68:71], v[124:127]
    ds_read_b64_tr_b16 v[18:19], v2 offset:25600
    s_waitcnt lgkmcnt(10)
    v_mfma_f32_16x16x32_bf16 v[128:131], v[24:27], v[64:67], v[128:131]
    ds_read_b64_tr_b16 v[20:21], v3 offset:24576
    buffer_load_dwordx4 v[60:63], v1, s[20:23], s66 offen offset:256
    v_mfma_f32_16x16x32_bf16 v[132:135], v[24:27], v[68:71], v[132:135]
    ds_read_b64_tr_b16 v[22:23], v3 offset:25600
    s_add_u32 s66, s66, 131072
    v_mfma_f32_16x16x32_bf16 v[136:139], v[28:31], v[64:67], v[136:139]
    ds_read_b64_tr_b16 v[24:25], v4 offset:24576
    v_add_u32 v2, s68, v2
    v_mfma_f32_16x16x32_bf16 v[140:143], v[28:31], v[68:71], v[140:143]
    ds_read_b64_tr_b16 v[26:27], v4 offset:25600
    s_waitcnt lgkmcnt(10)
    v_mfma_f32_16x16x32_bf16 v[144:147], v[32:35], v[64:67], v[144:147]
    ds_read_b64_tr_b16 v[28:29], v5 offset:24576
    v_add_u32 v3, s68, v3
    v_mfma_f32_16x16x32_bf16 v[148:151], v[32:35], v[68:71], v[148:151]
    ds_read_b64_tr_b16 v[30:31], v5 offset:25600
    v_add_u32 v4, s68, v4
    v_mfma_f32_16x16x32_bf16 v[152:155], v[36:39], v[64:67], v[152:155]
    ds_read_b64_tr_b16 v[32:33], v6 offset:24576
    v_add_u32 v5, s68, v5
    v_mfma_f32_16x16x32_bf16 v[156:159], v[36:39], v[68:71], v[156:159]
    ds_read_b64_tr_b16 v[34:35], v6 offset:25600
    s_waitcnt lgkmcnt(10)
    v_mfma_f32_16x16x32_bf16 v[160:163], v[40:43], v[64:67], v[160:163]
    ds_read_b64_tr_b16 v[36:37], v7 offset:24576
    v_add_u32 v6, s68, v6
    v_mfma_f32_16x16x32_bf16 v[164:167], v[40:43], v[68:71], v[164:167]
    ds_read_b64_tr_b16 v[38:39], v7 offset:25600
    v_mfma_f32_16x16x32_bf16 v[168:171], v[44:47], v[64:67], v[168:171]
    ds_read_b64_tr_b16 v[40:41], v8 offset:24576
    v_add_u32 v7, s68, v7
    v_mfma_f32_16x16x32_bf16 v[172:175], v[44:47], v[68:71], v[172:175]
    ds_read_b64_tr_b16 v[42:43], v8 offset:25600
    s_waitcnt vmcnt(12) lgkmcnt(10)
    v_mfma_f32_16x16x32_bf16 v[112:115], v[16:19], v[72:75], v[112:115]
    ds_read_b64_tr_b16 v[44:45], v9 offset:24576
    v_mfma_f32_16x16x32_bf16 v[116:119], v[16:19], v[76:79], v[116:119]
    ds_read_b64_tr_b16 v[46:47], v9 offset:25600
    s_barrier
    v_mfma_f32_16x16x32_bf16 v[120:123], v[20:23], v[72:75], v[120:123]
    ds_read_b64_tr_b16 v[16:17], v2 offset:0
    buffer_load_dwordx4 v[64:67], v1, s[20:23], s66 offen
    v_mfma_f32_16x16x32_bf16 v[124:127], v[20:23], v[76:79], v[124:127]
    ds_read_b64_tr_b16 v[18:19], v2 offset:1024
    s_waitcnt lgkmcnt(10)
    v_mfma_f32_16x16x32_bf16 v[128:131], v[24:27], v[72:75], v[128:131]
    ds_read_b64_tr_b16 v[20:21], v3 offset:0
    buffer_load_dwordx4 v[68:71], v1, s[20:23], s66 offen offset:256
    v_mfma_f32_16x16x32_bf16 v[132:135], v[24:27], v[76:79], v[132:135]
    ds_read_b64_tr_b16 v[22:23], v3 offset:1024
    s_add_u32 s66, s66, 131072
    v_mfma_f32_16x16x32_bf16 v[136:139], v[28:31], v[72:75], v[136:139]
    ds_read_b64_tr_b16 v[24:25], v4 offset:0
    v_add_u32 v8, s68, v8
    v_mfma_f32_16x16x32_bf16 v[140:143], v[28:31], v[76:79], v[140:143]
    ds_read_b64_tr_b16 v[26:27], v4 offset:1024
    s_waitcnt lgkmcnt(10)
    v_mfma_f32_16x16x32_bf16 v[144:147], v[32:35], v[72:75], v[144:147]
    ds_read_b64_tr_b16 v[28:29], v5 offset:0
    v_add_u32 v9, s68, v9
    v_mfma_f32_16x16x32_bf16 v[148:151], v[32:35], v[76:79], v[148:151]
    ds_read_b64_tr_b16 v[30:31], v5 offset:1024
    v_mfma_f32_16x16x32_bf16 v[152:155], v[36:39], v[72:75], v[152:155]
    ds_read_b64_tr_b16 v[32:33], v6 offset:0
    v_mfma_f32_16x16x32_bf16 v[156:159], v[36:39], v[76:79], v[156:159]
    ds_read_b64_tr_b16 v[34:35], v6 offset:1024
    s_waitcnt lgkmcnt(10)
    v_mfma_f32_16x16x32_bf16 v[160:163], v[40:43], v[72:75], v[160:163]
    ds_read_b64_tr_b16 v[36:37], v7 offset:0
    v_mfma_f32_16x16x32_bf16 v[164:167], v[40:43], v[76:79], v[164:167]
    ds_read_b64_tr_b16 v[38:39], v7 offset:1024
    v_mfma_f32_16x16x32_bf16 v[168:171], v[44:47], v[72:75], v[168:171]
    ds_read_b64_tr_b16 v[40:41], v8 offset:0
    v_mfma_f32_16x16x32_bf16 v[172:175], v[44:47], v[76:79], v[172:175]
    ds_read_b64_tr_b16 v[42:43], v8 offset:1024
    s_waitcnt vmcnt(12) lgkmcnt(10)
    v_mfma_f32_16x16x32_bf16 v[112:115], v[16:19], v[80:83], v[112:115]
    ds_read_b64_tr_b16 v[44:45], v9 offset:0
    s_cmp_eq_u32 s67, 131072
    v_mfma_f32_16x16x32_bf16 v[116:119], v[16:19], v[84:87], v[116:119]
    ds_read_b64_tr_b16 v[46:47], v9 offset:1024
    s_cselect_b32 s68, s81, s80
    v_mfma_f32_16x16x32_bf16 v[120:123], v[20:23], v[80:83], v[120:123]
    ds_read_b64_tr_b16 v[16:17], v2 offset:8192
    buffer_load_dwordx4 v[72:75], v1, s[20:23], s66 offen
    v_mfma_f32_16x16x32_bf16 v[124:127], v[20:23], v[84:87], v[124:127]
    ds_read_b64_tr_b16 v[18:19], v2 offset:9216
    s_waitcnt lgkmcnt(10)
    v_mfma_f32_16x16x32_bf16 v[128:131], v[24:27], v[80:83], v[128:131]
    ds_read_b64_tr_b16 v[20:21], v3 offset:8192
    buffer_load_dwordx4 v[76:79], v1, s[20:23], s66 offen offset:256
    v_mfma_f32_16x16x32_bf16 v[132:135], v[24:27], v[84:87], v[132:135]
    ds_read_b64_tr_b16 v[22:23], v3 offset:9216
    s_add_u32 s66, s66, 131072
    v_mfma_f32_16x16x32_bf16 v[136:139], v[28:31], v[80:83], v[136:139]
    ds_read_b64_tr_b16 v[24:25], v4 offset:8192
    v_mfma_f32_16x16x32_bf16 v[140:143], v[28:31], v[84:87], v[140:143]
    ds_read_b64_tr_b16 v[26:27], v4 offset:9216
    s_waitcnt lgkmcnt(10)
    v_mfma_f32_16x16x32_bf16 v[144:147], v[32:35], v[80:83], v[144:147]
    ds_read_b64_tr_b16 v[28:29], v5 offset:8192
    v_mfma_f32_16x16x32_bf16 v[148:151], v[32:35], v[84:87], v[148:151]
    ds_read_b64_tr_b16 v[30:31], v5 offset:9216
    v_mfma_f32_16x16x32_bf16 v[152:155], v[36:39], v[80:83], v[152:155]
    ds_read_b64_tr_b16 v[32:33], v6 offset:8192
    v_mfma_f32_16x16x32_bf16 v[156:159], v[36:39], v[84:87], v[156:159]
    ds_read_b64_tr_b16 v[34:35], v6 offset:9216
    s_waitcnt lgkmcnt(10)
    v_mfma_f32_16x16x32_bf16 v[160:163], v[40:43], v[80:83], v[160:163]
    ds_read_b64_tr_b16 v[36:37], v7 offset:8192
    v_mfma_f32_16x16x32_bf16 v[164:167], v[40:43], v[84:87], v[164:167]
    ds_read_b64_tr_b16 v[38:39], v7 offset:9216
    v_mfma_f32_16x16x32_bf16 v[168:171], v[44:47], v[80:83], v[168:171]
    ds_read_b64_tr_b16 v[40:41], v8 offset:8192
    v_mfma_f32_16x16x32_bf16 v[172:175], v[44:47], v[84:87], v[172:175]
    ds_read_b64_tr_b16 v[42:43], v8 offset:9216
    s_waitcnt vmcnt(12) lgkmcnt(10)
    v_mfma_f32_16x16x32_bf16 v[112:115], v[16:19], v[88:91], v[112:115]
    ds_read_b64_tr_b16 v[44:45], v9 offset:8192
    v_mfma_f32_16x16x32_bf16 v[116:119], v[16:19], v[92:95], v[116:119]
    ds_read_b64_tr_b16 v[46:47], v9 offset:9216
    v_mfma_f32_16x16x32_bf16 v[120:123], v[20:23], v[88:91], v[120:123]
    ds_read_b64_tr_b16 v[16:17], v2 offset:16384
    buffer_load_dwordx4 v[80:83], v1, s[20:23], s66 offen
    v_mfma_f32_16x16x32_bf16 v[124:127], v[20:23], v[92:95], v[124:127]
    ds_read_b64_tr_b16 v[18:19], v2 offset:17408
    s_waitcnt lgkmcnt(10)
    v_mfma_f32_16x16x32_bf16 v[128:131], v[24:27], v[88:91], v[128:131]
    ds_read_b64_tr_b16 v[20:21], v3 offset:16384
    buffer_load_dwordx4 v[84:87], v1, s[20:23], s66 offen offset:256
    v_mfma_f32_16x16x32_bf16 v[132:135], v[24:27], v[92:95], v[132:135]
    ds_read_b64_tr_b16 v[22:23], v3 offset:17408
    s_add_u32 s66, s66, 131072
    v_mfma_f32_16x16x32_bf16 v[136:139], v[28:31], v[88:91], v[136:139]
    ds_read_b64_tr_b16 v[24:25], v4 offset:16384
    v_mfma_f32_16x16x32_bf16 v[140:143], v[28:31], v[92:95], v[140:143]
    ds_read_b64_tr_b16 v[26:27], v4 offset:17408
    s_waitcnt lgkmcnt(10)
    v_mfma_f32_16x16x32_bf16 v[144:147], v[32:35], v[88:91], v[144:147]
    ds_read_b64_tr_b16 v[28:29], v5 offset:16384
    s_add_u32 s67, s67, s68
    v_mfma_f32_16x16x32_bf16 v[148:151], v[32:35], v[92:95], v[148:151]
    ds_read_b64_tr_b16 v[30:31], v5 offset:17408
    v_mfma_f32_16x16x32_bf16 v[152:155], v[36:39], v[88:91], v[152:155]
    ds_read_b64_tr_b16 v[32:33], v6 offset:16384
    v_mfma_f32_16x16x32_bf16 v[156:159], v[36:39], v[92:95], v[156:159]
    ds_read_b64_tr_b16 v[34:35], v6 offset:17408
    s_waitcnt lgkmcnt(10)
    v_mfma_f32_16x16x32_bf16 v[160:163], v[40:43], v[88:91], v[160:163]
    ds_read_b64_tr_b16 v[36:37], v7 offset:16384
    v_mfma_f32_16x16x32_bf16 v[164:167], v[40:43], v[92:95], v[164:167]
    ds_read_b64_tr_b16 v[38:39], v7 offset:17408
    v_mfma_f32_16x16x32_bf16 v[168:171], v[44:47], v[88:91], v[168:171]
    ds_read_b64_tr_b16 v[40:41], v8 offset:16384
    v_mfma_f32_16x16x32_bf16 v[172:175], v[44:47], v[92:95], v[172:175]
    ds_read_b64_tr_b16 v[42:43], v8 offset:17408
    s_waitcnt vmcnt(12) lgkmcnt(10)
    v_mfma_f32_16x16x32_bf16 v[112:115], v[16:19], v[96:99], v[112:115]
    ds_read_b64_tr_b16 v[44:45], v9 offset:16384
    v_mfma_f32_16x16x32_bf16 v[116:119], v[16:19], v[100:103], v[116:119]
    ds_read_b64_tr_b16 v[46:47], v9 offset:17408
    v_mfma_f32_16x16x32_bf16 v[120:123], v[20:23], v[96:99], v[120:123]
    ds_read_b64_tr_b16 v[16:17], v2 offset:24576
    buffer_load_dwordx4 v[88:91], v1, s[20:23], s66 offen
    v_mfma_f32_16x16x32_bf16 v[124:127], v[20:23], v[100:103], v[124:127]
    ds_read_b64_tr_b16 v[18:19], v2 offset:25600
    s_waitcnt lgkmcnt(10)
    v_mfma_f32_16x16x32_bf16 v[128:131], v[24:27], v[96:99], v[128:131]
    ds_read_b64_tr_b16 v[20:21], v3 offset:24576
    buffer_load_dwordx4 v[92:95], v1, s[20:23], s66 offen offset:256
    v_mfma_f32_16x16x32_bf16 v[132:135], v[24:27], v[100:103], v[132:135]
    ds_read_b64_tr_b16 v[22:23], v3 offset:25600
    s_add_u32 s66, s66, 131072
    v_mfma_f32_16x16x32_bf16 v[136:139], v[28:31], v[96:99], v[136:139]
    ds_read_b64_tr_b16 v[24:25], v4 offset:24576
    v_mfma_f32_16x16x32_bf16 v[140:143], v[28:31], v[100:103], v[140:143]
    ds_read_b64_tr_b16 v[26:27], v4 offset:25600
    s_waitcnt lgkmcnt(10)
    v_mfma_f32_16x16x32_bf16 v[144:147], v[32:35], v[96:99], v[144:147]
    ds_read_b64_tr_b16 v[28:29], v5 offset:24576
    v_add_u32 v10, s67, v10
    v_mfma_f32_16x16x32_bf16 v[148:151], v[32:35], v[100:103], v[148:151]
    ds_read_b64_tr_b16 v[30:31], v5 offset:25600
    v_add_u32 v11, s67, v11
    v_mfma_f32_16x16x32_bf16 v[152:155], v[36:39], v[96:99], v[152:155]
    ds_read_b64_tr_b16 v[32:33], v6 offset:24576
    v_add_u32 v12, s67, v12
    v_mfma_f32_16x16x32_bf16 v[156:159], v[36:39], v[100:103], v[156:159]
    ds_read_b64_tr_b16 v[34:35], v6 offset:25600
    s_waitcnt lgkmcnt(10)
    v_mfma_f32_16x16x32_bf16 v[160:163], v[40:43], v[96:99], v[160:163]
    ds_read_b64_tr_b16 v[36:37], v7 offset:24576
    v_add_u32 v13, s67, v13
    v_mfma_f32_16x16x32_bf16 v[164:167], v[40:43], v[100:103], v[164:167]
    ds_read_b64_tr_b16 v[38:39], v7 offset:25600
    v_mfma_f32_16x16x32_bf16 v[168:171], v[44:47], v[96:99], v[168:171]
    ds_read_b64_tr_b16 v[40:41], v8 offset:24576
    v_mfma_f32_16x16x32_bf16 v[172:175], v[44:47], v[100:103], v[172:175]
    ds_read_b64_tr_b16 v[42:43], v8 offset:25600
    s_waitcnt vmcnt(12) lgkmcnt(10)
    v_mfma_f32_16x16x32_bf16 v[112:115], v[16:19], v[104:107], v[112:115]
    ds_read_b64_tr_b16 v[44:45], v9 offset:24576
    v_mfma_f32_16x16x32_bf16 v[116:119], v[16:19], v[108:111], v[116:119]
    ds_read_b64_tr_b16 v[46:47], v9 offset:25600
    s_barrier
    v_mfma_f32_16x16x32_bf16 v[120:123], v[20:23], v[104:107], v[120:123]
    ds_read_b128 v[16:19], v10 offset:16384
    buffer_load_dwordx4 v[96:99], v1, s[20:23], s66 offen
    v_mfma_f32_16x16x32_bf16 v[124:127], v[20:23], v[108:111], v[124:127]
    s_waitcnt lgkmcnt(9)
    v_mfma_f32_16x16x32_bf16 v[128:131], v[24:27], v[104:107], v[128:131]
    ds_read_b128 v[20:23], v10 offset:20480
    buffer_load_dwordx4 v[100:103], v1, s[20:23], s66 offen offset:256
    v_mfma_f32_16x16x32_bf16 v[132:135], v[24:27], v[108:111], v[132:135]
    s_add_u32 s66, s66, 131072
    v_mfma_f32_16x16x32_bf16 v[136:139], v[28:31], v[104:107], v[136:139]
    ds_read_b128 v[24:27], v10 offset:24576
    v_mfma_f32_16x16x32_bf16 v[140:143], v[28:31], v[108:111], v[140:143]
    s_waitcnt lgkmcnt(7)
    v_mfma_f32_16x16x32_bf16 v[144:147], v[32:35], v[104:107], v[144:147]
    ds_read_b128 v[28:31], v10 offset:28672
    v_mfma_f32_16x16x32_bf16 v[148:151], v[32:35], v[108:111], v[148:151]
    v_mfma_f32_16x16x32_bf16 v[152:155], v[36:39], v[104:107], v[152:155]
    ds_read_b128 v[32:35], v10 offset:0
    v_mfma_f32_16x16x32_bf16 v[156:159], v[36:39], v[108:111], v[156:159]
    s_waitcnt lgkmcnt(5)
    v_mfma_f32_16x16x32_bf16 v[160:163], v[40:43], v[104:107], v[160:163]
    ds_read_b128 v[36:39], v10 offset:4096
    v_mfma_f32_16x16x32_bf16 v[164:167], v[40:43], v[108:111], v[164:167]
    v_mfma_f32_16x16x32_bf16 v[168:171], v[44:47], v[104:107], v[168:171]
    ds_read_b128 v[40:43], v10 offset:8192
    v_mfma_f32_16x16x32_bf16 v[172:175], v[44:47], v[108:111], v[172:175]
    s_mov_b32 s69, 7
K3_CL_3:
    s_waitcnt vmcnt(12) lgkmcnt(5)
    v_mfma_f32_16x16x32_bf16 v[112:115], v[16:19], v[48:51], v[112:115]
    ds_read_b128 v[44:47], v10 offset:12288
    s_cmp_eq_u32 s67, 131072
    v_mfma_f32_16x16x32_bf16 v[116:119], v[16:19], v[52:55], v[116:119]
    s_cselect_b32 s68, s81, s80
    v_mfma_f32_16x16x32_bf16 v[120:123], v[20:23], v[48:51], v[120:123]
    ds_read_b128 v[16:19], v11 offset:16384
    buffer_load_dwordx4 v[104:107], v1, s[20:23], s66 offen
    v_mfma_f32_16x16x32_bf16 v[124:127], v[20:23], v[52:55], v[124:127]
    s_waitcnt lgkmcnt(5)
    v_mfma_f32_16x16x32_bf16 v[128:131], v[24:27], v[48:51], v[128:131]
    ds_read_b128 v[20:23], v11 offset:20480
    buffer_load_dwordx4 v[108:111], v1, s[20:23], s66 offen offset:256
    v_mfma_f32_16x16x32_bf16 v[132:135], v[24:27], v[52:55], v[132:135]
    s_add_u32 s66, s66, 131072
    v_mfma_f32_16x16x32_bf16 v[136:139], v[28:31], v[48:51], v[136:139]
    ds_read_b128 v[24:27], v11 offset:24576
    v_mfma_f32_16x16x32_bf16 v[140:143], v[28:31], v[52:55], v[140:143]
    s_waitcnt lgkmcnt(5)
    v_mfma_f32_16x16x32_bf16 v[144:147], v[32:35], v[48:51], v[144:147]
    ds_read_b128 v[28:31], v11 offset:28672
    v_add_u32 v10, s68, v10
    v_mfma_f32_16x16x32_bf16 v[148:151], v[32:35], v[52:55], v[148:151]
    v_mfma_f32_16x16x32_bf16 v[152:155], v[36:39], v[48:51], v[152:155]
    ds_read_b128 v[32:35], v11 offset:0
    v_mfma_f32_16x16x32_bf16 v[156:159], v[36:39], v[52:55], v[156:159]
    s_waitcnt lgkmcnt(5)
    v_mfma_f32_16x16x32_bf16 v[160:163], v[40:43], v[48:51], v[160:163]
    ds_read_b128 v[36:39], v11 offset:4096
    v_mfma_f32_16x16x32_bf16 v[164:167], v[40:43], v[52:55], v[164:167]
    v_mfma_f32_16x16x32_bf16 v[168:171], v[44:47], v[48:51], v[168:171]
    ds_read_b128 v[40:43], v11 offset:8192
    v_mfma_f32_16x16x32_bf16 v[172:175], v[44:47], v[52:55], v[172:175]
    s_waitcnt vmcnt(12) lgkmcnt(5)
    v_mfma_f32_16x16x32_bf16 v[112:115], v[16:19], v[56:59], v[112:115]
    ds_read_b128 v[44:47], v11 offset:12288
    v_mfma_f32_16x16x32_bf16 v[116:119], v[16:19], v[60:63], v[116:119]
    v_mfma_f32_16x16x32_bf16 v[120:123], v[20:23], v[56:59], v[120:123]
    ds_read_b128 v[16:19], v12 offset:16384
    buffer_load_dwordx4 v[48:51], v1, s[20:23], s66 offen
    v_mfma_f32_16x16x32_bf16 v[124:127], v[20:23], v[60:63], v[124:127]
    s_waitcnt lgkmcnt(5)
    v_mfma_f32_16x16x32_bf16 v[128:131], v[24:27], v[56:59], v[128:131]
    ds_read_b128 v[20:23], v12 offset:20480
    buffer_load_dwordx4 v[52:55], v1, s[20:23], s66 offen offset:256
    v_mfma_f32_16x16x32_bf16 v[132:135], v[24:27], v[60:63], v[132:135]
    s_add_u32 s66, s66, 131072
    v_mfma_f32_16x16x32_bf16 v[136:139], v[28:31], v[56:59], v[136:139]
    ds_read_b128 v[24:27], v12 offset:24576
    v_mfma_f32_16x16x32_bf16 v[140:143], v[28:31], v[60:63], v[140:143]
    s_waitcnt lgkmcnt(5)
    v_mfma_f32_16x16x32_bf16 v[144:147], v[32:35], v[56:59], v[144:147]
    ds_read_b128 v[28:31], v12 offset:28672
    s_add_u32 s67, s67, s68
    v_add_u32 v11, s68, v11
    v_mfma_f32_16x16x32_bf16 v[148:151], v[32:35], v[60:63], v[148:151]
    v_mfma_f32_16x16x32_bf16 v[152:155], v[36:39], v[56:59], v[152:155]
    ds_read_b128 v[32:35], v12 offset:0
    v_mfma_f32_16x16x32_bf16 v[156:159], v[36:39], v[60:63], v[156:159]
    s_waitcnt lgkmcnt(5)
    v_mfma_f32_16x16x32_bf16 v[160:163], v[40:43], v[56:59], v[160:163]
    ds_read_b128 v[36:39], v12 offset:4096
    v_mfma_f32_16x16x32_bf16 v[164:167], v[40:43], v[60:63], v[164:167]
    v_mfma_f32_16x16x32_bf16 v[168:171], v[44:47], v[56:59], v[168:171]
    ds_read_b128 v[40:43], v12 offset:8192
    v_mfma_f32_16x16x32_bf16 v[172:175], v[44:47], v[60:63], v[172:175]
    s_waitcnt vmcnt(12) lgkmcnt(5)
    v_mfma_f32_16x16x32_bf16 v[112:115], v[16:19], v[64:67], v[112:115]
    ds_read_b128 v[44:47], v12 offset:12288
    v_mfma_f32_16x16x32_bf16 v[116:119], v[16:19], v[68:71], v[116:119]
    v_mfma_f32_16x16x32_bf16 v[120:123], v[20:23], v[64:67], v[120:123]
    ds_read_b128 v[16:19], v13 offset:16384
    buffer_load_dwordx4 v[56:59], v1, s[20:23], s66 offen
    v_mfma_f32_16x16x32_bf16 v[124:127], v[20:23], v[68:71], v[124:127]
    s_waitcnt lgkmcnt(5)
    v_mfma_f32_16x16x32_bf16 v[128:131], v[24:27], v[64:67], v[128:131]
    ds_read_b128 v[20:23], v13 offset:20480
    buffer_load_dwordx4 v[60:63], v1, s[20:23], s66 offen offset:256
    v_mfma_f32_16x16x32_bf16 v[132:135], v[24:27], v[68:71], v[132:135]
    s_add_u32 s66, s66, 131072
    v_mfma_f32_16x16x32_bf16 v[136:139], v[28:31], v[64:67], v[136:139]
    ds_read_b128 v[24:27], v13 offset:24576
    v_mfma_f32_16x16x32_bf16 v[140:143], v[28:31], v[68:71], v[140:143]
    s_waitcnt lgkmcnt(5)
    v_mfma_f32_16x16x32_bf16 v[144:147], v[32:35], v[64:67], v[144:147]
    ds_read_b128 v[28:31], v13 offset:28672
    v_add_u32 v12, s68, v12
    v_mfma_f32_16x16x32_bf16 v[148:151], v[32:35], v[68:71], v[148:151]
    v_mfma_f32_16x16x32_bf16 v[152:155], v[36:39], v[64:67], v[152:155]
    ds_read_b128 v[32:35], v13 offset:0
    v_mfma_f32_16x16x32_bf16 v[156:159], v[36:39], v[68:71], v[156:159]
    s_waitcnt lgkmcnt(5)
    v_mfma_f32_16x16x32_bf16 v[160:163], v[40:43], v[64:67], v[160:163]
    ds_read_b128 v[36:39], v13 offset:4096
    v_mfma_f32_16x16x32_bf16 v[164:167], v[40:43], v[68:71], v[164:167]
    v_mfma_f32_16x16x32_bf16 v[168:171], v[44:47], v[64:67], v[168:171]
    ds_read_b128 v[40:43], v13 offset:8192
    v_mfma_f32_16x16x32_bf16 v[172:175], v[44:47], v[68:71], v[172:175]
    s_waitcnt vmcnt(12) lgkmcnt(5)
    v_mfma_f32_16x16x32_bf16 v[112:115], v[16:19], v[72:75], v[112:115]
    ds_read_b128 v[44:47], v13 offset:12288
    v_mfma_f32_16x16x32_bf16 v[116:119], v[16:19], v[76:79], v[116:119]
    s_barrier
    v_mfma_f32_16x16x32_bf16 v[120:123], v[20:23], v[72:75], v[120:123]
    ds_read_b128 v[16:19], v10 offset:16384
    buffer_load_dwordx4 v[64:67], v1, s[20:23], s66 offen
    v_mfma_f32_16x16x32_bf16 v[124:127], v[20:23], v[76:79], v[124:127]
    s_waitcnt lgkmcnt(5)
    v_mfma_f32_16x16x32_bf16 v[128:131], v[24:27], v[72:75], v[128:131]
    ds_read_b128 v[20:23], v10 offset:20480
    buffer_load_dwordx4 v[68:71], v1, s[20:23], s66 offen offset:256
    v_mfma_f32_16x16x32_bf16 v[132:135], v[24:27], v[76:79], v[132:135]
    s_add_u32 s66, s66, 131072
    v_mfma_f32_16x16x32_bf16 v[136:139], v[28:31], v[72:75], v[136:139]
    ds_read_b128 v[24:27], v10 offset:24576
    v_mfma_f32_16x16x32_bf16 v[140:143], v[28:31], v[76:79], v[140:143]
    s_waitcnt lgkmcnt(5)
    v_mfma_f32_16x16x32_bf16 v[144:147], v[32:35], v[72:75], v[144:147]
    ds_read_b128 v[28:31], v10 offset:28672
    v_add_u32 v13, s68, v13
    v_mfma_f32_16x16x32_bf16 v[148:151], v[32:35], v[76:79], v[148:151]
    v_mfma_f32_16x16x32_bf16 v[152:155], v[36:39], v[72:75], v[152:155]
    ds_read_b128 v[32:35], v10 offset:0
    v_mfma_f32_16x16x32_bf16 v[156:159], v[36:39], v[76:79], v[156:159]
    s_waitcnt lgkmcnt(5)
    v_mfma_f32_16x16x32_bf16 v[160:163], v[40:43], v[72:75], v[160:163]
    ds_read_b128 v[36:39], v10 offset:4096
    v_mfma_f32_16x16x32_bf16 v[164:167], v[40:43], v[76:79], v[164:167]
    v_mfma_f32_16x16x32_bf16 v[168:171], v[44:47], v[72:75], v[168:171]
    ds_read_b128 v[40:43], v10 offset:8192
    v_mfma_f32_16x16x32_bf16 v[172:175], v[44:47], v[76:79], v[172:175]
    s_waitcnt vmcnt(12) lgkmcnt(5)
    v_mfma_f32_16x16x32_bf16 v[112:115], v[16:19], v[80:83], v[112:115]
    ds_read_b128 v[44:47], v10 offset:12288
    s_cmp_eq_u32 s67, 131072
    v_mfma_f32_16x16x32_bf16 v[116:119], v[16:19], v[84:87], v[116:119]
    s_cselect_b32 s68, s81, s80
    v_mfma_f32_16x16x32_bf16 v[120:123], v[20:23], v[80:83], v[120:123]
    ds_read_b128 v[16:19], v11 offset:16384
    buffer_load_dwordx4 v[72:75], v1, s[20:23], s66 offen
    v_mfma_f32_16x16x32_bf16 v[124:127], v[20:23], v[84:87], v[124:127]
    s_waitcnt lgkmcnt(5)
    v_mfma_f32_16x16x32_bf16 v[128:131], v[24:27], v[80:83], v[128:131]
    ds_read_b128 v[20:23], v11 offset:20480
    buffer_load_dwordx4 v[76:79], v1, s[20:23], s66 offen offset:256
    v_mfma_f32_16x16x32_bf16 v[132:135], v[24:27], v[84:87], v[132:135]
    s_add_u32 s66, s66, 131072
    v_mfma_f32_16x16x32_bf16 v[136:139], v[28:31], v[80:83], v[136:139]
    ds_read_b128 v[24:27], v11 offset:24576
    v_mfma_f32_16x16x32_bf16 v[140:143], v[28:31], v[84:87], v[140:143]
    s_waitcnt lgkmcnt(5)
    v_mfma_f32_16x16x32_bf16 v[144:147], v[32:35], v[80:83], v[144:147]
    ds_read_b128 v[28:31], v11 offset:28672
    v_add_u32 v10, s68, v10
    v_mfma_f32_16x16x32_bf16 v[148:151], v[32:35], v[84:87], v[148:151]
    v_mfma_f32_16x16x32_bf16 v[152:155], v[36:39], v[80:83], v[152:155]
    ds_read_b128 v[32:35], v11 offset:0
    v_mfma_f32_16x16x32_bf16 v[156:159], v[36:39], v[84:87], v[156:159]
    s_waitcnt lgkmcnt(5)
    v_mfma_f32_16x16x32_bf16 v[160:163], v[40:43], v[80:83], v[160:163]
    ds_read_b128 v[36:39], v11 offset:4096
    v_mfma_f32_16x16x32_bf16 v[164:167], v[40:43], v[84:87], v[164:167]
    v_mfma_f32_16x16x32_bf16 v[168:171], v[44:47], v[80:83], v[168:171]
    ds_read_b128 v[40:43], v11 offset:8192
    v_mfma_f32_16x16x32_bf16 v[172:175], v[44:47], v[84:87], v[172:175]
    s_waitcnt vmcnt(12) lgkmcnt(5)
    v_mfma_f32_16x16x32_bf16 v[112:115], v[16:19], v[88:91], v[112:115]
    ds_read_b128 v[44:47], v11 offset:12288
    v_mfma_f32_16x16x32_bf16 v[116:119], v[16:19], v[92:95], v[116:119]
    v_mfma_f32_16x16x32_bf16 v[120:123], v[20:23], v[88:91], v[120:123]
    ds_read_b128 v[16:19], v12 offset:16384
    buffer_load_dwordx4 v[80:83], v1, s[20:23], s66 offen
    v_mfma_f32_16x16x32_bf16 v[124:127], v[20:23], v[92:95], v[124:127]
    s_waitcnt lgkmcnt(5)
    v_mfma_f32_16x16x32_bf16 v[128:131], v[24:27], v[88:91], v[128:131]
    ds_read_b128 v[20:23], v12 offset:20480
    buffer_load_dwordx4 v[84:87], v1, s[20:23], s66 offen offset:256
    v_mfma_f32_16x16x32_bf16 v[132:135], v[24:27], v[92:95], v[132:135]
    s_add_u32 s66, s66, 131072
    v_mfma_f32_16x16x32_bf16 v[136:139], v[28:31], v[88:91], v[136:139]
    ds_read_b128 v[24:27], v12 offset:24576
    v_mfma_f32_16x16x32_bf16 v[140:143], v[28:31], v[92:95], v[140:143]
    s_waitcnt lgkmcnt(5)
    v_mfma_f32_16x16x32_bf16 v[144:147], v[32:35], v[88:91], v[144:147]
    ds_read_b128 v[28:31], v12 offset:28672
    s_add_u32 s67, s67, s68
    v_add_u32 v11, s68, v11
    v_mfma_f32_16x16x32_bf16 v[148:151], v[32:35], v[92:95], v[148:151]
    v_mfma_f32_16x16x32_bf16 v[152:155], v[36:39], v[88:91], v[152:155]
    ds_read_b128 v[32:35], v12 offset:0
    v_mfma_f32_16x16x32_bf16 v[156:159], v[36:39], v[92:95], v[156:159]
    s_waitcnt lgkmcnt(5)
    v_mfma_f32_16x16x32_bf16 v[160:163], v[40:43], v[88:91], v[160:163]
    ds_read_b128 v[36:39], v12 offset:4096
    v_mfma_f32_16x16x32_bf16 v[164:167], v[40:43], v[92:95], v[164:167]
    v_mfma_f32_16x16x32_bf16 v[168:171], v[44:47], v[88:91], v[168:171]
    ds_read_b128 v[40:43], v12 offset:8192
    v_mfma_f32_16x16x32_bf16 v[172:175], v[44:47], v[92:95], v[172:175]
    s_waitcnt vmcnt(12) lgkmcnt(5)
    v_mfma_f32_16x16x32_bf16 v[112:115], v[16:19], v[96:99], v[112:115]
    ds_read_b128 v[44:47], v12 offset:12288
    v_mfma_f32_16x16x32_bf16 v[116:119], v[16:19], v[100:103], v[116:119]
    v_mfma_f32_16x16x32_bf16 v[120:123], v[20:23], v[96:99], v[120:123]
    ds_read_b128 v[16:19], v13 offset:16384
    buffer_load_dwordx4 v[88:91], v1, s[20:23], s66 offen
    v_mfma_f32_16x16x32_bf16 v[124:127], v[20:23], v[100:103], v[124:127]
    s_waitcnt lgkmcnt(5)
    v_mfma_f32_16x16x32_bf16 v[128:131], v[24:27], v[96:99], v[128:131]
    ds_read_b128 v[20:23], v13 offset:20480
    buffer_load_dwordx4 v[92:95], v1, s[20:23], s66 offen offset:256
    v_mfma_f32_16x16x32_bf16 v[132:135], v[24:27], v[100:103], v[132:135]
    s_add_u32 s66, s66, 131072
    v_mfma_f32_16x16x32_bf16 v[136:139], v[28:31], v[96:99], v[136:139]
    ds_read_b128 v[24:27], v13 offset:24576
    v_mfma_f32_16x16x32_bf16 v[140:143], v[28:31], v[100:103], v[140:143]
    s_waitcnt lgkmcnt(5)
    v_mfma_f32_16x16x32_bf16 v[144:147], v[32:35], v[96:99], v[144:147]
    ds_read_b128 v[28:31], v13 offset:28672
    v_add_u32 v12, s68, v12
    v_mfma_f32_16x16x32_bf16 v[148:151], v[32:35], v[100:103], v[148:151]
    v_mfma_f32_16x16x32_bf16 v[152:155], v[36:39], v[96:99], v[152:155]
    ds_read_b128 v[32:35], v13 offset:0
    v_mfma_f32_16x16x32_bf16 v[156:159], v[36:39], v[100:103], v[156:159]
    s_waitcnt lgkmcnt(5)
    v_mfma_f32_16x16x32_bf16 v[160:163], v[40:43], v[96:99], v[160:163]
    ds_read_b128 v[36:39], v13 offset:4096
    v_mfma_f32_16x16x32_bf16 v[164:167], v[40:43], v[100:103], v[164:167]
    v_mfma_f32_16x16x32_bf16 v[168:171], v[44:47], v[96:99], v[168:171]
    ds_read_b128 v[40:43], v13 offset:8192
    v_mfma_f32_16x16x32_bf16 v[172:175], v[44:47], v[100:103], v[172:175]
    s_waitcnt vmcnt(12) lgkmcnt(5)
    v_mfma_f32_16x16x32_bf16 v[112:115], v[16:19], v[104:107], v[112:115]
    ds_read_b128 v[44:47], v13 offset:12288
    v_mfma_f32_16x16x32_bf16 v[116:119], v[16:19], v[108:111], v[116:119]
    s_barrier
    v_mfma_f32_16x16x32_bf16 v[120:123], v[20:23], v[104:107], v[120:123]
    ds_read_b128 v[16:19], v10 offset:16384
    buffer_load_dwordx4 v[96:99], v1, s[20:23], s66 offen
    v_mfma_f32_16x16x32_bf16 v[124:127], v[20:23], v[108:111], v[124:127]
    s_waitcnt lgkmcnt(5)
    v_mfma_f32_16x16x32_bf16 v[128:131], v[24:27], v[104:107], v[128:131]
    ds_read_b128 v[20:23], v10 offset:20480
    buffer_load_dwordx4 v[100:103], v1, s[20:23], s66 offen offset:256
    v_mfma_f32_16x16x32_bf16 v[132:135], v[24:27], v[108:111], v[132:135]
    s_add_u32 s66, s66, 131072
    v_mfma_f32_16x16x32_bf16 v[136:139], v[28:31], v[104:107], v[136:139]
    ds_read_b128 v[24:27], v10 offset:24576
    v_mfma_f32_16x16x32_bf16 v[140:143], v[28:31], v[108:111], v[140:143]
    s_waitcnt lgkmcnt(5)
    v_mfma_f32_16x16x32_bf16 v[144:147], v[32:35], v[104:107], v[144:147]
    ds_read_b128 v[28:31], v10 offset:28672
    v_add_u32 v13, s68, v13
    v_mfma_f32_16x16x32_bf16 v[148:151], v[32:35], v[108:111], v[148:151]
    v_mfma_f32_16x16x32_bf16 v[152:155], v[36:39], v[104:107], v[152:155]
    ds_read_b128 v[32:35], v10 offset:0
    s_sub_u32 s69, s69, 1
    v_mfma_f32_16x16x32_bf16 v[156:159], v[36:39], v[108:111], v[156:159]
    s_waitcnt lgkmcnt(5)
    v_mfma_f32_16x16x32_bf16 v[160:163], v[40:43], v[104:107], v[160:163]
    ds_read_b128 v[36:39], v10 offset:4096
    s_cmp_lg_u32 s69, 0
    v_mfma_f32_16x16x32_bf16 v[164:167], v[40:43], v[108:111], v[164:167]
    v_mfma_f32_16x16x32_bf16 v[168:171], v[44:47], v[104:107], v[168:171]
    ds_read_b128 v[40:43], v10 offset:8192
    v_mfma_f32_16x16x32_bf16 v[172:175], v[44:47], v[108:111], v[172:175]
    s_cbranch_scc1 K3_CL_3
    s_waitcnt vmcnt(12) lgkmcnt(5)
    v_mfma_f32_16x16x32_bf16 v[112:115], v[16:19], v[48:51], v[112:115]
    ds_read_b128 v[44:47], v10 offset:12288
    v_mfma_f32_16x16x32_bf16 v[116:119], v[16:19], v[52:55], v[116:119]
    v_mfma_f32_16x16x32_bf16 v[120:123], v[20:23], v[48:51], v[120:123]
    ds_read_b128 v[16:19], v11 offset:0
    buffer_load_dwordx4 v[104:107], v1, s[20:23], s66 offen
    v_mfma_f32_16x16x32_bf16 v[124:127], v[20:23], v[52:55], v[124:127]
    s_waitcnt lgkmcnt(5)
    v_mfma_f32_16x16x32_bf16 v[128:131], v[24:27], v[48:51], v[128:131]
    ds_read_b128 v[20:23], v11 offset:4096
    buffer_load_dwordx4 v[108:111], v1, s[20:23], s66 offen offset:256
    v_mfma_f32_16x16x32_bf16 v[132:135], v[24:27], v[52:55], v[132:135]
    v_mfma_f32_16x16x32_bf16 v[136:139], v[28:31], v[48:51], v[136:139]
    ds_read_b128 v[24:27], v11 offset:8192
    v_mfma_f32_16x16x32_bf16 v[140:143], v[28:31], v[52:55], v[140:143]
    s_waitcnt lgkmcnt(5)
    v_mfma_f32_16x16x32_bf16 v[144:147], v[32:35], v[48:51], v[144:147]
    ds_read_b128 v[28:31], v11 offset:12288
    v_mfma_f32_16x16x32_bf16 v[148:151], v[32:35], v[52:55], v[148:151]
    v_mfma_f32_16x16x32_bf16 v[152:155], v[36:39], v[48:51], v[152:155]
    ds_read_b128 v[32:35], v12 offset:0
    v_mfma_f32_16x16x32_bf16 v[156:159], v[36:39], v[52:55], v[156:159]
    s_waitcnt lgkmcnt(5)
    v_mfma_f32_16x16x32_bf16 v[160:163], v[40:43], v[48:51], v[160:163]
    ds_read_b128 v[36:39], v12 offset:4096
    v_mfma_f32_16x16x32_bf16 v[164:167], v[40:43], v[52:55], v[164:167]
    v_mfma_f32_16x16x32_bf16 v[168:171], v[44:47], v[48:51], v[168:171]
    ds_read_b128 v[40:43], v12 offset:8192
    v_mfma_f32_16x16x32_bf16 v[172:175], v[44:47], v[52:55], v[172:175]
    s_waitcnt vmcnt(12) lgkmcnt(5)
    v_mfma_f32_16x16x32_bf16 v[144:147], v[16:19], v[56:59], v[144:147]
    ds_read_b128 v[44:47], v12 offset:12288
    v_mfma_f32_16x16x32_bf16 v[148:151], v[16:19], v[60:63], v[148:151]
    v_mfma_f32_16x16x32_bf16 v[152:155], v[20:23], v[56:59], v[152:155]
    ds_read_b128 v[16:19], v13 offset:0
    v_mfma_f32_16x16x32_bf16 v[156:159], v[20:23], v[60:63], v[156:159]
    s_waitcnt lgkmcnt(5)
    v_mfma_f32_16x16x32_bf16 v[160:163], v[24:27], v[56:59], v[160:163]
    ds_read_b128 v[20:23], v13 offset:4096
    v_mfma_f32_16x16x32_bf16 v[164:167], v[24:27], v[60:63], v[164:167]
    v_mfma_f32_16x16x32_bf16 v[168:171], v[28:31], v[56:59], v[168:171]
    ds_read_b128 v[24:27], v13 offset:8192
    v_mfma_f32_16x16x32_bf16 v[172:175], v[28:31], v[60:63], v[172:175]
    s_waitcnt vmcnt(10) lgkmcnt(5)
    v_mfma_f32_16x16x32_bf16 v[144:147], v[32:35], v[64:67], v[144:147]
    ds_read_b128 v[28:31], v13 offset:12288
    v_mfma_f32_16x16x32_bf16 v[148:151], v[32:35], v[68:71], v[148:151]
    s_barrier
    v_mfma_f32_16x16x32_bf16 v[152:155], v[36:39], v[64:67], v[152:155]
    ds_read_b128 v[32:35], v10 offset:32768
    v_mfma_f32_16x16x32_bf16 v[156:159], v[36:39], v[68:71], v[156:159]
    s_waitcnt lgkmcnt(5)
    v_mfma_f32_16x16x32_bf16 v[160:163], v[40:43], v[64:67], v[160:163]
    ds_read_b128 v[36:39], v10 offset:36864
    v_mfma_f32_16x16x32_bf16 v[164:167], v[40:43], v[68:71], v[164:167]
    v_mfma_f32_16x16x32_bf16 v[168:171], v[44:47], v[64:67], v[168:171]
    ds_read_b128 v[40:43], v10 offset:40960
    v_mfma_f32_16x16x32_bf16 v[172:175], v[44:47], v[68:71], v[172:175]
    s_waitcnt vmcnt(8) lgkmcnt(5)
    v_mfma_f32_16x16x32_bf16 v[144:147], v[16:19], v[72:75], v[144:147]
    ds_read_b128 v[44:47], v10 offset:45056
    v_mfma_f32_16x16x32_bf16 v[148:151], v[16:19], v[76:79], v[148:151]
    v_mfma_f32_16x16x32_bf16 v[152:155], v[20:23], v[72:75], v[152:155]
    ds_read_b128 v[16:19], v11 offset:32768
    v_mfma_f32_16x16x32_bf16 v[156:159], v[20:23], v[76:79], v[156:159]
    s_waitcnt lgkmcnt(5)
    v_mfma_f32_16x16x32_bf16 v[160:163], v[24:27], v[72:75], v[160:163]
    ds_read_b128 v[20:23], v11 offset:36864
    v_mfma_f32_16x16x32_bf16 v[164:167], v[24:27], v[76:79], v[164:167]
    v_mfma_f32_16x16x32_bf16 v[168:171], v[28:31], v[72:75], v[168:171]
    ds_read_b128 v[24:27], v11 offset:40960
    v_mfma_f32_16x16x32_bf16 v[172:175], v[28:31], v[76:79], v[172:175]
    s_waitcnt vmcnt(6) lgkmcnt(5)
    v_mfma_f32_16x16x32_bf16 v[144:147], v[32:35], v[80:83], v[144:147]
    ds_read_b128 v[28:31], v11 offset:45056
    v_mfma_f32_16x16x32_bf16 v[148:151], v[32:35], v[84:87], v[148:151]
    v_mfma_f32_16x16x32_bf16 v[152:155], v[36:39], v[80:83], v[152:155]
    ds_read_b128 v[32:35], v12 offset:32768
    v_mfma_f32_16x16x32_bf16 v[156:159], v[36:39], v[84:87], v[156:159]
    s_waitcnt lgkmcnt(5)
    v_mfma_f32_16x16x32_bf16 v[160:163], v[40:43], v[80:83], v[160:163]
    ds_read_b128 v[36:39], v12 offset:36864
    v_mfma_f32_16x16x32_bf16 v[164:167], v[40:43], v[84:87], v[164:167]
    v_mfma_f32_16x16x32_bf16 v[168:171], v[44:47], v[80:83], v[168:171]
    ds_read_b128 v[40:43], v12 offset:40960
    v_mfma_f32_16x16x32_bf16 v[172:175], v[44:47], v[84:87], v[172:175]
    s_waitcnt vmcnt(4) lgkmcnt(5)
    v_mfma_f32_16x16x32_bf16 v[144:147], v[16:19], v[88:91], v[144:147]
    ds_read_b128 v[44:47], v12 offset:45056
    v_mfma_f32_16x16x32_bf16 v[148:151], v[16:19], v[92:95], v[148:151]
    v_mfma_f32_16x16x32_bf16 v[152:155], v[20:23], v[88:91], v[152:155]
    ds_read_b128 v[16:19], v13 offset:32768
    v_mfma_f32_16x16x32_bf16 v[156:159], v[20:23], v[92:95], v[156:159]
    s_waitcnt lgkmcnt(5)
    v_mfma_f32_16x16x32_bf16 v[160:163], v[24:27], v[88:91], v[160:163]
    ds_read_b128 v[20:23], v13 offset:36864
    v_mfma_f32_16x16x32_bf16 v[164:167], v[24:27], v[92:95], v[164:167]
    v_mfma_f32_16x16x32_bf16 v[168:171], v[28:31], v[88:91], v[168:171]
    ds_read_b128 v[24:27], v13 offset:40960
    v_mfma_f32_16x16x32_bf16 v[172:175], v[28:31], v[92:95], v[172:175]
    s_waitcnt vmcnt(2) lgkmcnt(5)
    v_mfma_f32_16x16x32_bf16 v[144:147], v[32:35], v[96:99], v[144:147]
    ds_read_b128 v[28:31], v13 offset:45056
    v_mfma_f32_16x16x32_bf16 v[148:151], v[32:35], v[100:103], v[148:151]
    v_mfma_f32_16x16x32_bf16 v[152:155], v[36:39], v[96:99], v[152:155]
    ds_read_b128 v[32:35], v11 offset:16384
    v_mfma_f32_16x16x32_bf16 v[156:159], v[36:39], v[100:103], v[156:159]
    s_waitcnt lgkmcnt(5)
    v_mfma_f32_16x16x32_bf16 v[160:163], v[40:43], v[96:99], v[160:163]
    ds_read_b128 v[36:39], v11 offset:20480
    v_mfma_f32_16x16x32_bf16 v[164:167], v[40:43], v[100:103], v[164:167]
    v_mfma_f32_16x16x32_bf16 v[168:171], v[44:47], v[96:99], v[168:171]
    ds_read_b128 v[40:43], v11 offset:24576
    v_mfma_f32_16x16x32_bf16 v[172:175], v[44:47], v[100:103], v[172:175]
    s_waitcnt vmcnt(0) lgkmcnt(5)
    v_mfma_f32_16x16x32_bf16 v[144:147], v[16:19], v[104:107], v[144:147]
    ds_read_b128 v[44:47], v11 offset:28672
    v_mfma_f32_16x16x32_bf16 v[148:151], v[16:19], v[108:111], v[148:151]
    v_mfma_f32_16x16x32_bf16 v[152:155], v[20:23], v[104:107], v[152:155]
    ds_read_b128 v[16:19], v12 offset:16384
    v_mfma_f32_16x16x32_bf16 v[156:159], v[20:23], v[108:111], v[156:159]
    s_waitcnt lgkmcnt(5)
    v_mfma_f32_16x16x32_bf16 v[160:163], v[24:27], v[104:107], v[160:163]
    ds_read_b128 v[20:23], v12 offset:20480
    v_mfma_f32_16x16x32_bf16 v[164:167], v[24:27], v[108:111], v[164:167]
    v_mfma_f32_16x16x32_bf16 v[168:171], v[28:31], v[104:107], v[168:171]
    ds_read_b128 v[24:27], v12 offset:24576
    v_mfma_f32_16x16x32_bf16 v[172:175], v[28:31], v[108:111], v[172:175]
    s_waitcnt lgkmcnt(5)
    v_mfma_f32_16x16x32_bf16 v[112:115], v[32:35], v[56:59], v[112:115]
    ds_read_b128 v[28:31], v12 offset:28672
    v_mfma_f32_16x16x32_bf16 v[116:119], v[32:35], v[60:63], v[116:119]
    v_mfma_f32_16x16x32_bf16 v[120:123], v[36:39], v[56:59], v[120:123]
    ds_read_b128 v[32:35], v13 offset:16384
    v_mfma_f32_16x16x32_bf16 v[124:127], v[36:39], v[60:63], v[124:127]
    s_waitcnt lgkmcnt(5)
    v_mfma_f32_16x16x32_bf16 v[128:131], v[40:43], v[56:59], v[128:131]
    ds_read_b128 v[36:39], v13 offset:20480
    v_mfma_f32_16x16x32_bf16 v[132:135], v[40:43], v[60:63], v[132:135]
    v_mfma_f32_16x16x32_bf16 v[136:139], v[44:47], v[56:59], v[136:139]
    ds_read_b128 v[40:43], v13 offset:24576
    v_cvt_pk_bf16_f32 v144, v144, v145
    v_cvt_pk_bf16_f32 v145, v146, v147
    v_cvt_pk_bf16_f32 v146, v148, v149
    v_cvt_pk_bf16_f32 v147, v150, v151
    v_mfma_f32_16x16x32_bf16 v[140:143], v[44:47], v[60:63], v[140:143]
    v_min_u32 v144, s75, v144
    v_min_u32 v145, s75, v145
    v_min_u32 v146, s75, v146
    v_min_u32 v147, s75, v147
    s_waitcnt lgkmcnt(5)
    v_mfma_f32_16x16x32_bf16 v[112:115], v[16:19], v[64:67], v[112:115]
    ds_read_b128 v[44:47], v13 offset:28672
    v_cvt_pk_bf16_f32 v152, v152, v153
    v_cvt_pk_bf16_f32 v153, v154, v155
    v_cvt_pk_bf16_f32 v154, v156, v157
    v_cvt_pk_bf16_f32 v155, v158, v159
    v_mfma_f32_16x16x32_bf16 v[116:119], v[16:19], v[68:71], v[116:119]
    v_min_u32 v152, s75, v152
    v_min_u32 v153, s75, v153
    v_min_u32 v154, s75, v154
    v_mfma_f32_16x16x32_bf16 v[120:123], v[20:23], v[64:67], v[120:123]
    ds_read_b128 v[16:19], v10 offset:49152
    v_min_u32 v155, s75, v155
    v_mov_b32 v220, v144
    v_mov_b32 v221, v145
    v_mov_b32 v222, v146
    v_mfma_f32_16x16x32_bf16 v[124:127], v[20:23], v[68:71], v[124:127]
    v_mov_b32 v223, v147
    v_mov_b32_dpp v144, v152 row_ror:8 row_mask:0xf bank_mask:0xc
    v_mov_b32_dpp v145, v153 row_ror:8 row_mask:0xf bank_mask:0xc
    v_mov_b32_dpp v146, v154 row_ror:8 row_mask:0xf bank_mask:0xc
    s_waitcnt lgkmcnt(5)
    v_mfma_f32_16x16x32_bf16 v[128:131], v[24:27], v[64:67], v[128:131]
    ds_read_b128 v[20:23], v10 offset:53248
    v_mov_b32_dpp v147, v155 row_ror:8 row_mask:0xf bank_mask:0xc
    v_mov_b32_dpp v152, v220 row_ror:8 row_mask:0xf bank_mask:0x3
    v_mov_b32_dpp v153, v221 row_ror:8 row_mask:0xf bank_mask:0x3
    v_mov_b32_dpp v154, v222 row_ror:8 row_mask:0xf bank_mask:0x3
    v_mfma_f32_16x16x32_bf16 v[132:135], v[24:27], v[68:71], v[132:135]
    v_mov_b32_dpp v155, v223 row_ror:8 row_mask:0xf bank_mask:0x3
    buffer_store_dwordx4 v[144:147], v15, s[36:39], s72 offen offset:0 sc1
    buffer_store_dwordx4 v[152:155], v15, s[36:39], s72 offen offset:1024 sc1
    v_mfma_f32_16x16x32_bf16 v[136:139], v[28:31], v[64:67], v[136:139]
    ds_read_b128 v[24:27], v10 offset:57344
    v_cvt_pk_bf16_f32 v160, v160, v161
    v_cvt_pk_bf16_f32 v161, v162, v163
    v_cvt_pk_bf16_f32 v162, v164, v165
    v_cvt_pk_bf16_f32 v163, v166, v167
    v_mfma_f32_16x16x32_bf16 v[140:143], v[28:31], v[68:71], v[140:143]
    v_min_u32 v160, s75, v160
    v_min_u32 v161, s75, v161
    v_min_u32 v162, s75, v162
    v_min_u32 v163, s75, v163
    s_waitcnt lgkmcnt(5)
    v_mfma_f32_16x16x32_bf16 v[112:115], v[32:35], v[72:75], v[112:115]
    ds_read_b128 v[28:31], v10 offset:61440
    v_cvt_pk_bf16_f32 v168, v168, v169
    v_cvt_pk_bf16_f32 v169, v170, v171
    v_cvt_pk_bf16_f32 v170, v172, v173
    v_cvt_pk_bf16_f32 v171, v174, v175
    v_mfma_f32_16x16x32_bf16 v[116:119], v[32:35], v[76:79], v[116:119]
    v_min_u32 v168, s75, v168
    v_min_u32 v169, s75, v169
    v_min_u32 v170, s75, v170
    v_mfma_f32_16x16x32_bf16 v[120:123], v[36:39], v[72:75], v[120:123]
    ds_read_b128 v[32:35], v11 offset:49152
    v_min_u32 v171, s75, v171
    v_mov_b32 v220, v160
    v_mov_b32 v221, v161
    v_mov_b32 v222, v162
    v_mfma_f32_16x16x32_bf16 v[124:127], v[36:39], v[76:79], v[124:127]
    v_mov_b32 v223, v163
    v_mov_b32_dpp v160, v168 row_ror:8 row_mask:0xf bank_mask:0xc
    v_mov_b32_dpp v161, v169 row_ror:8 row_mask:0xf bank_mask:0xc
    v_mov_b32_dpp v162, v170 row_ror:8 row_mask:0xf bank_mask:0xc
    s_waitcnt lgkmcnt(5)
    v_mfma_f32_16x16x32_bf16 v[128:131], v[40:43], v[72:75], v[128:131]
    ds_read_b128 v[36:39], v11 offset:53248
    v_mov_b32_dpp v163, v171 row_ror:8 row_mask:0xf bank_mask:0xc
    v_mov_b32_dpp v168, v220 row_ror:8 row_mask:0xf bank_mask:0x3
    v_mov_b32_dpp v169, v221 row_ror:8 row_mask:0xf bank_mask:0x3
    v_mov_b32_dpp v170, v222 row_ror:8 row_mask:0xf bank_mask:0x3
    v_mfma_f32_16x16x32_bf16 v[132:135], v[40:43], v[76:79], v[132:135]
    v_mov_b32_dpp v171, v223 row_ror:8 row_mask:0xf bank_mask:0x3
    buffer_store_dwordx4 v[160:163], v15, s[36:39], s72 offen offset:2048 sc1
    buffer_store_dwordx4 v[168:171], v15, s[36:39], s72 offen offset:3072 sc1
    v_mfma_f32_16x16x32_bf16 v[136:139], v[44:47], v[72:75], v[136:139]
    ds_read_b128 v[40:43], v11 offset:57344
    v_mfma_f32_16x16x32_bf16 v[140:143], v[44:47], v[76:79], v[140:143]
    s_waitcnt lgkmcnt(5)
    v_mfma_f32_16x16x32_bf16 v[112:115], v[16:19], v[80:83], v[112:115]
    ds_read_b128 v[44:47], v11 offset:61440
    v_mfma_f32_16x16x32_bf16 v[116:119], v[16:19], v[84:87], v[116:119]
    v_mfma_f32_16x16x32_bf16 v[120:123], v[20:23], v[80:83], v[120:123]
    ds_read_b128 v[16:19], v12 offset:49152
    v_mfma_f32_16x16x32_bf16 v[124:127], v[20:23], v[84:87], v[124:127]
    s_waitcnt lgkmcnt(5)
    v_mfma_f32_16x16x32_bf16 v[128:131], v[24:27], v[80:83], v[128:131]
    ds_read_b128 v[20:23], v12 offset:53248
    v_mfma_f32_16x16x32_bf16 v[132:135], v[24:27], v[84:87], v[132:135]
    v_mfma_f32_16x16x32_bf16 v[136:139], v[28:31], v[80:83], v[136:139]
    ds_read_b128 v[24:27], v12 offset:57344
    v_mfma_f32_16x16x32_bf16 v[140:143], v[28:31], v[84:87], v[140:143]
    s_waitcnt lgkmcnt(5)
    v_mfma_f32_16x16x32_bf16 v[112:115], v[32:35], v[88:91], v[112:115]
    ds_read_b128 v[28:31], v12 offset:61440
    v_mfma_f32_16x16x32_bf16 v[116:119], v[32:35], v[92:95], v[116:119]
    v_mfma_f32_16x16x32_bf16 v[120:123], v[36:39], v[88:91], v[120:123]
    ds_read_b128 v[32:35], v13 offset:49152
    v_mfma_f32_16x16x32_bf16 v[124:127], v[36:39], v[92:95], v[124:127]
    s_waitcnt lgkmcnt(5)
    v_mfma_f32_16x16x32_bf16 v[128:131], v[40:43], v[88:91], v[128:131]
    ds_read_b128 v[36:39], v13 offset:53248
    v_mfma_f32_16x16x32_bf16 v[132:135], v[40:43], v[92:95], v[132:135]
    v_mfma_f32_16x16x32_bf16 v[136:139], v[44:47], v[88:91], v[136:139]
    ds_read_b128 v[40:43], v13 offset:57344
    v_mfma_f32_16x16x32_bf16 v[140:143], v[44:47], v[92:95], v[140:143]
    s_waitcnt lgkmcnt(5)
    v_mfma_f32_16x16x32_bf16 v[112:115], v[16:19], v[96:99], v[112:115]
    ds_read_b128 v[44:47], v13 offset:61440
    v_mfma_f32_16x16x32_bf16 v[116:119], v[16:19], v[100:103], v[116:119]
    v_mfma_f32_16x16x32_bf16 v[120:123], v[20:23], v[96:99], v[120:123]
    v_mfma_f32_16x16x32_bf16 v[124:127], v[20:23], v[100:103], v[124:127]
    s_waitcnt lgkmcnt(4)
    v_mfma_f32_16x16x32_bf16 v[128:131], v[24:27], v[96:99], v[128:131]
    v_mfma_f32_16x16x32_bf16 v[132:135], v[24:27], v[100:103], v[132:135]
    v_mfma_f32_16x16x32_bf16 v[136:139], v[28:31], v[96:99], v[136:139]
    v_mfma_f32_16x16x32_bf16 v[140:143], v[28:31], v[100:103], v[140:143]
    s_waitcnt lgkmcnt(2)
    v_mfma_f32_16x16x32_bf16 v[112:115], v[32:35], v[104:107], v[112:115]
    buffer_load_dwordx4 v[148:151], v15, s[36:39], s73 offen offset:0 sc1
    v_mfma_f32_16x16x32_bf16 v[116:119], v[32:35], v[108:111], v[116:119]
    buffer_load_dwordx4 v[156:159], v15, s[36:39], s73 offen offset:1024 sc1
    v_mfma_f32_16x16x32_bf16 v[120:123], v[36:39], v[104:107], v[120:123]
    buffer_load_dwordx4 v[164:167], v15, s[36:39], s73 offen offset:2048 sc1
    v_mfma_f32_16x16x32_bf16 v[124:127], v[36:39], v[108:111], v[124:127]
    buffer_load_dwordx4 v[172:175], v15, s[36:39], s73 offen offset:3072 sc1
    s_waitcnt lgkmcnt(0)
    v_mfma_f32_16x16x32_bf16 v[128:131], v[40:43], v[104:107], v[128:131]
    v_mfma_f32_16x16x32_bf16 v[132:135], v[40:43], v[108:111], v[132:135]
    v_mfma_f32_16x16x32_bf16 v[136:139], v[44:47], v[104:107], v[136:139]
    v_mfma_f32_16x16x32_bf16 v[140:143], v[44:47], v[108:111], v[140:143]
K3_EPI:
    s_nop 15
    s_add_u32 s77, s76, 32768
    s_add_u32 s78, s76, 65536
    s_add_u32 s79, s76, 98304
    v_mov_b32 v220, v112
    v_mov_b32 v221, v113
    v_mov_b32 v222, v114
    v_mov_b32 v223, v115
    v_mov_b32_dpp v112, v120 row_ror:8 row_mask:0xf bank_mask:0xc
    v_mov_b32_dpp v113, v121 row_ror:8 row_mask:0xf bank_mask:0xc
    v_mov_b32_dpp v114, v122 row_ror:8 row_mask:0xf bank_mask:0xc
    v_mov_b32_dpp v115, v123 row_ror:8 row_mask:0xf bank_mask:0xc
    v_mov_b32_dpp v120, v220 row_ror:8 row_mask:0xf bank_mask:0x3
    v_mov_b32_dpp v121, v221 row_ror:8 row_mask:0xf bank_mask:0x3
    v_mov_b32_dpp v122, v222 row_ror:8 row_mask:0xf bank_mask:0x3
    v_mov_b32_dpp v123, v223 row_ror:8 row_mask:0xf bank_mask:0x3
    v_mov_b32 v220, v116
    v_mov_b32 v221, v117
    v_mov_b32 v222, v118
    v_mov_b32 v223, v119
    v_mov_b32_dpp v116, v124 row_ror:8 row_mask:0xf bank_mask:0xc
    v_mov_b32_dpp v117, v125 row_ror:8 row_mask:0xf bank_mask:0xc
    v_mov_b32_dpp v118, v126 row_ror:8 row_mask:0xf bank_mask:0xc
    v_mov_b32_dpp v119, v127 row_ror:8 row_mask:0xf bank_mask:0xc
    v_mov_b32_dpp v124, v220 row_ror:8 row_mask:0xf bank_mask:0x3
    v_mov_b32_dpp v125, v221 row_ror:8 row_mask:0xf bank_mask:0x3
    v_mov_b32_dpp v126, v222 row_ror:8 row_mask:0xf bank_mask:0x3
    v_mov_b32_dpp v127, v223 row_ror:8 row_mask:0xf bank_mask:0x3
    v_mov_b32 v220, v128
    v_mov_b32 v221, v129
    v_mov_b32 v222, v130
    v_mov_b32 v223, v131
    v_mov_b32_dpp v128, v136 row_ror:8 row_mask:0xf bank_mask:0xc
    v_mov_b32_dpp v129, v137 row_ror:8 row_mask:0xf bank_mask:0xc
    v_mov_b32_dpp v130, v138 row_ror:8 row_mask:0xf bank_mask:0xc
    v_mov_b32_dpp v131, v139 row_ror:8 row_mask:0xf bank_mask:0xc
    v_mov_b32_dpp v136, v220 row_ror:8 row_mask:0xf bank_mask:0x3
    v_mov_b32_dpp v137, v221 row_ror:8 row_mask:0xf bank_mask:0x3
    v_mov_b32_dpp v138, v222 row_ror:8 row_mask:0xf bank_mask:0x3
    v_mov_b32_dpp v139, v223 row_ror:8 row_mask:0xf bank_mask:0x3
    v_mov_b32 v220, v132
    v_mov_b32 v221, v133
    v_mov_b32 v222, v134
    v_mov_b32 v223, v135
    v_mov_b32_dpp v132, v140 row_ror:8 row_mask:0xf bank_mask:0xc
    v_mov_b32_dpp v133, v141 row_ror:8 row_mask:0xf bank_mask:0xc
    v_mov_b32_dpp v134, v142 row_ror:8 row_mask:0xf bank_mask:0xc
    v_mov_b32_dpp v135, v143 row_ror:8 row_mask:0xf bank_mask:0xc
    v_mov_b32_dpp v140, v220 row_ror:8 row_mask:0xf bank_mask:0x3
    v_mov_b32_dpp v141, v221 row_ror:8 row_mask:0xf bank_mask:0x3
    v_mov_b32_dpp v142, v222 row_ror:8 row_mask:0xf bank_mask:0x3
    v_mov_b32_dpp v143, v223 row_ror:8 row_mask:0xf bank_mask:0x3
    s_barrier
    ds_read_b128 v[176:179], v216 offset:0
    ds_read_b128 v[180:183], v216 offset:4352
    ds_read_b128 v[184:187], v216 offset:2176
    ds_read_b128 v[188:191], v216 offset:6528
    ds_read_b128 v[192:195], v216 offset:128
    ds_read_b128 v[196:199], v216 offset:4480
    ds_read_b128 v[200:203], v216 offset:2304
    ds_read_b128 v[204:207], v216 offset:6656
    s_waitcnt lgkmcnt(7)
    v_add_f32 v112, v112, v176
    v_add_f32 v113, v113, v177
    v_add_f32 v114, v114, v178
    v_add_f32 v115, v115, v179
    s_waitcnt lgkmcnt(6)
    v_add_f32 v116, v116, v180
    v_add_f32 v117, v117, v181
    v_add_f32 v118, v118, v182
    v_add_f32 v119, v119, v183
    s_waitcnt lgkmcnt(5)
    v_add_f32 v120, v120, v184
    v_add_f32 v121, v121, v185
    v_add_f32 v122, v122, v186
    v_add_f32 v123, v123, v187
    s_waitcnt lgkmcnt(4)
    v_add_f32 v124, v124, v188
    v_add_f32 v125, v125, v189
    v_add_f32 v126, v126, v190
    v_add_f32 v127, v127, v191
    s_waitcnt lgkmcnt(3)
    v_add_f32 v128, v128, v192
    v_add_f32 v129, v129, v193
    v_add_f32 v130, v130, v194
    v_add_f32 v131, v131, v195
    s_waitcnt lgkmcnt(2)
    v_add_f32 v132, v132, v196
    v_add_f32 v133, v133, v197
    v_add_f32 v134, v134, v198
    v_add_f32 v135, v135, v199
    s_waitcnt lgkmcnt(1)
    v_add_f32 v136, v136, v200
    v_add_f32 v137, v137, v201
    v_add_f32 v138, v138, v202
    v_add_f32 v139, v139, v203
    s_waitcnt lgkmcnt(0)
    v_add_f32 v140, v140, v204
    v_add_f32 v141, v141, v205
    v_add_f32 v142, v142, v206
    v_add_f32 v143, v143, v207
    s_mov_b32 s69, 0
    s_branch K3_PCK_5
K3_POLL_4:
    buffer_load_dwordx4 v[148:151], v15, s[36:39], s73 offen offset:0 sc1
    buffer_load_dwordx4 v[156:159], v15, s[36:39], s73 offen offset:1024 sc1
    buffer_load_dwordx4 v[164:167], v15, s[36:39], s73 offen offset:2048 sc1
    buffer_load_dwordx4 v[172:175], v15, s[36:39], s73 offen offset:3072 sc1
K3_PCK_5:
    s_waitcnt vmcnt(0)
    v_max3_u32 v2, v148, v149, v150
    v_max3_u32 v2, v2, v151, v156
    v_max3_u32 v2, v2, v157, v158
    v_max3_u32 v2, v2, v159, v164
    v_max3_u32 v2, v2, v165, v166
    v_max3_u32 v2, v2, v167, v172
    v_max3_u32 v2, v2, v173, v174
    v_max_u32 v2, v2, v175
    s_nop 0
    v_cmp_eq_u32 vcc, -1, v2
    s_add_u32 s69, s69, 1
    s_nop 1
    s_cbranch_vccz K3_POK_6
    s_cmp_lt_u32 s69, 100000
    s_cbranch_scc1 K3_POLL_4
K3_POK_6:
    v_lshlrev_b32 v220, 16, v148
    v_and_b32 v221, 0xffff0000, v148
    v_lshlrev_b32 v222, 16, v149
    v_and_b32 v223, 0xffff0000, v149
    v_lshlrev_b32 v224, 16, v150
    v_and_b32 v225, 0xffff0000, v150
    v_lshlrev_b32 v226, 16, v151
    v_and_b32 v227, 0xffff0000, v151
    v_add_f32 v112, v112, v220
    v_add_f32 v113, v113, v221
    v_add_f32 v114, v114, v222
    v_add_f32 v115, v115, v223
    v_add_f32 v116, v116, v224
    v_add_f32 v117, v117, v225
    v_add_f32 v118, v118, v226
    v_add_f32 v119, v119, v227
    buffer_store_dwordx4 v[112:115], v14, s[44:47], s76 offen offset:0 sc1
    buffer_store_dwordx4 v[116:119], v14, s[44:47], s78 offen offset:0 sc1
    v_lshlrev_b32 v220, 16, v156
    v_and_b32 v221, 0xffff0000, v156
    v_lshlrev_b32 v222, 16, v157
    v_and_b32 v223, 0xffff0000, v157
    v_lshlrev_b32 v224, 16, v158
    v_and_b32 v225, 0xffff0000, v158
    v_lshlrev_b32 v226, 16, v159
    v_and_b32 v227, 0xffff0000, v159
    v_add_f32 v120, v120, v220
    v_add_f32 v121, v121, v221
    v_add_f32 v122, v122, v222
    v_add_f32 v123, v123, v223
    v_add_f32 v124, v124, v224
    v_add_f32 v125, v125, v225
    v_add_f32 v126, v126, v226
    v_add_f32 v127, v127, v227
    buffer_store_dwordx4 v[120:123], v14, s[44:47], s77 offen offset:0 sc1
    buffer_store_dwordx4 v[124:127], v14, s[44:47], s79 offen offset:0 sc1
    v_lshlrev_b32 v220, 16, v164
    v_and_b32 v221, 0xffff0000, v164
    v_lshlrev_b32 v222, 16, v165
    v_and_b32 v223, 0xffff0000, v165
    v_lshlrev_b32 v224, 16, v166
    v_and_b32 v225, 0xffff0000, v166
    v_lshlrev_b32 v226, 16, v167
    v_and_b32 v227, 0xffff0000, v167
    v_add_f32 v128, v128, v220
    v_add_f32 v129, v129, v221
    v_add_f32 v130, v130, v222
    v_add_f32 v131, v131, v223
    v_add_f32 v132, v132, v224
    v_add_f32 v133, v133, v225
    v_add_f32 v134, v134, v226
    v_add_f32 v135, v135, v227
    buffer_store_dwordx4 v[128:131], v14, s[44:47], s76 offen offset:128 sc1
    buffer_store_dwordx4 v[132:135], v14, s[44:47], s78 offen offset:128 sc1
    v_lshlrev_b32 v220, 16, v172
    v_and_b32 v221, 0xffff0000, v172
    v_lshlrev_b32 v222, 16, v173
    v_and_b32 v223, 0xffff0000, v173
    v_lshlrev_b32 v224, 16, v174
    v_and_b32 v225, 0xffff0000, v174
    v_lshlrev_b32 v226, 16, v175
    v_and_b32 v227, 0xffff0000, v175
    v_add_f32 v136, v136, v220
    v_add_f32 v137, v137, v221
    v_add_f32 v138, v138, v222
    v_add_f32 v139, v139, v223
    v_add_f32 v140, v140, v224
    v_add_f32 v141, v141, v225
    v_add_f32 v142, v142, v226
    v_add_f32 v143, v143, v227
    buffer_store_dwordx4 v[136:139], v14, s[44:47], s77 offen offset:128 sc1
    buffer_store_dwordx4 v[140:143], v14, s[44:47], s79 offen offset:128 sc1
    s_endpgm
K3_PROD:
    s_sub_u32 s77, s3, 4
    v_and_b32 v19, 15, v0
    v_lshrrev_b32 v20, 1, v19
    v_and_b32 v21, 1, v19
    v_lshlrev_b32 v21, 4, v21
    v_lshl_add_u32 v21, v18, 11, v21
    v_xor_b32 v22, v20, v18
    v_xor_b32 v23, 4, v22
    v_lshl_add_u32 v22, v22, 5, v21
    v_lshl_add_u32 v23, v23, 5, v21
    v_add_u32 v32, 0, v22
    v_add_u32 v33, 7168, v22
    v_add_u32 v34, 14336, v23
    v_add_u32 v35, 21504, v23
    v_add_u32 v36, 32768, v22
    v_add_u32 v37, 39936, v22
    v_add_u32 v38, 47104, v23
    v_add_u32 v39, 54272, v23
    v_xor_b32 v22, v19, v18
    v_lshlrev_b32 v21, 11, v18
    v_xor_b32 v23, 0, v22
    v_lshl_add_u32 v23, v23, 4, v21
    v_add_u32 v40, 0, v23
    v_xor_b32 v23, 4, v22
    v_lshl_add_u32 v23, v23, 4, v21
    v_add_u32 v41, 7168, v23
    v_xor_b32 v23, 8, v22
    v_lshl_add_u32 v23, v23, 4, v21
    v_add_u32 v42, 14336, v23
    v_xor_b32 v23, 12, v22
    v_lshl_add_u32 v23, v23, 4, v21
    v_add_u32 v43, 21504, v23
    v_xor_b32 v23, 0, v22
    v_lshl_add_u32 v23, v23, 4, v21
    v_add_u32 v44, 32768, v23
    v_xor_b32 v23, 4, v22
    v_lshl_add_u32 v23, v23, 4, v21
    v_add_u32 v45, 39936, v23
    v_xor_b32 v23, 8, v22
    v_lshl_add_u32 v23, v23, 4, v21
    v_add_u32 v46, 47104, v23
    v_xor_b32 v23, 12, v22
    v_lshl_add_u32 v23, v23, 4, v21
    v_add_u32 v47, 54272, v23
    v_mov_b32 v16, v32
    v_mov_b32 v17, v33
    v_mov_b32 v18, v34
    v_mov_b32 v19, v35
    v_mov_b32 v20, v36
    v_mov_b32 v21, v37
    v_mov_b32 v22, v38
    v_mov_b32 v23, v39
    v_mov_b32 v24, v40
    v_mov_b32 v25, v41
    v_mov_b32 v26, v42
    v_mov_b32 v27, v43
    v_mov_b32 v28, v44
    v_mov_b32 v29, v45
    v_mov_b32 v30, v46
    v_mov_b32 v31, v47
    s_lshl_b32 s71, s77, 13
    s_mul_i32 s70, s6, 2816
    s_lshl_b32 s7, s77, 5
    s_add_u32 s70, s70, s7
    s_lshl_b32 s70, s70, 11
    s_lshl_b32 s7, s65, 1
    s_add_u32 s70, s70, s7
    s_lshl_b32 s79, s77, 5
    s_add_u32 s79, s79, s65
    s_lshl_b32 s79, s79, 11
    s_waitcnt lgkmcnt(0)
    s_mov_b32 s8, s48
    s_mov_b32 s9, s49
    s_mov_b32 s10, 0x700000
    s_mov_b32 s11, 0x00020000
    s_mov_b32 s12, s52
    s_mov_b32 s13, s53
    s_mov_b32 s14, 0x200000
    s_mov_b32 s15, 0x00020000
    s_mov_b32 s16, s54
    s_mov_b32 s17, s55
    s_mov_b32 s18, 0x200000
    s_mov_b32 s19, 0x00020000
    s_mov_b32 m0, s71
    s_nop 0
    buffer_load_dwordx4 v16, s[8:11], s70 offen offset:0  lds
    buffer_load_dwordx4 v17, s[8:11], s70 offen offset:1024  lds
    buffer_load_dwordx4 v18, s[8:11], s70 offen offset:2048  lds
    buffer_load_dwordx4 v19, s[8:11], s70 offen offset:3072  lds
    s_add_u32 m0, s71, 4096
    s_nop 0
    buffer_load_dwordx4 v20, s[8:11], s70 offen offset:0  lds
    buffer_load_dwordx4 v21, s[8:11], s70 offen offset:1024  lds
    buffer_load_dwordx4 v22, s[8:11], s70 offen offset:2048  lds
    buffer_load_dwordx4 v23, s[8:11], s70 offen offset:3072  lds
    s_add_u32 s70, s70, 262144
    s_add_u32 s71, s71, 32768
    s_cmp_ge_u32 s71, 163840
    s_cselect_b32 s7, 163840, 0
    s_sub_u32 s71, s71, s7
    s_mov_b32 m0, s71
    s_nop 0
    buffer_load_dwordx4 v16, s[8:11], s70 offen offset:0  lds
    buffer_load_dwordx4 v17, s[8:11], s70 offen offset:1024  lds
    buffer_load_dwordx4 v18, s[8:11], s70 offen offset:2048  lds
    buffer_load_dwordx4 v19, s[8:11], s70 offen offset:3072  lds
    s_add_u32 m0, s71, 4096
    s_nop 0
    buffer_load_dwordx4 v20, s[8:11], s70 offen offset:0  lds
    buffer_load_dwordx4 v21, s[8:11], s70 offen offset:1024  lds
    buffer_load_dwordx4 v22, s[8:11], s70 offen offset:2048  lds
    buffer_load_dwordx4 v23, s[8:11], s70 offen offset:3072  lds
    s_add_u32 s70, s70, 262144
    s_add_u32 s71, s71, 32768
    s_cmp_ge_u32 s71, 163840
    s_cselect_b32 s7, 163840, 0
    s_sub_u32 s71, s71, s7
    s_waitcnt vmcnt(8)
    s_barrier
    s_mov_b32 m0, s71
    s_nop 0
    buffer_load_dwordx4 v16, s[8:11], s70 offen offset:0  lds
    buffer_load_dwordx4 v17, s[8:11], s70 offen offset:1024  lds
    buffer_load_dwordx4 v18, s[8:11], s70 offen offset:2048  lds
    buffer_load_dwordx4 v19, s[8:11], s70 offen offset:3072  lds
    s_add_u32 m0, s71, 4096
    s_nop 0
    buffer_load_dwordx4 v20, s[8:11], s70 offen offset:0  lds
    buffer_load_dwordx4 v21, s[8:11], s70 offen offset:1024  lds
    buffer_load_dwordx4 v22, s[8:11], s70 offen offset:2048  lds
    buffer_load_dwordx4 v23, s[8:11], s70 offen offset:3072  lds
    s_add_u32 s70, s70, 262144
    s_add_u32 s71, s71, 32768
    s_cmp_ge_u32 s71, 163840
    s_cselect_b32 s7, 163840, 0
    s_sub_u32 s71, s71, s7
    s_mov_b32 m0, s71
    s_nop 0
    buffer_load_dwordx4 v16, s[8:11], s70 offen offset:0  lds
    buffer_load_dwordx4 v17, s[8:11], s70 offen offset:1024  lds
    buffer_load_dwordx4 v18, s[8:11], s70 offen offset:2048  lds
    buffer_load_dwordx4 v19, s[8:11], s70 offen offset:3072  lds
    s_add_u32 m0, s71, 4096
    s_nop 0
    buffer_load_dwordx4 v20, s[8:11], s70 offen offset:0  lds
    buffer_load_dwordx4 v21, s[8:11], s70 offen offset:1024  lds
    buffer_load_dwordx4 v22, s[8:11], s70 offen offset:2048  lds
    buffer_load_dwordx4 v23, s[8:11], s70 offen offset:3072  lds
    s_add_u32 s70, s70, 262144
    s_add_u32 s71, s71, 32768
    s_cmp_ge_u32 s71, 163840
    s_cselect_b32 s7, 163840, 0
    s_sub_u32 s71, s71, s7
    s_cmp_eq_u32 s6, 0
    s_cbranch_scc0 K3_PH1
    s_mov_b32 s69, 18
K3_PL_7:
    s_waitcnt vmcnt(16)
    s_barrier
    s_mov_b32 m0, s71
    s_nop 0
    buffer_load_dwordx4 v16, s[8:11], s70 offen offset:0  lds
    buffer_load_dwordx4 v17, s[8:11], s70 offen offset:1024  lds
    buffer_load_dwordx4 v18, s[8:11], s70 offen offset:2048  lds
    buffer_load_dwordx4 v19, s[8:11], s70 offen offset:3072  lds
    s_add_u32 m0, s71, 4096
    s_nop 0
    buffer_load_dwordx4 v20, s[8:11], s70 offen offset:0  lds
    buffer_load_dwordx4 v21, s[8:11], s70 offen offset:1024  lds
    buffer_load_dwordx4 v22, s[8:11], s70 offen offset:2048  lds
    buffer_load_dwordx4 v23, s[8:11], s70 offen offset:3072  lds
    s_add_u32 s70, s70, 262144
    s_add_u32 s71, s71, 32768
    s_cmp_ge_u32 s71, 163840
    s_cselect_b32 s7, 163840, 0
    s_sub_u32 s71, s71, s7
    s_sub_u32 s69, s69, 1
    s_cmp_lg_u32 s69, 0
    s_cbranch_scc1 K3_PL_7
    s_branch K3_PTAIL
K3_PH1:
    s_mov_b32 s69, 2
K3_PL_8:
    s_waitcnt vmcnt(16)
    s_barrier
    s_mov_b32 m0, s71
    s_nop 0
    buffer_load_dwordx4 v16, s[8:11], s70 offen offset:0  lds
    buffer_load_dwordx4 v17, s[8:11], s70 offen offset:1024  lds
    buffer_load_dwordx4 v18, s[8:11], s70 offen offset:2048  lds
    buffer_load_dwordx4 v19, s[8:11], s70 offen offset:3072  lds
    s_add_u32 m0, s71, 4096
    s_nop 0
    buffer_load_dwordx4 v20, s[8:11], s70 offen offset:0  lds
    buffer_load_dwordx4 v21, s[8:11], s70 offen offset:1024  lds
    buffer_load_dwordx4 v22, s[8:11], s70 offen offset:2048  lds
    buffer_load_dwordx4 v23, s[8:11], s70 offen offset:3072  lds
    s_add_u32 s70, s70, 262144
    s_add_u32 s71, s71, 32768
    s_cmp_ge_u32 s71, 163840
    s_cselect_b32 s7, 163840, 0
    s_sub_u32 s71, s71, s7
    s_sub_u32 s69, s69, 1
    s_cmp_lg_u32 s69, 0
    s_cbranch_scc1 K3_PL_8
    s_mov_b32 s70, s79
    s_mov_b32 s69, 8
K3_PL_9:
    s_waitcnt vmcnt(16)
    s_barrier
    s_mov_b32 m0, s71
    s_nop 0
    buffer_load_dwordx4 v24, s[12:15], s70 offen offset:0  lds
    buffer_load_dwordx4 v25, s[12:15], s70 offen offset:1024  lds
    buffer_load_dwordx4 v26, s[12:15], s70 offen offset:2048  lds
    buffer_load_dwordx4 v27, s[12:15], s70 offen offset:3072  lds
    s_add_u32 m0, s71, 4096
    s_nop 0
    buffer_load_dwordx4 v28, s[12:15], s70 offen offset:0  lds
    buffer_load_dwordx4 v29, s[12:15], s70 offen offset:1024  lds
    buffer_load_dwordx4 v30, s[12:15], s70 offen offset:2048  lds
    buffer_load_dwordx4 v31, s[12:15], s70 offen offset:3072  lds
    s_add_u32 s70, s70, 256
    s_add_u32 s71, s71, 32768
    s_cmp_ge_u32 s71, 163840
    s_cselect_b32 s7, 163840, 0
    s_sub_u32 s71, s71, s7
    s_sub_u32 s69, s69, 1
    s_cmp_lg_u32 s69, 0
    s_cbranch_scc1 K3_PL_9
    s_mov_b32 s70, s79
    s_mov_b32 s69, 8
K3_PL_10:
    s_waitcnt vmcnt(16)
    s_barrier
    s_mov_b32 m0, s71
    s_nop 0
    buffer_load_dwordx4 v24, s[16:19], s70 offen offset:0  lds
    buffer_load_dwordx4 v25, s[16:19], s70 offen offset:1024  lds
    buffer_load_dwordx4 v26, s[16:19], s70 offen offset:2048  lds
    buffer_load_dwordx4 v27, s[16:19], s70 offen offset:3072  lds
    s_add_u32 m0, s71, 4096
    s_nop 0
    buffer_load_dwordx4 v28, s[16:19], s70 offen offset:0  lds
    buffer_load_dwordx4 v29, s[16:19], s70 offen offset:1024  lds
    buffer_load_dwordx4 v30, s[16:19], s70 offen offset:2048  lds
    buffer_load_dwordx4 v31, s[16:19], s70 offen offset:3072  lds
    s_add_u32 s70, s70, 256
    s_add_u32 s71, s71, 32768
    s_cmp_ge_u32 s71, 163840
    s_cselect_b32 s7, 163840, 0
    s_sub_u32 s71, s71, s7
    s_sub_u32 s69, s69, 1
    s_cmp_lg_u32 s69, 0
    s_cbranch_scc1 K3_PL_10
K3_PTAIL:
    v_and_b32 v32, 15, v0
    v_lshrrev_b32 v33, 4, v0
    v_lshlrev_b32 v32, 4, v32
    v_lshl_add_u32 v32, v33, 15, v32
    s_mul_i32 s78, s6, 11534336
    s_lshl_b32 s7, s77, 5
    s_add_u32 s7, s7, s64
    s_lshl_b32 s7, s7, 4
    s_add_u32 s78, s78, s7
    s_add_u32 s78, s78, 11403264
    s_add_u32 s20, s56, 0x400000
    s_addc_u32 s21, s57, 0
    s_mov_b32 s22, 0x1600000
    s_mov_b32 s23, 0x00020000
    buffer_load_dwordx4 v[36:39], v32, s[20:23], s78 offen
    buffer_load_dwordx4 v[40:43], v32, s[20:23], s78 offen offset:256
    s_mov_b32 s24, s58
    s_mov_b32 s25, s59
    s_mov_b32 s26, 0x400000
    s_mov_b32 s27, 0x00020000
    s_mov_b32 s28, s56
    s_mov_b32 s29, s57
    s_mov_b32 s30, 0x400000
    s_mov_b32 s31, 0x00020000
    s_mov_b32 s32, s60
    s_mov_b32 s33, s61
    s_mov_b32 s34, 0x800
    s_mov_b32 s35, 0x00020000
    s_lshl_b32 s78, s6, 6
    s_add_u32 s78, s78, s65
    s_lshl_b32 s79, s77, 5
    s_add_u32 s79, s79, s64
    v_and_b32 v130, 7, v0
    v_lshrrev_b32 v131, 3, v0
    v_lshlrev_b32 v132, 15, v130
    v_lshl_add_u32 v132, v131, 4, v132
    s_lshl_b32 s82, s78, 12
    s_lshl_b32 s7, s79, 4
    s_add_u32 s82, s82, s7
    buffer_load_dwordx4 v[48:51], v132, s[28:31], s82 offen offset:0
    buffer_load_dwordx4 v[52:55], v132, s[28:31], s82 offen offset:128
    buffer_load_dwordx4 v[56:59], v132, s[28:31], s82 offen offset:256
    buffer_load_dwordx4 v[60:63], v132, s[28:31], s82 offen offset:384
    v_lshrrev_b32 v133, 2, v131
    v_lshlrev_b32 v133, 3, v133
    v_and_b32 v134, 3, v131
    v_add_u32 v133, v133, v134
    v_lshlrev_b32 v134, 11, v133
    v_lshl_add_u32 v134, v130, 4, v134
    s_lshl_b32 s82, s79, 11
    s_lshl_b32 s7, s78, 1
    s_add_u32 s82, s82, s7
    s_add_u32 s83, s82, 0
    buffer_load_dwordx4 v[64:67], v134, s[24:27], s83 offen
    s_add_u32 s83, s82, 32768
    buffer_load_dwordx4 v[68:71], v134, s[24:27], s83 offen
    s_add_u32 s83, s82, 8192
    buffer_load_dwordx4 v[72:75], v134, s[24:27], s83 offen
    s_add_u32 s83, s82, 40960
    buffer_load_dwordx4 v[76:79], v134, s[24:27], s83 offen
    v_lshlrev_b32 v135, 4, v130
    buffer_load_dwordx4 v[80:83], v135, s[32:35], s7 offen
    s_lshl_b32 s7, s77, 5
    v_add_u32 v133, s7, v133
    v_mul_u32_u24 v133, 272, v133
    v_lshl_add_u32 v133, v130, 5, v133
    v_add_u32 v133, 98304, v133
    s_waitcnt vmcnt(27)
    s_barrier
    s_waitcnt vmcnt(19)
    s_barrier
    s_waitcnt vmcnt(11)
    s_barrier
    s_waitcnt vmcnt(0)
    v_lshlrev_b32 v84, 16, v80
    v_and_b32 v85, 0xffff0000, v80
    v_lshlrev_b32 v86, 16, v81
    v_and_b32 v87, 0xffff0000, v81
    v_lshlrev_b32 v88, 16, v82
    v_and_b32 v89, 0xffff0000, v82
    v_lshlrev_b32 v90, 16, v83
    v_and_b32 v91, 0xffff0000, v83
    v_lshlrev_b32 v124, 16, v48
    v_and_b32 v125, 0xffff0000, v48
    v_mul_f32 v124, v124, v84
    v_mul_f32 v125, v125, v85
    v_lshlrev_b32 v92, 16, v64
    v_cvt_pk_bf16_f32 v124, v124, v125
    v_and_b32 v93, 0xffff0000, v64
    v_lshlrev_b32 v126, 16, v124
    v_and_b32 v127, 0xffff0000, v124
    v_add_f32 v92, v92, v126
    v_add_f32 v93, v93, v127
    v_lshlrev_b32 v124, 16, v49
    v_and_b32 v125, 0xffff0000, v49
    v_mul_f32 v124, v124, v86
    v_mul_f32 v125, v125, v87
    v_lshlrev_b32 v94, 16, v65
    v_cvt_pk_bf16_f32 v124, v124, v125
    v_and_b32 v95, 0xffff0000, v65
    v_lshlrev_b32 v126, 16, v124
    v_and_b32 v127, 0xffff0000, v124
    v_add_f32 v94, v94, v126
    v_add_f32 v95, v95, v127
    v_lshlrev_b32 v124, 16, v50
    v_and_b32 v125, 0xffff0000, v50
    v_mul_f32 v124, v124, v88
    v_mul_f32 v125, v125, v89
    v_lshlrev_b32 v96, 16, v66
    v_cvt_pk_bf16_f32 v124, v124, v125
    v_and_b32 v97, 0xffff0000, v66
    v_lshlrev_b32 v126, 16, v124
    v_and_b32 v127, 0xffff0000, v124
    v_add_f32 v96, v96, v126
    v_add_f32 v97, v97, v127
    v_lshlrev_b32 v124, 16, v51
    v_and_b32 v125, 0xffff0000, v51
    v_mul_f32 v124, v124, v90
    v_mul_f32 v125, v125, v91
    v_lshlrev_b32 v98, 16, v67
    v_cvt_pk_bf16_f32 v124, v124, v125
    v_and_b32 v99, 0xffff0000, v67
    v_lshlrev_b32 v126, 16, v124
    v_and_b32 v127, 0xffff0000, v124
    v_add_f32 v98, v98, v126
    v_add_f32 v99, v99, v127
    ds_write_b128 v133, v[92:95] offset:0
    ds_write_b128 v133, v[96:99] offset:16
    v_lshlrev_b32 v124, 16, v52
    v_and_b32 v125, 0xffff0000, v52
    v_mul_f32 v124, v124, v84
    v_mul_f32 v125, v125, v85
    v_lshlrev_b32 v100, 16, v68
    v_cvt_pk_bf16_f32 v124, v124, v125
    v_and_b32 v101, 0xffff0000, v68
    v_lshlrev_b32 v126, 16, v124
    v_and_b32 v127, 0xffff0000, v124
    v_add_f32 v100, v100, v126
    v_add_f32 v101, v101, v127
    v_lshlrev_b32 v124, 16, v53
    v_and_b32 v125, 0xffff0000, v53
    v_mul_f32 v124, v124, v86
    v_mul_f32 v125, v125, v87
    v_lshlrev_b32 v102, 16, v69
    v_cvt_pk_bf16_f32 v124, v124, v125
    v_and_b32 v103, 0xffff0000, v69
    v_lshlrev_b32 v126, 16, v124
    v_and_b32 v127, 0xffff0000, v124
    v_add_f32 v102, v102, v126
    v_add_f32 v103, v103, v127
    v_lshlrev_b32 v124, 16, v54
    v_and_b32 v125, 0xffff0000, v54
    v_mul_f32 v124, v124, v88
    v_mul_f32 v125, v125, v89
    v_lshlrev_b32 v104, 16, v70
    v_cvt_pk_bf16_f32 v124, v124, v125
    v_and_b32 v105, 0xffff0000, v70
    v_lshlrev_b32 v126, 16, v124
    v_and_b32 v127, 0xffff0000, v124
    v_add_f32 v104, v104, v126
    v_add_f32 v105, v105, v127
    v_lshlrev_b32 v124, 16, v55
    v_and_b32 v125, 0xffff0000, v55
    v_mul_f32 v124, v124, v90
    v_mul_f32 v125, v125, v91
    v_lshlrev_b32 v106, 16, v71
    v_cvt_pk_bf16_f32 v124, v124, v125
    v_and_b32 v107, 0xffff0000, v71
    v_lshlrev_b32 v126, 16, v124
    v_and_b32 v127, 0xffff0000, v124
    v_add_f32 v106, v106, v126
    v_add_f32 v107, v107, v127
    ds_write_b128 v133, v[100:103] offset:4352
    ds_write_b128 v133, v[104:107] offset:4368
    v_lshlrev_b32 v124, 16, v56
    v_and_b32 v125, 0xffff0000, v56
    v_mul_f32 v124, v124, v84
    v_mul_f32 v125, v125, v85
    v_lshlrev_b32 v108, 16, v72
    v_cvt_pk_bf16_f32 v124, v124, v125
    v_and_b32 v109, 0xffff0000, v72
    v_lshlrev_b32 v126, 16, v124
    v_and_b32 v127, 0xffff0000, v124
    v_add_f32 v108, v108, v126
    v_add_f32 v109, v109, v127
    v_lshlrev_b32 v124, 16, v57
    v_and_b32 v125, 0xffff0000, v57
    v_mul_f32 v124, v124, v86
    v_mul_f32 v125, v125, v87
    v_lshlrev_b32 v110, 16, v73
    v_cvt_pk_bf16_f32 v124, v124, v125
    v_and_b32 v111, 0xffff0000, v73
    v_lshlrev_b32 v126, 16, v124
    v_and_b32 v127, 0xffff0000, v124
    v_add_f32 v110, v110, v126
    v_add_f32 v111, v111, v127
    v_lshlrev_b32 v124, 16, v58
    v_and_b32 v125, 0xffff0000, v58
    v_mul_f32 v124, v124, v88
    v_mul_f32 v125, v125, v89
    v_lshlrev_b32 v112, 16, v74
    v_cvt_pk_bf16_f32 v124, v124, v125
    v_and_b32 v113, 0xffff0000, v74
    v_lshlrev_b32 v126, 16, v124
    v_and_b32 v127, 0xffff0000, v124
    v_add_f32 v112, v112, v126
    v_add_f32 v113, v113, v127
    v_lshlrev_b32 v124, 16, v59
    v_and_b32 v125, 0xffff0000, v59
    v_mul_f32 v124, v124, v90
    v_mul_f32 v125, v125, v91
    v_lshlrev_b32 v114, 16, v75
    v_cvt_pk_bf16_f32 v124, v124, v125
    v_and_b32 v115, 0xffff0000, v75
    v_lshlrev_b32 v126, 16, v124
    v_and_b32 v127, 0xffff0000, v124
    v_add_f32 v114, v114, v126
    v_add_f32 v115, v115, v127
    ds_write_b128 v133, v[108:111] offset:1088
    ds_write_b128 v133, v[112:115] offset:1104
    v_lshlrev_b32 v124, 16, v60
    v_and_b32 v125, 0xffff0000, v60
    v_mul_f32 v124, v124, v84
    v_mul_f32 v125, v125, v85
    v_lshlrev_b32 v116, 16, v76
    v_cvt_pk_bf16_f32 v124, v124, v125
    v_and_b32 v117, 0xffff0000, v76
    v_lshlrev_b32 v126, 16, v124
    v_and_b32 v127, 0xffff0000, v124
    v_add_f32 v116, v116, v126
    v_add_f32 v117, v117, v127
    v_lshlrev_b32 v124, 16, v61
    v_and_b32 v125, 0xffff0000, v61
    v_mul_f32 v124, v124, v86
    v_mul_f32 v125, v125, v87
    v_lshlrev_b32 v118, 16, v77
    v_cvt_pk_bf16_f32 v124, v124, v125
    v_and_b32 v119, 0xffff0000, v77
    v_lshlrev_b32 v126, 16, v124
    v_and_b32 v127, 0xffff0000, v124
    v_add_f32 v118, v118, v126
    v_add_f32 v119, v119, v127
    v_lshlrev_b32 v124, 16, v62
    v_and_b32 v125, 0xffff0000, v62
    v_mul_f32 v124, v124, v88
    v_mul_f32 v125, v125, v89
    v_lshlrev_b32 v120, 16, v78
    v_cvt_pk_bf16_f32 v124, v124, v125
    v_and_b32 v121, 0xffff0000, v78
    v_lshlrev_b32 v126, 16, v124
    v_and_b32 v127, 0xffff0000, v124
    v_add_f32 v120, v120, v126
    v_add_f32 v121, v121, v127
    v_lshlrev_b32 v124, 16, v63
    v_and_b32 v125, 0xffff0000, v63
    v_mul_f32 v124, v124, v90
    v_mul_f32 v125, v125, v91
    v_lshlrev_b32 v122, 16, v79
    v_cvt_pk_bf16_f32 v124, v124, v125
    v_and_b32 v123, 0xffff0000, v79
    v_lshlrev_b32 v126, 16, v124
    v_and_b32 v127, 0xffff0000, v124
    v_add_f32 v122, v122, v126
    v_add_f32 v123, v123, v127
    ds_write_b128 v133, v[116:119] offset:5440
    ds_write_b128 v133, v[120:123] offset:5456
    s_waitcnt lgkmcnt(0)
    s_barrier
K3_END:
    s_endpgm
.section .rodata,"a"
.p2align 6
.amdhsa_kernel ssm_ln_kernel
  .amdhsa_next_free_vgpr 120
  .amdhsa_next_free_sgpr 102
  .amdhsa_accum_offset 120
  .amdhsa_group_segment_fixed_size 0
  .amdhsa_kernarg_size 128
  .amdhsa_user_sgpr_count 2
  .amdhsa_user_sgpr_kernarg_segment_ptr 1
  .amdhsa_system_sgpr_workgroup_id_x 1
.end_amdhsa_kernel

.p2align 6
.amdhsa_kernel ssm_gemm1_kernel
  .amdhsa_next_free_vgpr 256
  .amdhsa_next_free_sgpr 102
  .amdhsa_accum_offset 256
  .amdhsa_group_segment_fixed_size 0
  .amdhsa_kernarg_size 128
  .amdhsa_user_sgpr_count 2
  .amdhsa_user_sgpr_kernarg_segment_ptr 1
  .amdhsa_system_sgpr_workgroup_id_x 1
.end_amdhsa_kernel

.p2align 6
.amdhsa_kernel ssm_gemm2_kernel
  .amdhsa_next_free_vgpr 228
  .amdhsa_next_free_sgpr 102
  .amdhsa_accum_offset 228
  .amdhsa_group_segment_fixed_size 0
  .amdhsa_kernarg_size 128
  .amdhsa_user_sgpr_count 2
  .amdhsa_user_sgpr_kernarg_segment_ptr 1
  .amdhsa_system_sgpr_workgroup_id_x 1
.end_amdhsa_kernel
```
